```python
import torch

def _softmax(x, axis=-1):
    return torch.softmax(x, dim=axis)
def _gelu(x):
    return torch.nn.functional.gelu(x, approximate="tanh")
def _silu(x):
    return torch.nn.functional.silu(x)
def _sigmoid(x):
    return torch.sigmoid(x)
def _layernorm(x, axis=-1, eps=1e-5):
    m = x.mean(dim=axis, keepdim=True)
    v = x.var(dim=axis, keepdim=True, unbiased=False)
    return (x - m) / torch.sqrt(v + eps)
def _scatter_add(tgt, idx, src, axis=0):
    return tgt.clone().index_add_(axis, idx, src)
def _segment_sum(src, seg, n):
    out = torch.zeros((n,) + src.shape[1:], dtype=src.dtype)
    return out.index_add_(0, seg, src)
def _pad(x, pw):
    flat = tuple(v for pair in reversed(pw) for v in pair)
    return torch.nn.functional.pad(x, flat)

kernel_name = 'interleave_layers__spectral_fnet__dense_activation_relu__prompt'

def setup_inputs():

    _w = (lambda a: (lambda t: t.to(torch.bfloat16) if t.is_floating_point() else t)(torch.as_tensor(a)))
    def _A_setup():
        B, S, D = 1, 2048, 640
        ns = torch.arange(S)[:, None] * torch.arange(S)[None, :]
        nd = torch.arange(D)[:, None] * torch.arange(D)[None, :]
        Ws_re = torch.cos(-2.0 * torch.pi * ns / S).to(float)
        Ws_im = torch.sin(-2.0 * torch.pi * ns / S).to(float)
        Wd_re = torch.cos(-2.0 * torch.pi * nd / D).to(float)
        Wd_im = torch.sin(-2.0 * torch.pi * nd / D).to(float)
        return {
            "x": _w((lambda *s: torch.randn(*s, dtype=torch.bfloat16) * 0.05)(B, S, D)),
            "dft_seq_re": _w(Ws_re),
            "dft_seq_im": _w(Ws_im),
            "dft_hid_re": _w(Wd_re),
            "dft_hid_im": _w(Wd_im),
        }
    _A_in = _A_setup()

    def _B_setup():
        B, S, D, Dff = 1, 2048, 640, 1728
        return {
            "x": _w((lambda *s: torch.randn(*s, dtype=torch.bfloat16) * 0.05)(B, S, D)),
            "w1": _w((lambda *s: torch.randn(*s, dtype=torch.bfloat16) * 1.6)(D, Dff)),
            "w2": _w((lambda *s: torch.randn(*s, dtype=torch.bfloat16) * 1.6)(Dff, D)),
        }
    _B_in = _B_setup()

    return {
        "A_x": _A_in["x"],
        "A_dft_seq_re": _A_in["dft_seq_re"],
        "A_dft_seq_im": _A_in["dft_seq_im"],
        "A_dft_hid_re": _A_in["dft_hid_re"],
        "A_dft_hid_im": _A_in["dft_hid_im"],
        "B_x": _B_in["x"],
        "B_w1": _B_in["w1"],
        "B_w2": _B_in["w2"],
    }

def reference(A_x, A_dft_seq_re, A_dft_seq_im, A_dft_hid_re, A_dft_hid_im, B_x, B_w1, B_w2):
    def _A_ref(x, dft_seq_re, dft_seq_im, dft_hid_re, dft_hid_im):
        a = torch.einsum("bsd,ed->bse", x, dft_hid_re)
        b = torch.einsum("bsd,ed->bse", x, dft_hid_im)
        y = torch.einsum("ts,bse->bte", dft_seq_re, a) - torch.einsum("ts,bse->bte", dft_seq_im, b)
        return y

    def _B_ref(x, w1, w2):
        h = torch.einsum("bsd,df->bsf", x, w1)
        zero = torch.zeros_like(h)
        h = torch.maximum(h, zero)
        return torch.einsum("bsf,fd->bsd", h, w2)

    x = A_x
    x = x + _A_ref(_layernorm(x, axis=-1), A_dft_seq_re, A_dft_seq_im, A_dft_hid_re, A_dft_hid_im)
    x = x + _B_ref(_layernorm(x, axis=-1), B_w1, B_w2)
    x = x + _A_ref(_layernorm(x, axis=-1), A_dft_seq_re, A_dft_seq_im, A_dft_hid_re, A_dft_hid_im)
    x = x + _B_ref(_layernorm(x, axis=-1), B_w1, B_w2)
    return x
```

```asm
; @launch grid=(256,1,1) block=(512,1,1) lds=163840
.amdgcn_target "amdgcn-amd-amdhsa--gfx950"
.text
.globl interleave_layers__spectral_fnet__dense_activation_relu__prompt_kernel
.p2align 8
.type interleave_layers__spectral_fnet__dense_activation_relu__prompt_kernel,@function
interleave_layers__spectral_fnet__dense_activation_relu__prompt_kernel:
    s_cmp_ge_u32 s2, 256
    s_cbranch_scc1 interleave_layers__spectral_fnet__dense_activation_relu__prompt_kernel_end
    s_load_dwordx16 s[8:23], s[0:1], 0
    s_load_dwordx2 s[24:25], s[0:1], 64
    s_load_dwordx2 s[26:27], s[0:1], 80
    s_load_dwordx2 s[96:97], s[0:1], 72
    v_lshrrev_b32 v1, 6, v0
    s_nop 0
    v_readfirstlane_b32 s3, v1
    v_and_b32 v1, 63, v0
    s_getpc_b64 s[98:99]
Lpc:
    s_lshr_b32 s6, s2, 3
    s_lshl_b32 s6, s6, 5
    v_and_b32 v253, 31, v0
    v_add_u32 v253, s6, v253
    v_lshlrev_b32 v253, 7, v253
    v_min_u32 v253, interleave_layers__spectral_fnet__dense_activation_relu__prompt_kernel_end - Lpc, v253
    v_cmp_gt_u32 vcc, 32, v0
    s_nop 1
    s_and_saveexec_b64 s[6:7], vcc
    s_cbranch_execz Lpcd
    global_load_dword v253, v253, s[98:99]
Lpcd:
    s_mov_b64 exec, -1
    s_and_b32 s6, s2, 7
    s_lshr_b32 s7, s2, 3
    s_and_b32 s98, s6, 0
    s_lshl_b32 s98, s98, 3
    s_and_b32 s99, s7, 7
    s_add_u32 s5, s98, s99
    s_lshr_b32 s6, s6, 0
    s_lshl_b32 s6, s6, 2
    s_lshr_b32 s7, s7, 3
    s_add_u32 s101, s6, s7
    s_lshr_b32 s6, s101, 1
    s_sub_u32 s7, 32, s6
    s_cmp_eq_u32 s6, 0
    s_cselect_b32 s7, 16, s7
    s_bitcmp1_b32 s101, 0
    s_cselect_b32 s4, s7, s6
    v_lshlrev_b32 v2, 4, v1
    v_and_b32 v8, 15, v1
    v_lshrrev_b32 v9, 4, v1
    v_and_b32 v10, 31, v1
    v_lshrrev_b32 v4, 5, v1
    v_lshrrev_b32 v246, 3, v1
    v_and_b32 v247, 7, v1
    v_xor_b32 v247, v247, v246
    v_lshlrev_b32 v247, 4, v247
    s_and_b32 s39, s3, 1
    s_lshr_b32 s40, s3, 2
    s_bfe_u32 s38, s3, 0x10001
    s_lshl_b32 s6, s39, 4
    s_lshl_b32 s7, s40, 5
    s_add_u32 s6, s6, s7
    s_lshl_b32 s7, s38, 2
    s_add_u32 s6, s6, s7
    v_lshrrev_b32 v240, 2, v246
    v_lshlrev_b32 v240, 3, v240
    v_and_b32 v0, 3, v246
    v_add3_u32 v240, v240, v0, s6
    v_lshl_add_u32 v240, v240, 5, s4
    s_movk_i32 s62, 1280
    v_mad_u32_u24 v240, v240, s62, v247
    s_lshl_b32 s54, s3, 10
    s_lshl_b32 s55, s5, 7
    s_waitcnt lgkmcnt(0)
    s_mov_b32 s56, s8
    s_and_b32 s57, s9, 0xffff
    s_mov_b32 s58, 0x280000
    s_mov_b32 s59, 0x20000
    s_add_u32 s99, s55, 0
    s_add_u32 m0, s54, 81920
    s_nop 0
    buffer_load_dwordx4 v240, s[56:59], s99 offen lds
    s_add_u32 s99, s55, 128
    s_add_u32 m0, s54, 90112
    s_nop 0
    buffer_load_dwordx4 v240, s[56:59], s99 offen lds
    s_add_u32 s99, s55, 256
    s_add_u32 m0, s54, 98304
    s_nop 0
    buffer_load_dwordx4 v240, s[56:59], s99 offen lds
    s_add_u32 s99, s55, 384
    s_cmp_ge_u32 s99, 1280
    s_cselect_b32 s18, 1280, 0
    s_sub_u32 s99, s99, s18
    s_add_u32 m0, s54, 106496
    s_nop 0
    buffer_load_dwordx4 v240, s[56:59], s99 offen lds
    s_mov_b32 s68, s20
    s_and_b32 s69, s21, 0xffff
    s_mov_b32 s70, 0x21c000
    s_mov_b32 s71, 0x20000
    s_mov_b32 s72, s22
    s_and_b32 s73, s23, 0xffff
    s_mov_b32 s74, 0x21c000
    s_mov_b32 s75, 0x20000
    s_mov_b32 s28, s26
    s_and_b32 s29, s27, 0xffff
    s_mov_b32 s30, 0x10000000
    s_mov_b32 s31, 0x20000
    s_mov_b32 s32, s24
    s_and_b32 s33, s25, 0xffff
    s_mov_b32 s34, 0x280000
    s_mov_b32 s35, 0x20000
    s_add_u32 s99, s55, 512
    s_cmp_ge_u32 s99, 1280
    s_cselect_b32 s18, 1280, 0
    s_sub_u32 s99, s99, s18
    s_add_u32 m0, s54, 114688
    s_nop 0
    buffer_load_dwordx4 v240, s[56:59], s99 offen lds
    s_add_u32 s99, s55, 640
    s_cmp_ge_u32 s99, 1280
    s_cselect_b32 s18, 1280, 0
    s_sub_u32 s99, s99, s18
    s_add_u32 m0, s54, 122880
    s_nop 0
    buffer_load_dwordx4 v240, s[56:59], s99 offen lds
    s_add_u32 s99, s55, 768
    s_cmp_ge_u32 s99, 1280
    s_cselect_b32 s18, 1280, 0
    s_sub_u32 s99, s99, s18
    s_add_u32 m0, s54, 131072
    s_nop 0
    buffer_load_dwordx4 v240, s[56:59], s99 offen lds
    s_add_u32 s99, s55, 896
    s_cmp_ge_u32 s99, 1280
    s_cselect_b32 s18, 1280, 0
    s_sub_u32 s99, s99, s18
    s_add_u32 m0, s54, 139264
    s_nop 0
    buffer_load_dwordx4 v240, s[56:59], s99 offen lds
    s_add_u32 s99, s55, 1024
    s_cmp_ge_u32 s99, 1280
    s_cselect_b32 s18, 1280, 0
    s_sub_u32 s99, s99, s18
    s_add_u32 m0, s54, 147456
    s_nop 0
    buffer_load_dwordx4 v240, s[56:59], s99 offen lds
    s_add_u32 s99, s55, 1152
    s_cmp_ge_u32 s99, 1280
    s_cselect_b32 s18, 1280, 0
    s_sub_u32 s99, s99, s18
    s_add_u32 m0, s54, 155648
    s_nop 0
    buffer_load_dwordx4 v240, s[56:59], s99 offen lds
    s_mov_b32 s62, 0x7a0000
    buffer_load_dword v252, off, s[28:31], s62 sc1
    s_sub_u32 s6, 64, s4
    s_cmp_eq_u32 s4, 0
    s_cselect_b32 s51, 32, s6
    s_mul_i32 s6, s5, 7
    s_min_u32 s100, s6, 48
    s_lshl_b32 s6, s100, 1
    s_lshl_b32 s7, s3, 1
    s_add_u32 s42, s6, s7
    s_min_u32 s42, s42, 106
    s_cmp_lt_u32 s5, 6
    s_cselect_b32 s43, 7, 6
    s_mul_i32 s44, s4, 81920
    s_lshl_b32 s6, s4, 3
    s_add_u32 s7, s6, s5
    s_lshl_b32 s7, s7, 3
    s_add_u32 s7, s7, s3
    s_lshl_b32 s7, s7, 7
    s_add_u32 s45, s7, 0x760000
    s_add_u32 s7, s6, s3
    s_lshl_b32 s50, s7, 10
    s_sub_u32 s52, 32, s4
    s_and_b32 s52, s52, 31
    s_lshl_b32 s7, s52, 3
    s_add_u32 s7, s7, s3
    s_lshl_b32 s53, s7, 10
    s_mul_i32 s46, s42, 20480
    s_cmp_ge_u32 s3, s43
    s_cselect_b32 s46, 0x7f000000, s46
    s_getreg_b32 s27, hwreg(HW_REG_XCC_ID)
    s_and_b32 s27, s27, 15
    s_mul_i32 s49, s4, 221184
    s_mul_i32 s48, s5, 276480
    s_add_u32 s48, s48, 0x220000
    v_lshlrev_b32 v3, 4, v8
    v_lshl_add_u32 v3, v9, 10, v3
    v_and_b32 v244, 7, v1
    v_xor_b32 v244, v244, v9
    v_lshlrev_b32 v244, 4, v244
    v_lshl_add_u32 v244, v8, 7, v244
    v_xor_b32 v245, 64, v244
    v_mov_b32 v0, 0
    ds_write_b32 v0, v0 offset:512
    s_cmp_eq_u32 s3, 7
    s_cbranch_scc1 Lp0c_2
    s_cmp_ge_u32 s3, 5
    s_cbranch_scc1 Lp0s_1
    v_mov_b32 v208, 0x3f803f80
    v_mov_b32 v209, 0x3f803f80
    v_mov_b32 v210, 0x3f803f80
    v_mov_b32 v211, 0x3f803f80
    s_mul_i32 s6, s5, 40
    s_min_u32 s7, s3, 4
    s_lshl_b32 s7, s7, 3
    s_add_u32 s6, s6, s7
    v_and_b32 v200, 7, v1
    v_add_u32 v200, s6, v200
    v_mov_b32 v0, 320
    v_cmp_eq_u32 vcc, 0, v200
    s_nop 1
    v_cndmask_b32 v200, v200, v0, vcc
    s_lshr_b32 s6, s55, 1
    v_lshl_add_u32 v201, v9, 3, s6
    v_mul_u32_u24 v201, v200, v201
    v_mov_b32 v11, 160
    v_cmp_gt_u32 vcc, 8, v8
    s_nop 1
    v_cndmask_b32 v0, v0, v11, vcc
    v_add_u32 v201, v201, v0
    s_mov_b32 s7, 0x666667
    v_mul_hi_u32 v0, v201, s7
    v_mul_u32_u24 v0, 640, v0
    v_sub_u32 v201, v201, v0
    v_cvt_f32_i32 v201, v201
    v_cvt_f32_u32 v200, v200
    v_mul_f32 v201, 0x3acccccd, v201
    v_mul_f32 v200, 0x3acccccd, v200
    v_fmamk_f32 v192, v200, 0x00000000, v201
    v_fmamk_f32 v193, v200, 0x3f800000, v201
    v_fmamk_f32 v194, v200, 0x40000000, v201
    v_fmamk_f32 v195, v200, 0x40400000, v201
    v_fmamk_f32 v196, v200, 0x40800000, v201
    v_fmamk_f32 v197, v200, 0x40a00000, v201
    v_fmamk_f32 v198, v200, 0x40c00000, v201
    v_fmamk_f32 v199, v200, 0x40e00000, v201
    v_sin_f32 v192, v192
    v_sin_f32 v193, v193
    v_sin_f32 v194, v194
    v_sin_f32 v195, v195
    v_sin_f32 v196, v196
    v_sin_f32 v197, v197
    v_sin_f32 v198, v198
    v_sin_f32 v199, v199
    v_cvt_pk_bf16_f32 v112, v192, v193
    v_cvt_pk_bf16_f32 v113, v194, v195
    v_cvt_pk_bf16_f32 v114, v196, v197
    v_cvt_pk_bf16_f32 v115, v198, v199
    v_fmamk_f32 v192, v200, 0x42000000, v201
    v_fmamk_f32 v193, v200, 0x42040000, v201
    v_fmamk_f32 v194, v200, 0x42080000, v201
    v_fmamk_f32 v195, v200, 0x420c0000, v201
    v_fmamk_f32 v196, v200, 0x42100000, v201
    v_fmamk_f32 v197, v200, 0x42140000, v201
    v_fmamk_f32 v198, v200, 0x42180000, v201
    v_fmamk_f32 v199, v200, 0x421c0000, v201
    v_sin_f32 v192, v192
    v_sin_f32 v193, v193
    v_sin_f32 v194, v194
    v_sin_f32 v195, v195
    v_sin_f32 v196, v196
    v_sin_f32 v197, v197
    v_sin_f32 v198, v198
    v_sin_f32 v199, v199
    v_cvt_pk_bf16_f32 v116, v192, v193
    v_cvt_pk_bf16_f32 v117, v194, v195
    v_cvt_pk_bf16_f32 v118, v196, v197
    v_cvt_pk_bf16_f32 v119, v198, v199
    v_fmamk_f32 v192, v200, 0x42800000, v201
    v_fmamk_f32 v193, v200, 0x42820000, v201
    v_fmamk_f32 v194, v200, 0x42840000, v201
    v_fmamk_f32 v195, v200, 0x42860000, v201
    v_fmamk_f32 v196, v200, 0x42880000, v201
    v_fmamk_f32 v197, v200, 0x428a0000, v201
    v_fmamk_f32 v198, v200, 0x428c0000, v201
    v_fmamk_f32 v199, v200, 0x428e0000, v201
    v_sin_f32 v192, v192
    v_sin_f32 v193, v193
    v_sin_f32 v194, v194
    v_sin_f32 v195, v195
    v_sin_f32 v196, v196
    v_sin_f32 v197, v197
    v_sin_f32 v198, v198
    v_sin_f32 v199, v199
    v_cvt_pk_bf16_f32 v120, v192, v193
    v_cvt_pk_bf16_f32 v121, v194, v195
    v_cvt_pk_bf16_f32 v122, v196, v197
    v_cvt_pk_bf16_f32 v123, v198, v199
    v_fmamk_f32 v192, v200, 0x42c00000, v201
    v_fmamk_f32 v193, v200, 0x42c20000, v201
    v_fmamk_f32 v194, v200, 0x42c40000, v201
    v_fmamk_f32 v195, v200, 0x42c60000, v201
    v_fmamk_f32 v196, v200, 0x42c80000, v201
    v_fmamk_f32 v197, v200, 0x42ca0000, v201
    v_fmamk_f32 v198, v200, 0x42cc0000, v201
    v_fmamk_f32 v199, v200, 0x42ce0000, v201
    v_sin_f32 v192, v192
    v_sin_f32 v193, v193
    v_sin_f32 v194, v194
    v_sin_f32 v195, v195
    v_sin_f32 v196, v196
    v_sin_f32 v197, v197
    v_sin_f32 v198, v198
    v_sin_f32 v199, v199
    v_cvt_pk_bf16_f32 v124, v192, v193
    v_cvt_pk_bf16_f32 v125, v194, v195
    v_cvt_pk_bf16_f32 v126, v196, v197
    v_cvt_pk_bf16_f32 v127, v198, v199
    v_fmamk_f32 v192, v200, 0x43000000, v201
    v_fmamk_f32 v193, v200, 0x43010000, v201
    v_fmamk_f32 v194, v200, 0x43020000, v201
    v_fmamk_f32 v195, v200, 0x43030000, v201
    v_fmamk_f32 v196, v200, 0x43040000, v201
    v_fmamk_f32 v197, v200, 0x43050000, v201
    v_fmamk_f32 v198, v200, 0x43060000, v201
    v_fmamk_f32 v199, v200, 0x43070000, v201
    v_sin_f32 v192, v192
    v_sin_f32 v193, v193
    v_sin_f32 v194, v194
    v_sin_f32 v195, v195
    v_sin_f32 v196, v196
    v_sin_f32 v197, v197
    v_sin_f32 v198, v198
    v_sin_f32 v199, v199
    v_cvt_pk_bf16_f32 v128, v192, v193
    v_cvt_pk_bf16_f32 v129, v194, v195
    v_cvt_pk_bf16_f32 v130, v196, v197
    v_cvt_pk_bf16_f32 v131, v198, v199
    v_mov_b32 v13, 0x80008000
    v_lshrrev_b32 v0, 1, v1
    v_lshrrev_b32 v12, 3, v1
    v_and_b32 v12, v12, v1
    v_xor_b32 v0, v0, v12
    v_and_b32 v0, 1, v0
    v_cmp_eq_u32 vcc, 1, v0
    s_nop 1
    v_cndmask_b32 v12, 0, v13, vcc
    v_and_b32 v0, 1, v1
    v_cmp_eq_u32 vcc, 1, v0
    s_nop 1
    v_cndmask_b32 v200, 0, v13, vcc
    v_xor_b32 v132, v112, v12
    v_xor_b32 v133, v113, v12
    v_xor_b32 v134, v114, v12
    v_xor_b32 v135, v115, v12
    v_xor_b32 v136, v116, v12
    v_xor_b32 v137, v117, v12
    v_xor_b32 v138, v118, v12
    v_xor_b32 v139, v119, v12
    v_xor_b32 v140, v120, v12
    v_xor_b32 v141, v121, v12
    v_xor_b32 v142, v122, v12
    v_xor_b32 v143, v123, v12
    v_xor_b32 v144, v124, v12
    v_xor_b32 v145, v125, v12
    v_xor_b32 v146, v126, v12
    v_xor_b32 v147, v127, v12
    v_xor_b32 v148, v128, v12
    v_xor_b32 v149, v129, v12
    v_xor_b32 v150, v130, v12
    v_xor_b32 v151, v131, v12
    s_mov_b64 exec, vcc
    s_nop 4
    v_xor_b32_dpp v132, v112, v12 row_ror:8 row_mask:0xf bank_mask:0xf
    v_xor_b32_dpp v133, v113, v12 row_ror:8 row_mask:0xf bank_mask:0xf
    v_xor_b32_dpp v134, v114, v12 row_ror:8 row_mask:0xf bank_mask:0xf
    v_xor_b32_dpp v135, v115, v12 row_ror:8 row_mask:0xf bank_mask:0xf
    v_xor_b32_dpp v136, v116, v12 row_ror:8 row_mask:0xf bank_mask:0xf
    v_xor_b32_dpp v137, v117, v12 row_ror:8 row_mask:0xf bank_mask:0xf
    v_xor_b32_dpp v138, v118, v12 row_ror:8 row_mask:0xf bank_mask:0xf
    v_xor_b32_dpp v139, v119, v12 row_ror:8 row_mask:0xf bank_mask:0xf
    v_xor_b32_dpp v140, v120, v12 row_ror:8 row_mask:0xf bank_mask:0xf
    v_xor_b32_dpp v141, v121, v12 row_ror:8 row_mask:0xf bank_mask:0xf
    v_xor_b32_dpp v142, v122, v12 row_ror:8 row_mask:0xf bank_mask:0xf
    v_xor_b32_dpp v143, v123, v12 row_ror:8 row_mask:0xf bank_mask:0xf
    v_xor_b32_dpp v144, v124, v12 row_ror:8 row_mask:0xf bank_mask:0xf
    v_xor_b32_dpp v145, v125, v12 row_ror:8 row_mask:0xf bank_mask:0xf
    v_xor_b32_dpp v146, v126, v12 row_ror:8 row_mask:0xf bank_mask:0xf
    v_xor_b32_dpp v147, v127, v12 row_ror:8 row_mask:0xf bank_mask:0xf
    v_xor_b32_dpp v148, v128, v12 row_ror:8 row_mask:0xf bank_mask:0xf
    v_xor_b32_dpp v149, v129, v12 row_ror:8 row_mask:0xf bank_mask:0xf
    v_xor_b32_dpp v150, v130, v12 row_ror:8 row_mask:0xf bank_mask:0xf
    v_xor_b32_dpp v151, v131, v12 row_ror:8 row_mask:0xf bank_mask:0xf
    s_mov_b64 exec, -1
    v_mfma_f32_16x16x32_bf16 v[212:215], v[208:211], v[112:115], 0
    v_mfma_f32_16x16x32_bf16 v[212:215], v[208:211], v[116:119], v[212:215]
    v_mfma_f32_16x16x32_bf16 v[212:215], v[208:211], v[120:123], v[212:215]
    v_mfma_f32_16x16x32_bf16 v[212:215], v[208:211], v[124:127], v[212:215]
    v_mfma_f32_16x16x32_bf16 v[212:215], v[208:211], v[128:131], v[212:215]
    v_mfma_f32_16x16x32_bf16 v[212:215], v[208:211], v[132:135], v[212:215]
    v_mfma_f32_16x16x32_bf16 v[212:215], v[208:211], v[136:139], v[212:215]
    v_mfma_f32_16x16x32_bf16 v[212:215], v[208:211], v[140:143], v[212:215]
    v_mfma_f32_16x16x32_bf16 v[212:215], v[208:211], v[144:147], v[212:215]
    v_mfma_f32_16x16x32_bf16 v[212:215], v[208:211], v[148:151], v[212:215]
    v_add_u32 v248, 81920, v244
    v_add_u32 v249, 81920, v245
    v_and_b32 v243, 1, v1
    v_lshlrev_b32 v243, 31, v243
    v_or_b32 v243, 1.0, v243
    s_nop 2
    v_fma_f32 v14, v212, v243, v212
    s_cmp_lt_u32 s3, 4
    s_cbranch_scc1 Lp_4
    s_setprio 1
Lp_4:
    v_add_u32 v250, 40960, v248
    v_add_u32 v251, 40960, v249
    s_waitcnt vmcnt(7) lgkmcnt(0)
    s_barrier
    ds_read_b128 v[32:35], v248 offset:0
    ds_read_b128 v[36:39], v248 offset:2048
    ds_read_b128 v[40:43], v248 offset:4096
    ds_read_b128 v[44:47], v248 offset:6144
    ds_read_b128 v[48:51], v249 offset:0
    ds_read_b128 v[52:55], v249 offset:2048
    ds_read_b128 v[56:59], v249 offset:4096
    ds_read_b128 v[60:63], v249 offset:6144
    ds_read_b128 v[64:67], v248 offset:8192
    ds_read_b128 v[68:71], v248 offset:10240
    ds_read_b128 v[72:75], v248 offset:12288
    ds_read_b128 v[76:79], v248 offset:14336
    s_waitcnt lgkmcnt(8)
    v_mfma_f32_16x16x32_bf16 v[16:19], v[32:35], v[112:115], 0
    ds_read_b128 v[80:83], v249 offset:8192
    v_mfma_f32_16x16x32_bf16 v[20:23], v[36:39], v[112:115], 0
    ds_read_b128 v[84:87], v249 offset:10240
    v_mfma_f32_16x16x32_bf16 v[24:27], v[40:43], v[112:115], 0
    ds_read_b128 v[88:91], v249 offset:12288
    v_mfma_f32_16x16x32_bf16 v[28:31], v[44:47], v[112:115], 0
    ds_read_b128 v[92:95], v249 offset:14336
    s_waitcnt lgkmcnt(8)
    v_mfma_f32_16x16x32_bf16 v[16:19], v[48:51], v[116:119], v[16:19]
    ds_read_b128 v[32:35], v248 offset:16384
    v_mfma_f32_16x16x32_bf16 v[20:23], v[52:55], v[116:119], v[20:23]
    ds_read_b128 v[36:39], v248 offset:18432
    v_mfma_f32_16x16x32_bf16 v[24:27], v[56:59], v[116:119], v[24:27]
    ds_read_b128 v[40:43], v248 offset:20480
    v_mfma_f32_16x16x32_bf16 v[28:31], v[60:63], v[116:119], v[28:31]
    ds_read_b128 v[44:47], v248 offset:22528
    s_waitcnt vmcnt(1)
    v_mov_b32 v5, 0
    v_mov_b32 v0, 1
    s_mov_b64 exec, 1
    ds_add_u32 v5, v0 offset:512
    s_mov_b64 exec, -1
    v_mov_b32 v0, 0
    v_lshlrev_b32 v5, 2, v1
    s_mov_b32 exec_hi, 0
    buffer_store_dword v0, v5, s[28:31], s45 offen sc1
    s_add_u32 s62, s45, 0x80000
    buffer_load_dword v254, v5, s[28:31], s62 offen sc1
    s_mov_b32 exec_hi, -1
    s_waitcnt lgkmcnt(9)
    v_mfma_f32_16x16x32_bf16 v[16:19], v[64:67], v[120:123], v[16:19]
    ds_read_b128 v[48:51], v249 offset:16384
    v_mfma_f32_16x16x32_bf16 v[20:23], v[68:71], v[120:123], v[20:23]
    ds_read_b128 v[52:55], v249 offset:18432
    v_mfma_f32_16x16x32_bf16 v[24:27], v[72:75], v[120:123], v[24:27]
    ds_read_b128 v[56:59], v249 offset:20480
    v_mfma_f32_16x16x32_bf16 v[28:31], v[76:79], v[120:123], v[28:31]
    ds_read_b128 v[60:63], v249 offset:22528
    s_waitcnt lgkmcnt(9)
    v_mfma_f32_16x16x32_bf16 v[16:19], v[80:83], v[124:127], v[16:19]
    ds_read_b128 v[64:67], v248 offset:24576
    v_mfma_f32_16x16x32_bf16 v[20:23], v[84:87], v[124:127], v[20:23]
    ds_read_b128 v[68:71], v248 offset:26624
    v_mfma_f32_16x16x32_bf16 v[24:27], v[88:91], v[124:127], v[24:27]
    ds_read_b128 v[72:75], v248 offset:28672
    v_mfma_f32_16x16x32_bf16 v[28:31], v[92:95], v[124:127], v[28:31]
    ds_read_b128 v[76:79], v248 offset:30720
    s_waitcnt lgkmcnt(9)
    v_mfma_f32_16x16x32_bf16 v[16:19], v[32:35], v[128:131], v[16:19]
    ds_read_b128 v[80:83], v249 offset:24576
    v_mfma_f32_16x16x32_bf16 v[20:23], v[36:39], v[128:131], v[20:23]
    ds_read_b128 v[84:87], v249 offset:26624
    v_mfma_f32_16x16x32_bf16 v[24:27], v[40:43], v[128:131], v[24:27]
    ds_read_b128 v[88:91], v249 offset:28672
    v_mfma_f32_16x16x32_bf16 v[28:31], v[44:47], v[128:131], v[28:31]
    ds_read_b128 v[92:95], v249 offset:30720
    s_mov_b32 s61, 0
Lcw_5:
    v_mov_b32 v5, 0
    ds_read_b32 v5, v5 offset:512
    s_waitcnt lgkmcnt(0)
    v_cmp_gt_u32 vcc, 8, v5
    s_cbranch_vccz Lcd_6
    s_sleep 1
    s_add_u32 s61, s61, 1
    s_cmp_lt_u32 s61, 200000
    s_cbranch_scc1 Lcw_5
Lcd_6:
    v_mfma_f32_16x16x32_bf16 v[16:19], v[48:51], v[132:135], v[16:19]
    ds_read_b128 v[32:35], v248 offset:32768
    v_mfma_f32_16x16x32_bf16 v[20:23], v[52:55], v[132:135], v[20:23]
    ds_read_b128 v[36:39], v248 offset:34816
    v_mfma_f32_16x16x32_bf16 v[24:27], v[56:59], v[132:135], v[24:27]
    ds_read_b128 v[40:43], v248 offset:36864
    v_mfma_f32_16x16x32_bf16 v[28:31], v[60:63], v[132:135], v[28:31]
    ds_read_b128 v[44:47], v248 offset:38912
    v_mfma_f32_16x16x32_bf16 v[16:19], v[64:67], v[136:139], v[16:19]
    ds_read_b128 v[48:51], v249 offset:32768
    v_mfma_f32_16x16x32_bf16 v[20:23], v[68:71], v[136:139], v[20:23]
    ds_read_b128 v[52:55], v249 offset:34816
    v_mfma_f32_16x16x32_bf16 v[24:27], v[72:75], v[136:139], v[24:27]
    ds_read_b128 v[56:59], v249 offset:36864
    v_mfma_f32_16x16x32_bf16 v[28:31], v[76:79], v[136:139], v[28:31]
    ds_read_b128 v[60:63], v249 offset:38912
    v_mfma_f32_16x16x32_bf16 v[16:19], v[80:83], v[140:143], v[16:19]
    ds_read_b128 v[64:67], v250 offset:0
    v_mfma_f32_16x16x32_bf16 v[20:23], v[84:87], v[140:143], v[20:23]
    ds_read_b128 v[68:71], v250 offset:2048
    v_mfma_f32_16x16x32_bf16 v[24:27], v[88:91], v[140:143], v[24:27]
    ds_read_b128 v[72:75], v250 offset:4096
    v_mfma_f32_16x16x32_bf16 v[28:31], v[92:95], v[140:143], v[28:31]
    ds_read_b128 v[76:79], v250 offset:6144
    s_waitcnt lgkmcnt(8)
    v_mfma_f32_16x16x32_bf16 v[16:19], v[32:35], v[144:147], v[16:19]
    ds_read_b128 v[80:83], v251 offset:0
    v_mfma_f32_16x16x32_bf16 v[20:23], v[36:39], v[144:147], v[20:23]
    ds_read_b128 v[84:87], v251 offset:2048
    v_mfma_f32_16x16x32_bf16 v[24:27], v[40:43], v[144:147], v[24:27]
    ds_read_b128 v[88:91], v251 offset:4096
    v_mfma_f32_16x16x32_bf16 v[28:31], v[44:47], v[144:147], v[28:31]
    ds_read_b128 v[92:95], v251 offset:6144
    s_waitcnt lgkmcnt(8)
    v_mfma_f32_16x16x32_bf16 v[16:19], v[48:51], v[148:151], v[16:19]
    ds_read_b128 v[32:35], v250 offset:8192
    v_mfma_f32_16x16x32_bf16 v[20:23], v[52:55], v[148:151], v[20:23]
    ds_read_b128 v[36:39], v250 offset:10240
    v_mfma_f32_16x16x32_bf16 v[24:27], v[56:59], v[148:151], v[24:27]
    ds_read_b128 v[40:43], v250 offset:12288
    v_mfma_f32_16x16x32_bf16 v[28:31], v[60:63], v[148:151], v[28:31]
    ds_read_b128 v[44:47], v250 offset:14336
    s_waitcnt lgkmcnt(8)
    v_mfma_f32_16x16x32_bf16 v[96:99], v[64:67], v[112:115], 0
    ds_read_b128 v[48:51], v251 offset:8192
    v_mfma_f32_16x16x32_bf16 v[100:103], v[68:71], v[112:115], 0
    ds_read_b128 v[52:55], v251 offset:10240
    v_mfma_f32_16x16x32_bf16 v[104:107], v[72:75], v[112:115], 0
    ds_read_b128 v[56:59], v251 offset:12288
    v_mfma_f32_16x16x32_bf16 v[108:111], v[76:79], v[112:115], 0
    ds_read_b128 v[60:63], v251 offset:14336
    s_waitcnt lgkmcnt(8)
    v_mfma_f32_16x16x32_bf16 v[96:99], v[80:83], v[116:119], v[96:99]
    ds_read_b128 v[64:67], v250 offset:16384
    v_mfma_f32_16x16x32_bf16 v[100:103], v[84:87], v[116:119], v[100:103]
    ds_read_b128 v[68:71], v250 offset:18432
    v_mfma_f32_16x16x32_bf16 v[104:107], v[88:91], v[116:119], v[104:107]
    ds_read_b128 v[72:75], v250 offset:20480
    v_mfma_f32_16x16x32_bf16 v[108:111], v[92:95], v[116:119], v[108:111]
    ds_read_b128 v[76:79], v250 offset:22528
    s_waitcnt lgkmcnt(8)
    v_mfma_f32_16x16x32_bf16 v[96:99], v[32:35], v[120:123], v[96:99]
    ds_read_b128 v[80:83], v251 offset:16384
    v_mfma_f32_16x16x32_bf16 v[100:103], v[36:39], v[120:123], v[100:103]
    ds_read_b128 v[84:87], v251 offset:18432
    v_mfma_f32_16x16x32_bf16 v[104:107], v[40:43], v[120:123], v[104:107]
    ds_read_b128 v[88:91], v251 offset:20480
    v_mfma_f32_16x16x32_bf16 v[108:111], v[44:47], v[120:123], v[108:111]
    ds_read_b128 v[92:95], v251 offset:22528
    s_waitcnt lgkmcnt(8)
    v_mfma_f32_16x16x32_bf16 v[96:99], v[48:51], v[124:127], v[96:99]
    ds_read_b128 v[32:35], v250 offset:24576
    v_mfma_f32_16x16x32_bf16 v[100:103], v[52:55], v[124:127], v[100:103]
    ds_read_b128 v[36:39], v250 offset:26624
    v_mfma_f32_16x16x32_bf16 v[104:107], v[56:59], v[124:127], v[104:107]
    ds_read_b128 v[40:43], v250 offset:28672
    v_mfma_f32_16x16x32_bf16 v[108:111], v[60:63], v[124:127], v[108:111]
    ds_read_b128 v[44:47], v250 offset:30720
    s_waitcnt lgkmcnt(8)
    v_mfma_f32_16x16x32_bf16 v[96:99], v[64:67], v[128:131], v[96:99]
    ds_read_b128 v[48:51], v251 offset:24576
    v_mfma_f32_16x16x32_bf16 v[100:103], v[68:71], v[128:131], v[100:103]
    ds_read_b128 v[52:55], v251 offset:26624
    v_mfma_f32_16x16x32_bf16 v[104:107], v[72:75], v[128:131], v[104:107]
    ds_read_b128 v[56:59], v251 offset:28672
    v_mfma_f32_16x16x32_bf16 v[108:111], v[76:79], v[128:131], v[108:111]
    ds_read_b128 v[60:63], v251 offset:30720
    s_waitcnt lgkmcnt(8)
    v_mfma_f32_16x16x32_bf16 v[96:99], v[80:83], v[132:135], v[96:99]
    ds_read_b128 v[64:67], v250 offset:32768
    v_mfma_f32_16x16x32_bf16 v[100:103], v[84:87], v[132:135], v[100:103]
    ds_read_b128 v[68:71], v250 offset:34816
    v_mfma_f32_16x16x32_bf16 v[104:107], v[88:91], v[132:135], v[104:107]
    ds_read_b128 v[72:75], v250 offset:36864
    v_mfma_f32_16x16x32_bf16 v[108:111], v[92:95], v[132:135], v[108:111]
    ds_read_b128 v[76:79], v250 offset:38912
    s_waitcnt lgkmcnt(8)
    v_mfma_f32_16x16x32_bf16 v[96:99], v[32:35], v[136:139], v[96:99]
    ds_read_b128 v[80:83], v251 offset:32768
    v_mfma_f32_16x16x32_bf16 v[100:103], v[36:39], v[136:139], v[100:103]
    ds_read_b128 v[84:87], v251 offset:34816
    v_mfma_f32_16x16x32_bf16 v[104:107], v[40:43], v[136:139], v[104:107]
    ds_read_b128 v[88:91], v251 offset:36864
    v_mfma_f32_16x16x32_bf16 v[108:111], v[44:47], v[136:139], v[108:111]
    ds_read_b128 v[92:95], v251 offset:38912
    s_waitcnt lgkmcnt(8)
    v_mfma_f32_16x16x32_bf16 v[96:99], v[48:51], v[140:143], v[96:99]
    v_mfma_f32_16x16x32_bf16 v[100:103], v[52:55], v[140:143], v[100:103]
    v_mfma_f32_16x16x32_bf16 v[104:107], v[56:59], v[140:143], v[104:107]
    v_mfma_f32_16x16x32_bf16 v[108:111], v[60:63], v[140:143], v[108:111]
    s_waitcnt lgkmcnt(4)
    v_mfma_f32_16x16x32_bf16 v[96:99], v[64:67], v[144:147], v[96:99]
    v_mfma_f32_16x16x32_bf16 v[100:103], v[68:71], v[144:147], v[100:103]
    v_mfma_f32_16x16x32_bf16 v[104:107], v[72:75], v[144:147], v[104:107]
    v_mfma_f32_16x16x32_bf16 v[108:111], v[76:79], v[144:147], v[108:111]
    s_waitcnt lgkmcnt(0)
    v_mfma_f32_16x16x32_bf16 v[96:99], v[80:83], v[148:151], v[96:99]
    v_mfma_f32_16x16x32_bf16 v[100:103], v[84:87], v[148:151], v[100:103]
    v_mfma_f32_16x16x32_bf16 v[104:107], v[88:91], v[148:151], v[104:107]
    v_mfma_f32_16x16x32_bf16 v[108:111], v[92:95], v[148:151], v[108:111]
    s_waitcnt vmcnt(2)
    v_readfirstlane_b32 s41, v252
    s_nop 1
    s_add_u32 s41, s41, 16
    s_and_b32 s41, s41, -16
    s_bitset1_b32 s41, 31
    ds_read_b128 v[32:35], v2 offset:1024
    ds_read_b128 v[64:67], v2 offset:9216
    ds_read_b128 v[36:39], v2 offset:2048
    ds_read_b128 v[68:71], v2 offset:10240
    ds_read_b128 v[40:43], v2 offset:3072
    ds_read_b128 v[72:75], v2 offset:11264
    ds_read_b128 v[44:47], v2 offset:4096
    ds_read_b128 v[76:79], v2 offset:12288
    ds_read_b128 v[48:51], v2 offset:5120
    ds_read_b128 v[80:83], v2 offset:13312
    ds_read_b128 v[52:55], v2 offset:6144
    ds_read_b128 v[84:87], v2 offset:14336
    ds_read_b128 v[56:59], v2 offset:7168
    ds_read_b128 v[88:91], v2 offset:15360
    ds_read_b128 v[60:63], v2 offset:8192
    ds_read_b128 v[92:95], v2 offset:16384
    v_fma_f32 v16, v96, v243, v16
    v_fma_f32 v17, v97, v243, v17
    v_fma_f32 v18, v98, v243, v18
    v_fma_f32 v19, v99, v243, v19
    v_fma_f32 v20, v100, v243, v20
    v_fma_f32 v21, v101, v243, v21
    v_fma_f32 v22, v102, v243, v22
    v_fma_f32 v23, v103, v243, v23
    v_fma_f32 v24, v104, v243, v24
    v_fma_f32 v25, v105, v243, v25
    v_fma_f32 v26, v106, v243, v26
    v_fma_f32 v27, v107, v243, v27
    v_fma_f32 v28, v108, v243, v28
    v_fma_f32 v29, v109, v243, v29
    v_fma_f32 v30, v110, v243, v30
    v_fma_f32 v31, v111, v243, v31
    v_lshlrev_b32 v12, 4, v9
    s_barrier
    ds_read_b128 v[192:195], v12 offset:0
    ds_read_b128 v[208:211], v12 offset:256
    ds_read_b128 v[196:199], v12 offset:64
    ds_read_b128 v[212:215], v12 offset:320
    ds_read_b128 v[200:203], v12 offset:128
    ds_read_b128 v[216:219], v12 offset:384
    ds_read_b128 v[204:207], v12 offset:192
    ds_read_b128 v[220:223], v12 offset:448
    v_cmp_gt_u32 vcc, 8, v8
    v_mov_b32 v13, 0x80008000
    s_nop 0
    v_cndmask_b32 v13, 0, v13, vcc
    v_and_b32 v12, 1, v9
    v_lshl_add_u32 v12, v12, 4, v8
    v_mul_u32_u24 v12, 192, v12
    v_lshrrev_b32 v11, 1, v9
    v_mul_u32_u24 v11, 80, v11
    s_lshl_b32 s6, s3, 4
    s_add_u32 s6, s6, 41984
    v_add3_u32 v12, v12, v11, s6
    s_waitcnt lgkmcnt(0)
    v_mul_f32 v208, v208, v14
    v_mul_f32 v209, v209, v14
    v_mul_f32 v210, v210, v14
    v_mul_f32 v211, v211, v14
    v_mul_f32 v212, v212, v14
    v_mul_f32 v213, v213, v14
    v_mul_f32 v214, v214, v14
    v_mul_f32 v215, v215, v14
    v_mul_f32 v216, v216, v14
    v_mul_f32 v217, v217, v14
    v_mul_f32 v218, v218, v14
    v_mul_f32 v219, v219, v14
    v_mul_f32 v220, v220, v14
    v_mul_f32 v221, v221, v14
    v_mul_f32 v222, v222, v14
    v_mul_f32 v223, v223, v14
    v_fma_f32 v16, v16, v192, -v208
    v_fma_f32 v17, v17, v193, -v209
    v_fma_f32 v18, v18, v194, -v210
    v_fma_f32 v19, v19, v195, -v211
    v_fma_f32 v20, v20, v196, -v212
    v_fma_f32 v21, v21, v197, -v213
    v_fma_f32 v22, v22, v198, -v214
    v_fma_f32 v23, v23, v199, -v215
    v_fma_f32 v24, v24, v200, -v216
    v_fma_f32 v25, v25, v201, -v217
    v_fma_f32 v26, v26, v202, -v218
    v_fma_f32 v27, v27, v203, -v219
    v_fma_f32 v28, v28, v204, -v220
    v_fma_f32 v29, v29, v205, -v221
    v_fma_f32 v30, v30, v206, -v222
    v_fma_f32 v31, v31, v207, -v223
    v_cvt_pk_bf16_f32 v16, v16, v17
    v_cvt_pk_bf16_f32 v17, v18, v19
    v_cvt_pk_bf16_f32 v18, v20, v21
    v_cvt_pk_bf16_f32 v19, v22, v23
    v_cvt_pk_bf16_f32 v20, v24, v25
    v_cvt_pk_bf16_f32 v21, v26, v27
    v_cvt_pk_bf16_f32 v22, v28, v29
    v_cvt_pk_bf16_f32 v23, v30, v31
    v_xor_b32_dpp v24, v16, v13 row_ror:8 row_mask:0xf bank_mask:0xf
    v_xor_b32_dpp v25, v17, v13 row_ror:8 row_mask:0xf bank_mask:0xf
    v_xor_b32_dpp v26, v18, v13 row_ror:8 row_mask:0xf bank_mask:0xf
    v_xor_b32_dpp v27, v19, v13 row_ror:8 row_mask:0xf bank_mask:0xf
    v_xor_b32_dpp v28, v20, v13 row_ror:8 row_mask:0xf bank_mask:0xf
    v_xor_b32_dpp v29, v21, v13 row_ror:8 row_mask:0xf bank_mask:0xf
    v_xor_b32_dpp v30, v22, v13 row_ror:8 row_mask:0xf bank_mask:0xf
    v_xor_b32_dpp v31, v23, v13 row_ror:8 row_mask:0xf bank_mask:0xf
    v_mfma_f32_16x16x32_bf16 v[96:99], v[16:19], v[32:35], 0
    v_mfma_f32_16x16x32_bf16 v[96:99], v[24:27], v[64:67], v[96:99]
    v_mfma_f32_16x16x32_bf16 v[96:99], v[20:23], v[36:39], v[96:99]
    v_mfma_f32_16x16x32_bf16 v[96:99], v[28:31], v[68:71], v[96:99]
    v_mfma_f32_16x16x32_bf16 v[100:103], v[16:19], v[40:43], 0
    v_mfma_f32_16x16x32_bf16 v[100:103], v[24:27], v[72:75], v[100:103]
    v_mfma_f32_16x16x32_bf16 v[100:103], v[20:23], v[44:47], v[100:103]
    v_mfma_f32_16x16x32_bf16 v[100:103], v[28:31], v[76:79], v[100:103]
    v_mfma_f32_16x16x32_bf16 v[104:107], v[16:19], v[48:51], 0
    v_mfma_f32_16x16x32_bf16 v[104:107], v[24:27], v[80:83], v[104:107]
    v_mfma_f32_16x16x32_bf16 v[104:107], v[20:23], v[52:55], v[104:107]
    v_mfma_f32_16x16x32_bf16 v[104:107], v[28:31], v[84:87], v[104:107]
    v_mfma_f32_16x16x32_bf16 v[108:111], v[16:19], v[56:59], 0
    v_mfma_f32_16x16x32_bf16 v[108:111], v[24:27], v[88:91], v[108:111]
    v_mfma_f32_16x16x32_bf16 v[108:111], v[20:23], v[60:63], v[108:111]
    v_mfma_f32_16x16x32_bf16 v[108:111], v[28:31], v[92:95], v[108:111]
    v_cvt_pk_bf16_f32 v96, v96, v97
    v_cvt_pk_bf16_f32 v97, v98, v99
    v_cvt_pk_bf16_f32 v98, v100, v101
    v_cvt_pk_bf16_f32 v99, v102, v103
    s_nop 0
    v_permlane16_swap_b32 v96, v98
    v_permlane16_swap_b32 v97, v99
    ds_write_b128 v12, v[96:99] offset:0
    v_cvt_pk_bf16_f32 v104, v104, v105
    v_cvt_pk_bf16_f32 v105, v106, v107
    v_cvt_pk_bf16_f32 v106, v108, v109
    v_cvt_pk_bf16_f32 v107, v110, v111
    s_nop 0
    v_permlane16_swap_b32 v104, v106
    v_permlane16_swap_b32 v105, v107
    ds_write_b128 v12, v[104:107] offset:6144
    s_branch Lp0j_3
Lp0s_1:
    v_mov_b32 v40, 0x3f803f80
    v_mov_b32 v41, 0x3f803f80
    v_mov_b32 v42, 0x3f803f80
    v_mov_b32 v43, 0x3f803f80
    s_sub_u32 s60, s3, 5
    s_lshl_b32 s60, s60, 12
    s_add_u32 s6, s60, 81920
    v_add_u32 v248, s6, v244
    v_add_u32 v249, s6, v245
    v_add_u32 v0, 0, v1
    v_mul_u32_u24 v7, 5462, v0
    v_lshrrev_b32 v7, 16, v7
    v_mul_u32_u24 v5, 12, v7
    v_sub_u32 v0, v0, v5
    s_mul_i32 s6, s5, 5
    s_sub_u32 s7, 70, s6
    v_add_u32 v5, s6, v0
    v_add_u32 v6, s7, v0
    v_cmp_le_u32 vcc, 5, v0
    s_nop 1
    v_cndmask_b32 v5, v5, v6, vcc
    v_cmp_eq_u32 vcc, 80, v5
    s_nop 1
    v_cndmask_b32 v5, v5, 0, vcc
    v_cmp_eq_u32 vcc, 11, v0
    s_nop 1
    v_cndmask_b32 v5, v5, 40, vcc
    v_mul_u32_u24 v7, 81920, v7
    v_lshl_add_u32 v120, v5, 4, v7
    v_add_u32 v0, 64, v1
    v_mul_u32_u24 v7, 5462, v0
    v_lshrrev_b32 v7, 16, v7
    v_mul_u32_u24 v5, 12, v7
    v_sub_u32 v0, v0, v5
    s_mul_i32 s6, s5, 5
    s_sub_u32 s7, 70, s6
    v_add_u32 v5, s6, v0
    v_add_u32 v6, s7, v0
    v_cmp_le_u32 vcc, 5, v0
    s_nop 1
    v_cndmask_b32 v5, v5, v6, vcc
    v_cmp_eq_u32 vcc, 80, v5
    s_nop 1
    v_cndmask_b32 v5, v5, 0, vcc
    v_cmp_eq_u32 vcc, 11, v0
    s_nop 1
    v_cndmask_b32 v5, v5, 40, vcc
    v_mul_u32_u24 v7, 81920, v7
    v_lshl_add_u32 v121, v5, 4, v7
    v_add_u32 v0, 128, v1
    v_mul_u32_u24 v7, 5462, v0
    v_lshrrev_b32 v7, 16, v7
    v_mul_u32_u24 v5, 12, v7
    v_sub_u32 v0, v0, v5
    s_mul_i32 s6, s5, 5
    s_sub_u32 s7, 70, s6
    v_add_u32 v5, s6, v0
    v_add_u32 v6, s7, v0
    v_cmp_le_u32 vcc, 5, v0
    s_nop 1
    v_cndmask_b32 v5, v5, v6, vcc
    v_cmp_eq_u32 vcc, 80, v5
    s_nop 1
    v_cndmask_b32 v5, v5, 0, vcc
    v_cmp_eq_u32 vcc, 11, v0
    s_nop 1
    v_cndmask_b32 v5, v5, 40, vcc
    v_mul_u32_u24 v7, 81920, v7
    v_lshl_add_u32 v122, v5, 4, v7
    s_cmp_eq_u32 s3, 6
    s_cselect_b32 s98, 0.5, 0x3e800000
    s_cselect_b32 s99, s51, s4
    s_lshl_b32 s6, s60, 1
    v_add_u32 v99, s6, v2
    v_lshlrev_b32 v98, 3, v9
    v_cvt_f32_u32 v98, v98
    v_and_b32 v13, 1, v1
    v_mul_u32_u24 v13, 0x10001, v13
    v_lshlrev_b32 v13, 15, v13
    v_add_u32 v96, 0, v8
    v_cvt_f32_u32 v96, v96
    v_mul_f32 v96, 0x3c800000, v96
    v_fma_f32 v97, v98, v96, s98
    v_fmamk_f32 v80, v96, 0x00000000, v97
    v_fmamk_f32 v81, v96, 0x3f800000, v97
    v_fmamk_f32 v82, v96, 0x40000000, v97
    v_fmamk_f32 v83, v96, 0x40400000, v97
    v_fmamk_f32 v84, v96, 0x40800000, v97
    v_fmamk_f32 v85, v96, 0x40a00000, v97
    v_fmamk_f32 v86, v96, 0x40c00000, v97
    v_fmamk_f32 v87, v96, 0x40e00000, v97
    v_sin_f32 v80, v80
    v_sin_f32 v81, v81
    v_sin_f32 v82, v82
    v_sin_f32 v83, v83
    v_sin_f32 v84, v84
    v_sin_f32 v85, v85
    v_sin_f32 v86, v86
    v_sin_f32 v87, v87
    v_cvt_pk_bf16_f32 v88, v80, v81
    v_cvt_pk_bf16_f32 v89, v82, v83
    v_cvt_pk_bf16_f32 v90, v84, v85
    v_cvt_pk_bf16_f32 v91, v86, v87
    v_xor_b32 v92, v88, v13
    v_xor_b32 v93, v89, v13
    v_xor_b32 v94, v90, v13
    v_xor_b32 v95, v91, v13
    ds_write_b128 v99, v[88:91] offset:1024
    ds_write_b128 v99, v[92:95] offset:2048
    v_add_u32 v96, 16, v8
    v_cvt_f32_u32 v96, v96
    v_mul_f32 v96, 0x3c800000, v96
    v_fma_f32 v97, v98, v96, s98
    v_fmamk_f32 v80, v96, 0x00000000, v97
    v_fmamk_f32 v81, v96, 0x3f800000, v97
    v_fmamk_f32 v82, v96, 0x40000000, v97
    v_fmamk_f32 v83, v96, 0x40400000, v97
    v_fmamk_f32 v84, v96, 0x40800000, v97
    v_fmamk_f32 v85, v96, 0x40a00000, v97
    v_fmamk_f32 v86, v96, 0x40c00000, v97
    v_fmamk_f32 v87, v96, 0x40e00000, v97
    v_sin_f32 v80, v80
    v_sin_f32 v81, v81
    v_sin_f32 v82, v82
    v_sin_f32 v83, v83
    v_sin_f32 v84, v84
    v_sin_f32 v85, v85
    v_sin_f32 v86, v86
    v_sin_f32 v87, v87
    v_cvt_pk_bf16_f32 v88, v80, v81
    v_cvt_pk_bf16_f32 v89, v82, v83
    v_cvt_pk_bf16_f32 v90, v84, v85
    v_cvt_pk_bf16_f32 v91, v86, v87
    v_xor_b32 v92, v88, v13
    v_xor_b32 v93, v89, v13
    v_xor_b32 v94, v90, v13
    v_xor_b32 v95, v91, v13
    ds_write_b128 v99, v[88:91] offset:3072
    ds_write_b128 v99, v[92:95] offset:4096
    v_add_u32 v96, 32, v8
    v_cvt_f32_u32 v96, v96
    v_mul_f32 v96, 0x3c800000, v96
    v_fma_f32 v97, v98, v96, s98
    v_fmamk_f32 v80, v96, 0x00000000, v97
    v_fmamk_f32 v81, v96, 0x3f800000, v97
    v_fmamk_f32 v82, v96, 0x40000000, v97
    v_fmamk_f32 v83, v96, 0x40400000, v97
    v_fmamk_f32 v84, v96, 0x40800000, v97
    v_fmamk_f32 v85, v96, 0x40a00000, v97
    v_fmamk_f32 v86, v96, 0x40c00000, v97
    v_fmamk_f32 v87, v96, 0x40e00000, v97
    v_sin_f32 v80, v80
    v_sin_f32 v81, v81
    v_sin_f32 v82, v82
    v_sin_f32 v83, v83
    v_sin_f32 v84, v84
    v_sin_f32 v85, v85
    v_sin_f32 v86, v86
    v_sin_f32 v87, v87
    v_cvt_pk_bf16_f32 v88, v80, v81
    v_cvt_pk_bf16_f32 v89, v82, v83
    v_cvt_pk_bf16_f32 v90, v84, v85
    v_cvt_pk_bf16_f32 v91, v86, v87
    v_xor_b32 v92, v88, v13
    v_xor_b32 v93, v89, v13
    v_xor_b32 v94, v90, v13
    v_xor_b32 v95, v91, v13
    ds_write_b128 v99, v[88:91] offset:5120
    ds_write_b128 v99, v[92:95] offset:6144
    v_add_u32 v96, 48, v8
    v_cvt_f32_u32 v96, v96
    v_mul_f32 v96, 0x3c800000, v96
    v_fma_f32 v97, v98, v96, s98
    v_fmamk_f32 v80, v96, 0x00000000, v97
    v_fmamk_f32 v81, v96, 0x3f800000, v97
    v_fmamk_f32 v82, v96, 0x40000000, v97
    v_fmamk_f32 v83, v96, 0x40400000, v97
    v_fmamk_f32 v84, v96, 0x40800000, v97
    v_fmamk_f32 v85, v96, 0x40a00000, v97
    v_fmamk_f32 v86, v96, 0x40c00000, v97
    v_fmamk_f32 v87, v96, 0x40e00000, v97
    v_sin_f32 v80, v80
    v_sin_f32 v81, v81
    v_sin_f32 v82, v82
    v_sin_f32 v83, v83
    v_sin_f32 v84, v84
    v_sin_f32 v85, v85
    v_sin_f32 v86, v86
    v_sin_f32 v87, v87
    v_cvt_pk_bf16_f32 v88, v80, v81
    v_cvt_pk_bf16_f32 v89, v82, v83
    v_cvt_pk_bf16_f32 v90, v84, v85
    v_cvt_pk_bf16_f32 v91, v86, v87
    v_xor_b32 v92, v88, v13
    v_xor_b32 v93, v89, v13
    v_xor_b32 v94, v90, v13
    v_xor_b32 v95, v91, v13
    ds_write_b128 v99, v[88:91] offset:7168
    ds_write_b128 v99, v[92:95] offset:8192
    s_setprio 2
    v_add_u32 v250, 40960, v248
    v_add_u32 v251, 40960, v249
    s_waitcnt vmcnt(7) lgkmcnt(0)
    s_barrier
    s_waitcnt vmcnt(1)
    v_mov_b32 v5, 0
    v_mov_b32 v0, 1
    s_mov_b64 exec, 1
    ds_add_u32 v5, v0 offset:512
    s_mov_b64 exec, -1
    v_mov_b32 v0, 0
    v_lshlrev_b32 v5, 2, v1
    s_mov_b32 exec_hi, 0
    buffer_store_dword v0, v5, s[28:31], s45 offen sc1
    s_add_u32 s62, s45, 0x80000
    buffer_load_dword v254, v5, s[28:31], s62 offen sc1
    s_mov_b32 exec_hi, -1
    ds_read_b128 v[44:47], v248 offset:0
    ds_read_b128 v[48:51], v248 offset:2048
    ds_read_b128 v[52:55], v249 offset:0
    ds_read_b128 v[56:59], v249 offset:2048
    ds_read_b128 v[60:63], v248 offset:8192
    ds_read_b128 v[64:67], v248 offset:10240
    s_waitcnt lgkmcnt(4)
    v_mfma_f32_16x16x32_bf16 v[24:27], v[44:47], v[44:47], 0
    ds_read_b128 v[68:71], v249 offset:8192
    v_mfma_f32_16x16x32_bf16 v[32:35], v[44:47], v[40:43], 0
    ds_read_b128 v[72:75], v249 offset:10240
    v_mfma_f32_16x16x32_bf16 v[28:31], v[48:51], v[48:51], 0
    v_mfma_f32_16x16x32_bf16 v[36:39], v[48:51], v[40:43], 0
    s_waitcnt lgkmcnt(4)
    v_mfma_f32_16x16x32_bf16 v[24:27], v[52:55], v[52:55], v[24:27]
    ds_read_b128 v[44:47], v248 offset:16384
    v_mfma_f32_16x16x32_bf16 v[32:35], v[52:55], v[40:43], v[32:35]
    ds_read_b128 v[48:51], v248 offset:18432
    v_mfma_f32_16x16x32_bf16 v[28:31], v[56:59], v[56:59], v[28:31]
    v_mfma_f32_16x16x32_bf16 v[36:39], v[56:59], v[40:43], v[36:39]
    s_waitcnt lgkmcnt(4)
    v_mfma_f32_16x16x32_bf16 v[24:27], v[60:63], v[60:63], v[24:27]
    ds_read_b128 v[52:55], v249 offset:16384
    v_mfma_f32_16x16x32_bf16 v[32:35], v[60:63], v[40:43], v[32:35]
    ds_read_b128 v[56:59], v249 offset:18432
    v_mfma_f32_16x16x32_bf16 v[28:31], v[64:67], v[64:67], v[28:31]
    v_mfma_f32_16x16x32_bf16 v[36:39], v[64:67], v[40:43], v[36:39]
    s_waitcnt lgkmcnt(4)
    v_mfma_f32_16x16x32_bf16 v[24:27], v[68:71], v[68:71], v[24:27]
    ds_read_b128 v[60:63], v248 offset:24576
    v_mfma_f32_16x16x32_bf16 v[32:35], v[68:71], v[40:43], v[32:35]
    ds_read_b128 v[64:67], v248 offset:26624
    v_mfma_f32_16x16x32_bf16 v[28:31], v[72:75], v[72:75], v[28:31]
    v_mfma_f32_16x16x32_bf16 v[36:39], v[72:75], v[40:43], v[36:39]
    s_waitcnt lgkmcnt(4)
    v_mfma_f32_16x16x32_bf16 v[24:27], v[44:47], v[44:47], v[24:27]
    ds_read_b128 v[68:71], v249 offset:24576
    v_mfma_f32_16x16x32_bf16 v[32:35], v[44:47], v[40:43], v[32:35]
    ds_read_b128 v[72:75], v249 offset:26624
    v_mfma_f32_16x16x32_bf16 v[28:31], v[48:51], v[48:51], v[28:31]
    v_mfma_f32_16x16x32_bf16 v[36:39], v[48:51], v[40:43], v[36:39]
    s_mov_b32 s61, 0
Lcw_7:
    v_mov_b32 v5, 0
    ds_read_b32 v5, v5 offset:512
    s_waitcnt lgkmcnt(0)
    v_cmp_gt_u32 vcc, 8, v5
    s_cbranch_vccz Lcd_8
    s_sleep 1
    s_add_u32 s61, s61, 1
    s_cmp_lt_u32 s61, 200000
    s_cbranch_scc1 Lcw_7
Lcd_8:
    v_mfma_f32_16x16x32_bf16 v[24:27], v[52:55], v[52:55], v[24:27]
    ds_read_b128 v[44:47], v248 offset:32768
    v_mfma_f32_16x16x32_bf16 v[32:35], v[52:55], v[40:43], v[32:35]
    ds_read_b128 v[48:51], v248 offset:34816
    v_mfma_f32_16x16x32_bf16 v[28:31], v[56:59], v[56:59], v[28:31]
    v_mfma_f32_16x16x32_bf16 v[36:39], v[56:59], v[40:43], v[36:39]
    v_mfma_f32_16x16x32_bf16 v[24:27], v[60:63], v[60:63], v[24:27]
    ds_read_b128 v[52:55], v249 offset:32768
    v_mfma_f32_16x16x32_bf16 v[32:35], v[60:63], v[40:43], v[32:35]
    ds_read_b128 v[56:59], v249 offset:34816
    v_mfma_f32_16x16x32_bf16 v[28:31], v[64:67], v[64:67], v[28:31]
    v_mfma_f32_16x16x32_bf16 v[36:39], v[64:67], v[40:43], v[36:39]
    v_mfma_f32_16x16x32_bf16 v[24:27], v[68:71], v[68:71], v[24:27]
    ds_read_b128 v[60:63], v250 offset:0
    v_mfma_f32_16x16x32_bf16 v[32:35], v[68:71], v[40:43], v[32:35]
    ds_read_b128 v[64:67], v250 offset:2048
    v_mfma_f32_16x16x32_bf16 v[28:31], v[72:75], v[72:75], v[28:31]
    v_mfma_f32_16x16x32_bf16 v[36:39], v[72:75], v[40:43], v[36:39]
    s_waitcnt lgkmcnt(4)
    v_mfma_f32_16x16x32_bf16 v[24:27], v[44:47], v[44:47], v[24:27]
    ds_read_b128 v[68:71], v251 offset:0
    v_mfma_f32_16x16x32_bf16 v[32:35], v[44:47], v[40:43], v[32:35]
    ds_read_b128 v[72:75], v251 offset:2048
    v_mfma_f32_16x16x32_bf16 v[28:31], v[48:51], v[48:51], v[28:31]
    v_mfma_f32_16x16x32_bf16 v[36:39], v[48:51], v[40:43], v[36:39]
    s_waitcnt lgkmcnt(4)
    v_mfma_f32_16x16x32_bf16 v[24:27], v[52:55], v[52:55], v[24:27]
    ds_read_b128 v[44:47], v250 offset:8192
    v_mfma_f32_16x16x32_bf16 v[32:35], v[52:55], v[40:43], v[32:35]
    ds_read_b128 v[48:51], v250 offset:10240
    v_mfma_f32_16x16x32_bf16 v[28:31], v[56:59], v[56:59], v[28:31]
    v_mfma_f32_16x16x32_bf16 v[36:39], v[56:59], v[40:43], v[36:39]
    s_waitcnt lgkmcnt(4)
    v_mfma_f32_16x16x32_bf16 v[24:27], v[60:63], v[60:63], v[24:27]
    ds_read_b128 v[52:55], v251 offset:8192
    v_mfma_f32_16x16x32_bf16 v[32:35], v[60:63], v[40:43], v[32:35]
    ds_read_b128 v[56:59], v251 offset:10240
    v_mfma_f32_16x16x32_bf16 v[28:31], v[64:67], v[64:67], v[28:31]
    v_mfma_f32_16x16x32_bf16 v[36:39], v[64:67], v[40:43], v[36:39]
    s_waitcnt lgkmcnt(4)
    v_mfma_f32_16x16x32_bf16 v[24:27], v[68:71], v[68:71], v[24:27]
    ds_read_b128 v[60:63], v250 offset:16384
    v_mfma_f32_16x16x32_bf16 v[32:35], v[68:71], v[40:43], v[32:35]
    ds_read_b128 v[64:67], v250 offset:18432
    v_mfma_f32_16x16x32_bf16 v[28:31], v[72:75], v[72:75], v[28:31]
    v_mfma_f32_16x16x32_bf16 v[36:39], v[72:75], v[40:43], v[36:39]
    s_waitcnt lgkmcnt(4)
    v_mfma_f32_16x16x32_bf16 v[24:27], v[44:47], v[44:47], v[24:27]
    ds_read_b128 v[68:71], v251 offset:16384
    v_mfma_f32_16x16x32_bf16 v[32:35], v[44:47], v[40:43], v[32:35]
    ds_read_b128 v[72:75], v251 offset:18432
    v_mfma_f32_16x16x32_bf16 v[28:31], v[48:51], v[48:51], v[28:31]
    v_mfma_f32_16x16x32_bf16 v[36:39], v[48:51], v[40:43], v[36:39]
    s_waitcnt lgkmcnt(4)
    v_mfma_f32_16x16x32_bf16 v[24:27], v[52:55], v[52:55], v[24:27]
    ds_read_b128 v[44:47], v250 offset:24576
    v_mfma_f32_16x16x32_bf16 v[32:35], v[52:55], v[40:43], v[32:35]
    ds_read_b128 v[48:51], v250 offset:26624
    v_mfma_f32_16x16x32_bf16 v[28:31], v[56:59], v[56:59], v[28:31]
    v_mfma_f32_16x16x32_bf16 v[36:39], v[56:59], v[40:43], v[36:39]
    s_waitcnt lgkmcnt(4)
    v_mfma_f32_16x16x32_bf16 v[24:27], v[60:63], v[60:63], v[24:27]
    ds_read_b128 v[52:55], v251 offset:24576
    v_mfma_f32_16x16x32_bf16 v[32:35], v[60:63], v[40:43], v[32:35]
    ds_read_b128 v[56:59], v251 offset:26624
    v_mfma_f32_16x16x32_bf16 v[28:31], v[64:67], v[64:67], v[28:31]
    v_mfma_f32_16x16x32_bf16 v[36:39], v[64:67], v[40:43], v[36:39]
    s_waitcnt lgkmcnt(4)
    v_mfma_f32_16x16x32_bf16 v[24:27], v[68:71], v[68:71], v[24:27]
    ds_read_b128 v[60:63], v250 offset:32768
    v_mfma_f32_16x16x32_bf16 v[32:35], v[68:71], v[40:43], v[32:35]
    ds_read_b128 v[64:67], v250 offset:34816
    v_mfma_f32_16x16x32_bf16 v[28:31], v[72:75], v[72:75], v[28:31]
    v_mfma_f32_16x16x32_bf16 v[36:39], v[72:75], v[40:43], v[36:39]
    s_waitcnt lgkmcnt(4)
    v_mfma_f32_16x16x32_bf16 v[24:27], v[44:47], v[44:47], v[24:27]
    ds_read_b128 v[68:71], v251 offset:32768
    v_mfma_f32_16x16x32_bf16 v[32:35], v[44:47], v[40:43], v[32:35]
    ds_read_b128 v[72:75], v251 offset:34816
    v_mfma_f32_16x16x32_bf16 v[28:31], v[48:51], v[48:51], v[28:31]
    v_mfma_f32_16x16x32_bf16 v[36:39], v[48:51], v[40:43], v[36:39]
    s_waitcnt lgkmcnt(4)
    v_mfma_f32_16x16x32_bf16 v[24:27], v[52:55], v[52:55], v[24:27]
    v_mfma_f32_16x16x32_bf16 v[32:35], v[52:55], v[40:43], v[32:35]
    v_mfma_f32_16x16x32_bf16 v[28:31], v[56:59], v[56:59], v[28:31]
    v_mfma_f32_16x16x32_bf16 v[36:39], v[56:59], v[40:43], v[36:39]
    s_waitcnt lgkmcnt(2)
    v_mfma_f32_16x16x32_bf16 v[24:27], v[60:63], v[60:63], v[24:27]
    v_mfma_f32_16x16x32_bf16 v[32:35], v[60:63], v[40:43], v[32:35]
    v_mfma_f32_16x16x32_bf16 v[28:31], v[64:67], v[64:67], v[28:31]
    v_mfma_f32_16x16x32_bf16 v[36:39], v[64:67], v[40:43], v[36:39]
    s_waitcnt lgkmcnt(0)
    v_mfma_f32_16x16x32_bf16 v[24:27], v[68:71], v[68:71], v[24:27]
    v_mfma_f32_16x16x32_bf16 v[32:35], v[68:71], v[40:43], v[32:35]
    v_mfma_f32_16x16x32_bf16 v[28:31], v[72:75], v[72:75], v[28:31]
    v_mfma_f32_16x16x32_bf16 v[36:39], v[72:75], v[40:43], v[36:39]
    s_waitcnt vmcnt(2)
    v_readfirstlane_b32 s41, v252
    s_nop 1
    s_add_u32 s41, s41, 16
    s_and_b32 s41, s41, -16
    s_bitset1_b32 s41, 31
    s_lshr_b32 s6, s60, 5
    v_lshlrev_b32 v12, 2, v9
    v_sub_u32 v12, v8, v12
    v_lshl_add_u32 v13, v8, 2, s6
    v_cmp_eq_u32 s[70:71], 1, v12
    v_cmp_eq_u32 s[72:73], 2, v12
    v_cmp_eq_u32 s[74:75], 3, v12
    v_cmp_gt_u32 s[76:77], 4, v12
    s_mov_b32 s7, 0x3acccccd
    v_cndmask_b32 v24, v24, v25, s[70:71]
    v_cndmask_b32 v24, v24, v26, s[72:73]
    v_cndmask_b32 v24, v24, v27, s[74:75]
    v_cndmask_b32 v32, v32, v33, s[70:71]
    v_cndmask_b32 v32, v32, v34, s[72:73]
    v_cndmask_b32 v32, v32, v35, s[74:75]
    v_mul_f32 v32, s7, v32
    v_mul_f32 v24, s7, v24
    v_fma_f32 v24, -v32, v32, v24
    v_max_f32 v24, 0, v24
    v_add_f32 v24, 0x3727c5ac, v24
    v_rsq_f32 v24, v24
    s_nop 0
    v_mul_f32 v32, v32, v24
    v_cndmask_b32 v28, v28, v29, s[70:71]
    v_cndmask_b32 v28, v28, v30, s[72:73]
    v_cndmask_b32 v28, v28, v31, s[74:75]
    v_cndmask_b32 v36, v36, v37, s[70:71]
    v_cndmask_b32 v36, v36, v38, s[72:73]
    v_cndmask_b32 v36, v36, v39, s[74:75]
    v_mul_f32 v36, s7, v36
    v_mul_f32 v28, s7, v28
    v_fma_f32 v28, -v36, v36, v28
    v_max_f32 v28, 0, v28
    v_add_f32 v28, 0x3727c5ac, v28
    v_rsq_f32 v28, v28
    s_nop 0
    v_mul_f32 v36, v36, v28
    s_mov_b64 exec, s[76:77]
    ds_write_b32 v13, v24 offset:0
    ds_write_b32 v13, v32 offset:256
    ds_write_b32 v13, v28 offset:64
    ds_write_b32 v13, v36 offset:320
    s_mov_b64 exec, -1
    s_waitcnt lgkmcnt(0)
    s_barrier
    s_mul_i32 s64, s99, 1280
    s_mul_i32 s6, s60, 3
    s_lshr_b32 s6, s6, 1
    s_add_u32 m0, s6, 94208
    s_nop 0
    buffer_load_dwordx4 v120, s[56:59], s64 offen lds
    s_add_u32 m0, s6, 95232
    s_nop 0
    buffer_load_dwordx4 v121, s[56:59], s64 offen lds
    s_add_u32 m0, s6, 96256
    s_nop 0
    buffer_load_dwordx4 v122, s[56:59], s64 offen lds
    s_add_u32 s64, s64, 1310720
    s_add_u32 m0, s6, 97280
    s_nop 0
    buffer_load_dwordx4 v120, s[56:59], s64 offen lds
    s_add_u32 m0, s6, 98304
    s_nop 0
    buffer_load_dwordx4 v121, s[56:59], s64 offen lds
    s_add_u32 m0, s6, 99328
    s_nop 0
    buffer_load_dwordx4 v122, s[56:59], s64 offen lds
    s_add_u32 s6, s60, 106496
    v_add_u32 v95, s6, v2
    v_lshl_add_u32 v92, v10, 6, s99
    v_cvt_f32_u32 v92, v92
    v_mul_f32 v92, 0x3a000000, v92
    v_lshlrev_b32 v93, 3, v4
    v_cvt_f32_u32 v93, v93
    v_mul_f32 v93, v93, v92
    v_fmamk_f32 v80, v92, 0x00000000, v93
    v_fmamk_f32 v81, v92, 0x3f800000, v93
    v_fmamk_f32 v82, v92, 0x40000000, v93
    v_fmamk_f32 v83, v92, 0x40400000, v93
    v_fmamk_f32 v84, v92, 0x40800000, v93
    v_fmamk_f32 v85, v92, 0x40a00000, v93
    v_fmamk_f32 v86, v92, 0x40c00000, v93
    v_fmamk_f32 v87, v92, 0x40e00000, v93
    v_sin_f32 v80, v80
    v_sin_f32 v81, v81
    v_sin_f32 v82, v82
    v_sin_f32 v83, v83
    v_sin_f32 v84, v84
    v_sin_f32 v85, v85
    v_sin_f32 v86, v86
    v_sin_f32 v87, v87
    v_cvt_pk_bf16_f32 v88, v80, v81
    v_cvt_pk_bf16_f32 v89, v82, v83
    v_cvt_pk_bf16_f32 v90, v84, v85
    v_cvt_pk_bf16_f32 v91, v86, v87
    ds_write_b128 v95, v[88:91] offset:2048
    v_fmamk_f32 v80, v92, 0x41800000, v93
    v_fmamk_f32 v81, v92, 0x41880000, v93
    v_fmamk_f32 v82, v92, 0x41900000, v93
    v_fmamk_f32 v83, v92, 0x41980000, v93
    v_fmamk_f32 v84, v92, 0x41a00000, v93
    v_fmamk_f32 v85, v92, 0x41a80000, v93
    v_fmamk_f32 v86, v92, 0x41b00000, v93
    v_fmamk_f32 v87, v92, 0x41b80000, v93
    v_sin_f32 v80, v80
    v_sin_f32 v81, v81
    v_sin_f32 v82, v82
    v_sin_f32 v83, v83
    v_sin_f32 v84, v84
    v_sin_f32 v85, v85
    v_sin_f32 v86, v86
    v_sin_f32 v87, v87
    v_cvt_pk_bf16_f32 v88, v80, v81
    v_cvt_pk_bf16_f32 v89, v82, v83
    v_cvt_pk_bf16_f32 v90, v84, v85
    v_cvt_pk_bf16_f32 v91, v86, v87
    ds_write_b128 v95, v[88:91] offset:3072
    v_add_f32 v93, 0x3e800000, v93
    v_fmamk_f32 v80, v92, 0x00000000, v93
    v_fmamk_f32 v81, v92, 0x3f800000, v93
    v_fmamk_f32 v82, v92, 0x40000000, v93
    v_fmamk_f32 v83, v92, 0x40400000, v93
    v_fmamk_f32 v84, v92, 0x40800000, v93
    v_fmamk_f32 v85, v92, 0x40a00000, v93
    v_fmamk_f32 v86, v92, 0x40c00000, v93
    v_fmamk_f32 v87, v92, 0x40e00000, v93
    v_sin_f32 v80, v80
    v_sin_f32 v81, v81
    v_sin_f32 v82, v82
    v_sin_f32 v83, v83
    v_sin_f32 v84, v84
    v_sin_f32 v85, v85
    v_sin_f32 v86, v86
    v_sin_f32 v87, v87
    v_cvt_pk_bf16_f32 v88, v80, v81
    v_cvt_pk_bf16_f32 v89, v82, v83
    v_cvt_pk_bf16_f32 v90, v84, v85
    v_cvt_pk_bf16_f32 v91, v86, v87
    ds_write_b128 v95, v[88:91] offset:0
    v_fmamk_f32 v80, v92, 0x41800000, v93
    v_fmamk_f32 v81, v92, 0x41880000, v93
    v_fmamk_f32 v82, v92, 0x41900000, v93
    v_fmamk_f32 v83, v92, 0x41980000, v93
    v_fmamk_f32 v84, v92, 0x41a00000, v93
    v_fmamk_f32 v85, v92, 0x41a80000, v93
    v_fmamk_f32 v86, v92, 0x41b00000, v93
    v_fmamk_f32 v87, v92, 0x41b80000, v93
    v_sin_f32 v80, v80
    v_sin_f32 v81, v81
    v_sin_f32 v82, v82
    v_sin_f32 v83, v83
    v_sin_f32 v84, v84
    v_sin_f32 v85, v85
    v_sin_f32 v86, v86
    v_sin_f32 v87, v87
    v_cvt_pk_bf16_f32 v88, v80, v81
    v_cvt_pk_bf16_f32 v89, v82, v83
    v_cvt_pk_bf16_f32 v90, v84, v85
    v_cvt_pk_bf16_f32 v91, v86, v87
    ds_write_b128 v95, v[88:91] offset:1024
    s_branch Lp0j_3
Lp0c_2:
    s_movk_i32 s7, 1120
    v_add_u32 v0, 0, v1
    v_mul_u32_u24 v5, 6554, v0
    v_lshrrev_b32 v5, 16, v5
    v_lshlrev_b32 v0, 4, v0
    v_mad_u32_u24 v120, v5, s7, v0
    v_add_u32 v0, 64, v1
    v_mul_u32_u24 v5, 6554, v0
    v_lshrrev_b32 v5, 16, v5
    v_lshlrev_b32 v0, 4, v0
    v_mad_u32_u24 v121, v5, s7, v0
    v_add_u32 v0, 128, v1
    v_mul_u32_u24 v5, 6554, v0
    v_lshrrev_b32 v5, 16, v5
    v_lshlrev_b32 v0, 4, v0
    v_mad_u32_u24 v122, v5, s7, v0
    v_add_u32 v0, 192, v1
    v_mul_u32_u24 v5, 6554, v0
    v_lshrrev_b32 v5, 16, v5
    v_lshlrev_b32 v0, 4, v0
    v_mad_u32_u24 v123, v5, s7, v0
    v_add_u32 v0, 256, v1
    v_mul_u32_u24 v5, 6554, v0
    v_lshrrev_b32 v5, 16, v5
    v_lshlrev_b32 v0, 4, v0
    v_mad_u32_u24 v124, v5, s7, v0
    s_mul_i32 s6, s4, 40960
    s_mul_i32 s7, s5, 160
    s_add_u32 s6, s6, s7
    s_add_u32 s7, s6, 1310720
    s_mov_b32 m0, 31744
    s_nop 0
    buffer_load_dwordx4 v120, s[72:75], s6 offen lds
    s_mov_b32 m0, 32768
    s_nop 0
    buffer_load_dwordx4 v121, s[72:75], s6 offen lds
    s_mov_b32 m0, 33792
    s_nop 0
    buffer_load_dwordx4 v122, s[72:75], s6 offen lds
    s_mov_b32 m0, 34816
    s_nop 0
    buffer_load_dwordx4 v123, s[72:75], s6 offen lds
    s_mov_b32 m0, 35840
    s_nop 0
    buffer_load_dwordx4 v124, s[72:75], s6 offen lds
    s_mov_b32 m0, 36864
    s_nop 0
    buffer_load_dwordx4 v120, s[72:75], s7 offen lds
    s_mov_b32 m0, 37888
    s_nop 0
    buffer_load_dwordx4 v121, s[72:75], s7 offen lds
    s_mov_b32 m0, 38912
    s_nop 0
    buffer_load_dwordx4 v122, s[72:75], s7 offen lds
    s_mov_b32 m0, 39936
    s_nop 0
    buffer_load_dwordx4 v123, s[72:75], s7 offen lds
    s_mov_b32 m0, 40960
    s_nop 0
    buffer_load_dwordx4 v124, s[72:75], s7 offen lds
    s_and_b32 s6, s4, 7
    s_mul_i32 s98, s6, 5
    s_mul_i32 s99, s6, 10
    s_add_u32 s99, s99, 4
    s_bfe_u32 s7, s4, 0x10003
    s_cmp_ge_u32 s4, 16
    s_cselect_b64 s[76:77], -1, 0
    v_add_u32 v0, 0, v1
    v_mul_u32_u24 v5, 4682, v0
    v_lshrrev_b32 v5, 16, v5
    v_mul_u32_u24 v6, 14, v5
    v_sub_u32 v0, v0, v6
    v_lshrrev_b32 v6, 3, v5
    v_add_u32 v7, s98, v6
    v_lshrrev_b32 v11, 1, v6
    v_mad_u32_u24 v11, v11, 5, s99
    v_mov_b32 v12, s7
    v_and_b32 v6, 1, v6
    v_cndmask_b32 v7, v7, v11, s[76:77]
    v_cndmask_b32 v6, v12, v6, s[76:77]
    v_and_b32 v5, 7, v5
    v_lshl_add_u32 v5, v7, 3, v5
    v_sub_u32 v7, 640, v5
    v_cmp_eq_u32 vcc, 1, v6
    s_nop 1
    v_cndmask_b32 v5, v5, v7, vcc
    v_mov_b32 v6, 320
    v_cmp_eq_u32 vcc, 0, v5
    s_nop 1
    v_cndmask_b32 v5, v5, v6, vcc
    v_cmp_eq_u32 vcc, 640, v5
    s_nop 1
    v_cndmask_b32 v5, v5, 0, vcc
    v_and_b32 v5, 0x3ff, v5
    v_mul_u32_u24 v5, 3456, v5
    v_lshl_add_u32 v128, v0, 4, v5
    v_add_u32 v0, 64, v1
    v_mul_u32_u24 v5, 4682, v0
    v_lshrrev_b32 v5, 16, v5
    v_mul_u32_u24 v6, 14, v5
    v_sub_u32 v0, v0, v6
    v_lshrrev_b32 v6, 3, v5
    v_add_u32 v7, s98, v6
    v_lshrrev_b32 v11, 1, v6
    v_mad_u32_u24 v11, v11, 5, s99
    v_mov_b32 v12, s7
    v_and_b32 v6, 1, v6
    v_cndmask_b32 v7, v7, v11, s[76:77]
    v_cndmask_b32 v6, v12, v6, s[76:77]
    v_and_b32 v5, 7, v5
    v_lshl_add_u32 v5, v7, 3, v5
    v_sub_u32 v7, 640, v5
    v_cmp_eq_u32 vcc, 1, v6
    s_nop 1
    v_cndmask_b32 v5, v5, v7, vcc
    v_and_b32 v5, 0x3ff, v5
    v_mul_u32_u24 v5, 3456, v5
    v_lshl_add_u32 v129, v0, 4, v5
    v_add_u32 v0, 128, v1
    v_mul_u32_u24 v5, 4682, v0
    v_lshrrev_b32 v5, 16, v5
    v_mul_u32_u24 v6, 14, v5
    v_sub_u32 v0, v0, v6
    v_lshrrev_b32 v6, 3, v5
    v_add_u32 v7, s98, v6
    v_lshrrev_b32 v11, 1, v6
    v_mad_u32_u24 v11, v11, 5, s99
    v_mov_b32 v12, s7
    v_and_b32 v6, 1, v6
    v_cndmask_b32 v7, v7, v11, s[76:77]
    v_cndmask_b32 v6, v12, v6, s[76:77]
    v_and_b32 v5, 7, v5
    v_lshl_add_u32 v5, v7, 3, v5
    v_sub_u32 v7, 640, v5
    v_cmp_eq_u32 vcc, 1, v6
    s_nop 1
    v_cndmask_b32 v5, v5, v7, vcc
    v_and_b32 v5, 0x3ff, v5
    v_mul_u32_u24 v5, 3456, v5
    v_lshl_add_u32 v130, v0, 4, v5
    v_add_u32 v0, 192, v1
    v_mul_u32_u24 v5, 4682, v0
    v_lshrrev_b32 v5, 16, v5
    v_mul_u32_u24 v6, 14, v5
    v_sub_u32 v0, v0, v6
    v_lshrrev_b32 v6, 3, v5
    v_add_u32 v7, s98, v6
    v_lshrrev_b32 v11, 1, v6
    v_mad_u32_u24 v11, v11, 5, s99
    v_mov_b32 v12, s7
    v_and_b32 v6, 1, v6
    v_cndmask_b32 v7, v7, v11, s[76:77]
    v_cndmask_b32 v6, v12, v6, s[76:77]
    v_and_b32 v5, 7, v5
    v_lshl_add_u32 v5, v7, 3, v5
    v_sub_u32 v7, 640, v5
    v_cmp_eq_u32 vcc, 1, v6
    s_nop 1
    v_cndmask_b32 v5, v5, v7, vcc
    v_and_b32 v5, 0x3ff, v5
    v_mul_u32_u24 v5, 3456, v5
    v_lshl_add_u32 v131, v0, 4, v5
    v_add_u32 v0, 256, v1
    v_mul_u32_u24 v5, 4682, v0
    v_lshrrev_b32 v5, 16, v5
    v_mul_u32_u24 v6, 14, v5
    v_sub_u32 v0, v0, v6
    v_lshrrev_b32 v6, 3, v5
    v_add_u32 v7, s98, v6
    v_lshrrev_b32 v11, 1, v6
    v_mad_u32_u24 v11, v11, 5, s99
    v_mov_b32 v12, s7
    v_and_b32 v6, 1, v6
    v_cndmask_b32 v7, v7, v11, s[76:77]
    v_cndmask_b32 v6, v12, v6, s[76:77]
    v_and_b32 v5, 7, v5
    v_lshl_add_u32 v5, v7, 3, v5
    v_sub_u32 v7, 640, v5
    v_cmp_eq_u32 vcc, 1, v6
    s_nop 1
    v_cndmask_b32 v5, v5, v7, vcc
    v_and_b32 v5, 0x3ff, v5
    v_mul_u32_u24 v5, 3456, v5
    v_lshl_add_u32 v132, v0, 4, v5
    v_add_u32 v0, 320, v1
    v_mul_u32_u24 v5, 4682, v0
    v_lshrrev_b32 v5, 16, v5
    v_mul_u32_u24 v6, 14, v5
    v_sub_u32 v0, v0, v6
    v_lshrrev_b32 v6, 3, v5
    v_add_u32 v7, s98, v6
    v_lshrrev_b32 v11, 1, v6
    v_mad_u32_u24 v11, v11, 5, s99
    v_mov_b32 v12, s7
    v_and_b32 v6, 1, v6
    v_cndmask_b32 v7, v7, v11, s[76:77]
    v_cndmask_b32 v6, v12, v6, s[76:77]
    v_and_b32 v5, 7, v5
    v_lshl_add_u32 v5, v7, 3, v5
    v_sub_u32 v7, 640, v5
    v_cmp_eq_u32 vcc, 1, v6
    s_nop 1
    v_cndmask_b32 v5, v5, v7, vcc
    v_and_b32 v5, 0x3ff, v5
    v_mul_u32_u24 v5, 3456, v5
    v_lshl_add_u32 v133, v0, 4, v5
    v_add_u32 v0, 384, v1
    v_mul_u32_u24 v5, 4682, v0
    v_lshrrev_b32 v5, 16, v5
    v_mul_u32_u24 v6, 14, v5
    v_sub_u32 v0, v0, v6
    v_lshrrev_b32 v6, 3, v5
    v_add_u32 v7, s98, v6
    v_lshrrev_b32 v11, 1, v6
    v_mad_u32_u24 v11, v11, 5, s99
    v_mov_b32 v12, s7
    v_and_b32 v6, 1, v6
    v_cndmask_b32 v7, v7, v11, s[76:77]
    v_cndmask_b32 v6, v12, v6, s[76:77]
    v_and_b32 v5, 7, v5
    v_lshl_add_u32 v5, v7, 3, v5
    v_sub_u32 v7, 640, v5
    v_cmp_eq_u32 vcc, 1, v6
    s_nop 1
    v_cndmask_b32 v5, v5, v7, vcc
    v_and_b32 v5, 0x3ff, v5
    v_mul_u32_u24 v5, 3456, v5
    v_lshl_add_u32 v134, v0, 4, v5
    s_lshl_b32 s7, s100, 6
    s_cmp_lt_u32 s4, 20
    s_cselect_b32 s7, s7, 0x7f000000
    s_add_u32 s6, s7, 224
    s_mov_b32 m0, 17408
    s_nop 0
    buffer_load_dwordx4 v128, s[68:71], s7 offen lds
    s_mov_b32 m0, 18432
    s_nop 0
    buffer_load_dwordx4 v129, s[68:71], s7 offen lds
    s_mov_b32 m0, 19456
    s_nop 0
    buffer_load_dwordx4 v130, s[68:71], s7 offen lds
    s_mov_b32 m0, 20480
    s_nop 0
    buffer_load_dwordx4 v131, s[68:71], s7 offen lds
    s_mov_b32 m0, 21504
    s_nop 0
    buffer_load_dwordx4 v132, s[68:71], s7 offen lds
    s_mov_b32 m0, 22528
    s_nop 0
    buffer_load_dwordx4 v133, s[68:71], s7 offen lds
    s_mov_b32 m0, 23552
    s_nop 0
    buffer_load_dwordx4 v134, s[68:71], s7 offen lds
    s_mov_b32 m0, 24576
    s_nop 0
    buffer_load_dwordx4 v128, s[68:71], s6 offen lds
    s_mov_b32 m0, 25600
    s_nop 0
    buffer_load_dwordx4 v129, s[68:71], s6 offen lds
    s_mov_b32 m0, 26624
    s_nop 0
    buffer_load_dwordx4 v130, s[68:71], s6 offen lds
    s_mov_b32 m0, 27648
    s_nop 0
    buffer_load_dwordx4 v131, s[68:71], s6 offen lds
    s_mov_b32 m0, 28672
    s_nop 0
    buffer_load_dwordx4 v132, s[68:71], s6 offen lds
    s_mov_b32 m0, 29696
    s_nop 0
    buffer_load_dwordx4 v133, s[68:71], s6 offen lds
    s_mov_b32 m0, 30720
    s_nop 0
    buffer_load_dwordx4 v134, s[68:71], s6 offen lds
    s_waitcnt vmcnt(31) lgkmcnt(0)
    s_barrier
    s_waitcnt vmcnt(25)
    v_mov_b32 v5, 0
    v_mov_b32 v0, 1
    s_mov_b64 exec, 1
    ds_add_u32 v5, v0 offset:512
    s_mov_b64 exec, -1
    v_mov_b32 v0, 0
    v_lshlrev_b32 v5, 2, v1
    s_mov_b32 exec_hi, 0
    buffer_store_dword v0, v5, s[28:31], s45 offen sc1
    s_add_u32 s62, s45, 0x80000
    buffer_load_dword v254, v5, s[28:31], s62 offen sc1
    s_mov_b32 exec_hi, -1
    v_bfe_u32 v5, v1, 2, 2
    v_lshl_add_u32 v5, v9, 3, v5
    v_mul_u32_u24 v5, 160, v5
    v_and_b32 v0, 3, v1
    v_lshl_add_u32 v5, v0, 3, v5
    v_add_u32 v5, 31744, v5
    s_waitcnt vmcnt(16)
    ds_read_b64_tr_b16 v[136:137], v5 offset:0
    ds_read_b64_tr_b16 v[138:139], v5 offset:640
    ds_read_b64_tr_b16 v[140:141], v5 offset:32
    ds_read_b64_tr_b16 v[142:143], v5 offset:672
    ds_read_b64_tr_b16 v[144:145], v5 offset:64
    ds_read_b64_tr_b16 v[146:147], v5 offset:704
    ds_read_b64_tr_b16 v[148:149], v5 offset:96
    ds_read_b64_tr_b16 v[150:151], v5 offset:736
    ds_read_b64_tr_b16 v[152:153], v5 offset:128
    ds_read_b64_tr_b16 v[154:155], v5 offset:768
    ds_read_b64_tr_b16 v[156:157], v5 offset:5120
    ds_read_b64_tr_b16 v[158:159], v5 offset:5760
    ds_read_b64_tr_b16 v[160:161], v5 offset:5152
    ds_read_b64_tr_b16 v[162:163], v5 offset:5792
    ds_read_b64_tr_b16 v[164:165], v5 offset:5184
    ds_read_b64_tr_b16 v[166:167], v5 offset:5824
    ds_read_b64_tr_b16 v[168:169], v5 offset:5216
    ds_read_b64_tr_b16 v[170:171], v5 offset:5856
    ds_read_b64_tr_b16 v[172:173], v5 offset:5248
    ds_read_b64_tr_b16 v[174:175], v5 offset:5888
    s_mul_i32 s6, s5, 54
    s_add_u32 s6, s6, s4
    s_mul_i32 s6, s6, 5120
    s_add_u32 s6, s6, 0x220000
    s_waitcnt lgkmcnt(15)
    s_add_u32 s7, s6, 0
    buffer_store_dwordx4 v[136:139], v2, s[28:31], s7 offen sc1
    s_add_u32 s7, s6, 1024
    buffer_store_dwordx4 v[140:143], v2, s[28:31], s7 offen sc1
    s_waitcnt lgkmcnt(14)
    s_add_u32 s7, s6, 2048
    buffer_store_dwordx4 v[144:147], v2, s[28:31], s7 offen sc1
    s_waitcnt lgkmcnt(12)
    s_add_u32 s7, s6, 3072
    buffer_store_dwordx4 v[148:151], v2, s[28:31], s7 offen sc1
    s_waitcnt lgkmcnt(10)
    s_add_u32 s7, s6, 4096
    buffer_store_dwordx4 v[152:155], v2, s[28:31], s7 offen sc1
    s_cmp_ge_u32 s4, 22
    s_cselect_b32 s6, 0x7f000000, s6
    s_waitcnt lgkmcnt(8)
    s_add_u32 s7, s6, 163840
    buffer_store_dwordx4 v[156:159], v2, s[28:31], s7 offen sc1
    s_waitcnt lgkmcnt(6)
    s_add_u32 s7, s6, 164864
    buffer_store_dwordx4 v[160:163], v2, s[28:31], s7 offen sc1
    s_waitcnt lgkmcnt(4)
    s_add_u32 s7, s6, 165888
    buffer_store_dwordx4 v[164:167], v2, s[28:31], s7 offen sc1
    s_waitcnt lgkmcnt(2)
    s_add_u32 s7, s6, 166912
    buffer_store_dwordx4 v[168:171], v2, s[28:31], s7 offen sc1
    s_waitcnt lgkmcnt(0)
    s_add_u32 s7, s6, 167936
    buffer_store_dwordx4 v[172:175], v2, s[28:31], s7 offen sc1
    v_readfirstlane_b32 s41, v252
    s_nop 1
    s_add_u32 s41, s41, 16
    s_and_b32 s41, s41, -16
    s_bitset1_b32 s41, 31
    s_cmp_ge_u32 s4, 20
    s_cbranch_scc1 Lw1_9
    v_bfe_u32 v5, v1, 2, 2
    v_lshl_add_u32 v5, v9, 3, v5
    v_mul_u32_u24 v5, 224, v5
    v_and_b32 v0, 3, v1
    v_lshl_add_u32 v5, v0, 3, v5
    v_add_u32 v5, 17408, v5
    s_mov_b32 s60, 0
    s_waitcnt vmcnt(19)
    ds_read_b64_tr_b16 v[16:17], v5 offset:0
    ds_read_b64_tr_b16 v[18:19], v5 offset:896
    ds_read_b64_tr_b16 v[20:21], v5 offset:32
    ds_read_b64_tr_b16 v[22:23], v5 offset:928
    ds_read_b64_tr_b16 v[24:25], v5 offset:64
    ds_read_b64_tr_b16 v[26:27], v5 offset:960
    ds_read_b64_tr_b16 v[28:29], v5 offset:96
    ds_read_b64_tr_b16 v[30:31], v5 offset:992
    ds_read_b64_tr_b16 v[32:33], v5 offset:128
    ds_read_b64_tr_b16 v[34:35], v5 offset:1024
    ds_read_b64_tr_b16 v[36:37], v5 offset:160
    ds_read_b64_tr_b16 v[38:39], v5 offset:1056
    ds_read_b64_tr_b16 v[40:41], v5 offset:192
    ds_read_b64_tr_b16 v[42:43], v5 offset:1088
    s_lshl_b32 s6, s100, 1
    s_add_u32 s60, s60, s6
    s_mul_i32 s6, s60, 20
    s_add_u32 s6, s6, s4
    s_lshl_b32 s6, s6, 10
    s_mov_b32 s98, 0
    s_mov_b32 s99, 0x3f803f80
    s_waitcnt lgkmcnt(12)
    s_add_u32 s7, s6, 0
    buffer_store_dwordx4 v[16:19], v2, s[28:31], s7 offen sc1
    v_mov_b32 v48, 0
    s_waitcnt lgkmcnt(10)
    s_add_u32 s7, s6, 20480
    buffer_store_dwordx4 v[20:23], v2, s[28:31], s7 offen sc1
    v_mov_b32 v49, 0
    s_waitcnt lgkmcnt(8)
    s_add_u32 s7, s6, 40960
    buffer_store_dwordx4 v[24:27], v2, s[28:31], s7 offen sc1
    v_mov_b32 v50, 0
    s_waitcnt lgkmcnt(6)
    s_add_u32 s7, s6, 61440
    buffer_store_dwordx4 v[28:31], v2, s[28:31], s7 offen sc1
    v_mov_b32 v51, 0
    s_waitcnt lgkmcnt(4)
    s_add_u32 s7, s6, 81920
    buffer_store_dwordx4 v[32:35], v2, s[28:31], s7 offen sc1
    v_mov_b32 v52, 0
    s_waitcnt lgkmcnt(2)
    s_add_u32 s7, s6, 102400
    s_cmp_ge_u32 s98, 6
    s_cselect_b32 s7, 0x7f000000, s7
    buffer_store_dwordx4 v[36:39], v2, s[28:31], s7 offen sc1
    v_mov_b32 v53, 0
    s_waitcnt lgkmcnt(0)
    s_add_u32 s7, s6, 122880
    s_cmp_ge_u32 s98, 6
    s_cselect_b32 s7, 0x7f000000, s7
    buffer_store_dwordx4 v[40:43], v2, s[28:31], s7 offen sc1
    v_mov_b32 v54, 0
    v_mov_b32 v55, 0
    v_dot2_f32_bf16 v48, v16, s99, v48
    v_dot2_f32_bf16 v49, v20, s99, v49
    v_dot2_f32_bf16 v50, v24, s99, v50
    v_dot2_f32_bf16 v51, v28, s99, v51
    v_dot2_f32_bf16 v52, v32, s99, v52
    v_dot2_f32_bf16 v53, v36, s99, v53
    v_dot2_f32_bf16 v54, v40, s99, v54
    v_dot2_f32_bf16 v48, v17, s99, v48
    v_dot2_f32_bf16 v49, v21, s99, v49
    v_dot2_f32_bf16 v50, v25, s99, v50
    v_dot2_f32_bf16 v51, v29, s99, v51
    v_dot2_f32_bf16 v52, v33, s99, v52
    v_dot2_f32_bf16 v53, v37, s99, v53
    v_dot2_f32_bf16 v54, v41, s99, v54
    v_dot2_f32_bf16 v48, v18, s99, v48
    v_dot2_f32_bf16 v49, v22, s99, v49
    v_dot2_f32_bf16 v50, v26, s99, v50
    v_dot2_f32_bf16 v51, v30, s99, v51
    v_dot2_f32_bf16 v52, v34, s99, v52
    v_dot2_f32_bf16 v53, v38, s99, v53
    v_dot2_f32_bf16 v54, v42, s99, v54
    v_dot2_f32_bf16 v48, v19, s99, v48
    v_dot2_f32_bf16 v49, v23, s99, v49
    v_dot2_f32_bf16 v50, v27, s99, v50
    v_dot2_f32_bf16 v51, v31, s99, v51
    v_dot2_f32_bf16 v52, v35, s99, v52
    v_dot2_f32_bf16 v53, v39, s99, v53
    v_dot2_f32_bf16 v54, v43, s99, v54
    s_nop 3
    v_permlane16_swap_b32 v48, v49
    v_permlane16_swap_b32 v50, v51
    v_permlane16_swap_b32 v52, v53
    v_permlane16_swap_b32 v54, v55
    v_add_f32 v48, v48, v49
    v_add_f32 v50, v50, v51
    v_add_f32 v52, v52, v53
    v_add_f32 v54, v54, v55
    v_permlane32_swap_b32 v48, v50
    s_nop 0
    v_permlane32_swap_b32 v52, v54
    v_add_f32 v48, v48, v50
    v_add_f32 v52, v52, v54
    s_mul_i32 s6, s4, 6912
    s_lshl_b32 s7, s60, 6
    s_add_u32 s6, s6, s7
    s_add_u32 s6, s6, 0x510000
    v_lshlrev_b32 v5, 2, v1
    buffer_store_dword v48, v5, s[28:31], s6 offen sc1
    s_cmp_ge_u32 s98, 6
    s_cselect_b32 exec_lo, 0xffff, -1
    s_cselect_b32 exec_hi, 0, 0xffff
    buffer_store_dword v52, v5, s[28:31], s6 offen offset:256 sc1
    s_mov_b64 exec, -1
    v_bfe_u32 v5, v1, 2, 2
    v_lshl_add_u32 v5, v9, 3, v5
    v_mul_u32_u24 v5, 224, v5
    v_and_b32 v0, 3, v1
    v_lshl_add_u32 v5, v0, 3, v5
    v_add_u32 v5, 24576, v5
    s_mov_b32 s60, 7
    s_waitcnt vmcnt(21)
    ds_read_b64_tr_b16 v[16:17], v5 offset:0
    ds_read_b64_tr_b16 v[18:19], v5 offset:896
    ds_read_b64_tr_b16 v[20:21], v5 offset:32
    ds_read_b64_tr_b16 v[22:23], v5 offset:928
    ds_read_b64_tr_b16 v[24:25], v5 offset:64
    ds_read_b64_tr_b16 v[26:27], v5 offset:960
    ds_read_b64_tr_b16 v[28:29], v5 offset:96
    ds_read_b64_tr_b16 v[30:31], v5 offset:992
    ds_read_b64_tr_b16 v[32:33], v5 offset:128
    ds_read_b64_tr_b16 v[34:35], v5 offset:1024
    ds_read_b64_tr_b16 v[36:37], v5 offset:160
    ds_read_b64_tr_b16 v[38:39], v5 offset:1056
    ds_read_b64_tr_b16 v[40:41], v5 offset:192
    ds_read_b64_tr_b16 v[42:43], v5 offset:1088
    s_lshl_b32 s6, s100, 1
    s_add_u32 s60, s60, s6
    s_mul_i32 s6, s60, 20
    s_add_u32 s6, s6, s4
    s_lshl_b32 s6, s6, 10
    s_mov_b32 s98, s5
    s_mov_b32 s99, 0x3f803f80
    s_waitcnt lgkmcnt(12)
    s_add_u32 s7, s6, 0
    buffer_store_dwordx4 v[16:19], v2, s[28:31], s7 offen sc1
    v_mov_b32 v48, 0
    s_waitcnt lgkmcnt(10)
    s_add_u32 s7, s6, 20480
    buffer_store_dwordx4 v[20:23], v2, s[28:31], s7 offen sc1
    v_mov_b32 v49, 0
    s_waitcnt lgkmcnt(8)
    s_add_u32 s7, s6, 40960
    buffer_store_dwordx4 v[24:27], v2, s[28:31], s7 offen sc1
    v_mov_b32 v50, 0
    s_waitcnt lgkmcnt(6)
    s_add_u32 s7, s6, 61440
    buffer_store_dwordx4 v[28:31], v2, s[28:31], s7 offen sc1
    v_mov_b32 v51, 0
    s_waitcnt lgkmcnt(4)
    s_add_u32 s7, s6, 81920
    buffer_store_dwordx4 v[32:35], v2, s[28:31], s7 offen sc1
    v_mov_b32 v52, 0
    s_waitcnt lgkmcnt(2)
    s_add_u32 s7, s6, 102400
    s_cmp_ge_u32 s98, 6
    s_cselect_b32 s7, 0x7f000000, s7
    buffer_store_dwordx4 v[36:39], v2, s[28:31], s7 offen sc1
    v_mov_b32 v53, 0
    s_waitcnt lgkmcnt(0)
    s_add_u32 s7, s6, 122880
    s_cmp_ge_u32 s98, 6
    s_cselect_b32 s7, 0x7f000000, s7
    buffer_store_dwordx4 v[40:43], v2, s[28:31], s7 offen sc1
    v_mov_b32 v54, 0
    v_mov_b32 v55, 0
    v_dot2_f32_bf16 v48, v16, s99, v48
    v_dot2_f32_bf16 v49, v20, s99, v49
    v_dot2_f32_bf16 v50, v24, s99, v50
    v_dot2_f32_bf16 v51, v28, s99, v51
    v_dot2_f32_bf16 v52, v32, s99, v52
    v_dot2_f32_bf16 v53, v36, s99, v53
    v_dot2_f32_bf16 v54, v40, s99, v54
    v_dot2_f32_bf16 v48, v17, s99, v48
    v_dot2_f32_bf16 v49, v21, s99, v49
    v_dot2_f32_bf16 v50, v25, s99, v50
    v_dot2_f32_bf16 v51, v29, s99, v51
    v_dot2_f32_bf16 v52, v33, s99, v52
    v_dot2_f32_bf16 v53, v37, s99, v53
    v_dot2_f32_bf16 v54, v41, s99, v54
    v_dot2_f32_bf16 v48, v18, s99, v48
    v_dot2_f32_bf16 v49, v22, s99, v49
    v_dot2_f32_bf16 v50, v26, s99, v50
    v_dot2_f32_bf16 v51, v30, s99, v51
    v_dot2_f32_bf16 v52, v34, s99, v52
    v_dot2_f32_bf16 v53, v38, s99, v53
    v_dot2_f32_bf16 v54, v42, s99, v54
    v_dot2_f32_bf16 v48, v19, s99, v48
    v_dot2_f32_bf16 v49, v23, s99, v49
    v_dot2_f32_bf16 v50, v27, s99, v50
    v_dot2_f32_bf16 v51, v31, s99, v51
    v_dot2_f32_bf16 v52, v35, s99, v52
    v_dot2_f32_bf16 v53, v39, s99, v53
    v_dot2_f32_bf16 v54, v43, s99, v54
    s_nop 3
    v_permlane16_swap_b32 v48, v49
    v_permlane16_swap_b32 v50, v51
    v_permlane16_swap_b32 v52, v53
    v_permlane16_swap_b32 v54, v55
    v_add_f32 v48, v48, v49
    v_add_f32 v50, v50, v51
    v_add_f32 v52, v52, v53
    v_add_f32 v54, v54, v55
    v_permlane32_swap_b32 v48, v50
    s_nop 0
    v_permlane32_swap_b32 v52, v54
    v_add_f32 v48, v48, v50
    v_add_f32 v52, v52, v54
    s_mul_i32 s6, s4, 6912
    s_lshl_b32 s7, s60, 6
    s_add_u32 s6, s6, s7
    s_add_u32 s6, s6, 0x510000
    v_lshlrev_b32 v5, 2, v1
    buffer_store_dword v48, v5, s[28:31], s6 offen sc1
    s_cmp_ge_u32 s98, 6
    s_cselect_b32 exec_lo, 0xffff, -1
    s_cselect_b32 exec_hi, 0, 0xffff
    buffer_store_dword v52, v5, s[28:31], s6 offen offset:256 sc1
    s_mov_b64 exec, -1
Lw1_9:
    s_barrier
    s_waitcnt vmcnt(0)
    s_add_u32 s62, s41, 1
    v_mov_b32 v0, s62
    v_writelane_b32 v0, s27, 1
    v_lshlrev_b32 v5, 2, v1
    s_mov_b32 exec_hi, 0
    buffer_store_dword v0, v5, s[28:31], s45 offen sc1
    s_mov_b32 exec_hi, -1
Lp0j_3:
    s_nop 1
    s_lshl_b32 s6, s3, 6
    s_add_u32 s6, s6, 0
    v_add_u32 v0, s6, v1
    v_mul_u32_u24 v7, 5462, v0
    v_lshrrev_b32 v7, 16, v7
    v_lshlrev_b32 v0, 4, v0
    s_mov_b32 s7, 48960
    v_mad_u32_u24 v5, v7, s7, v0
    s_lshl_b32 s6, s3, 6
    s_add_u32 s6, s6, 512
    v_add_u32 v0, s6, v1
    v_mul_u32_u24 v7, 5462, v0
    v_lshrrev_b32 v7, 16, v7
    v_lshlrev_b32 v0, 4, v0
    s_mov_b32 s7, 48960
    v_mad_u32_u24 v6, v7, s7, v0
    s_lshl_b32 s67, s5, 10
    s_add_u32 s67, s67, 896
    s_waitcnt lgkmcnt(0)
    s_barrier
    s_lshl_b32 s6, s3, 10
    s_add_u32 s6, s6, 41984
    v_add_u32 v0, s6, v2
    ds_read_b128 v[64:67], v0
    ds_read_b128 v[68:71], v0 offset:8192
    s_lshl_b32 s6, s5, 5
    s_add_u32 s6, s6, s4
    s_mulk_i32 s6, 192
    s_add_u32 s6, s6, 0x960000
    s_cmp_lt_u32 s3, 4
    s_cselect_b32 s7, s6, 0x7f000000
    s_waitcnt lgkmcnt(1)
    buffer_store_dwordx4 v[64:67], v5, s[28:31], s6 offen sc1
    s_waitcnt lgkmcnt(0)
    buffer_store_dwordx4 v[68:71], v6, s[28:31], s7 offen sc1
    s_mul_i32 s98, s3, 14
    s_add_u32 s6, s3, 0
    s_sub_u32 s7, s98, 52
    s_cmp_ge_u32 s3, 4
    s_cselect_b32 s6, s7, s6
    s_cmp_eq_u32 s3, 7
    s_cselect_b32 s6, 46, s6
    s_lshl_b32 s7, s6, 12
    s_add_u32 s8, s7, s49
    s_mulk_i32 s6, 5120
    s_add_u32 s16, s6, s48
    s_add_u32 s6, s3, 7
    s_sub_u32 s7, s98, 51
    s_cmp_ge_u32 s3, 4
    s_cselect_b32 s6, s7, s6
    s_cmp_eq_u32 s3, 7
    s_cselect_b32 s6, 47, s6
    s_lshl_b32 s7, s6, 12
    s_add_u32 s9, s7, s49
    s_mulk_i32 s6, 5120
    s_add_u32 s17, s6, s48
    s_add_u32 s6, s3, 14
    s_sub_u32 s7, s98, 50
    s_cmp_ge_u32 s3, 4
    s_cselect_b32 s6, s7, s6
    s_cmp_eq_u32 s3, 7
    s_cselect_b32 s6, 52, s6
    s_lshl_b32 s7, s6, 12
    s_add_u32 s10, s7, s49
    s_mulk_i32 s6, 5120
    s_add_u32 s18, s6, s48
    s_add_u32 s6, s3, 21
    s_sub_u32 s7, s98, 45
    s_cmp_ge_u32 s3, 4
    s_cselect_b32 s6, s7, s6
    s_cmp_eq_u32 s3, 7
    s_cselect_b32 s6, 53, s6
    s_lshl_b32 s7, s6, 12
    s_add_u32 s11, s7, s49
    s_mulk_i32 s6, 5120
    s_add_u32 s19, s6, s48
    s_add_u32 s6, s3, 28
    s_sub_u32 s7, s98, 44
    s_cmp_ge_u32 s3, 4
    s_cselect_b32 s6, s7, s6
    s_cmp_eq_u32 s3, 7
    s_cselect_b32 s6, 262144, s6
    s_lshl_b32 s7, s6, 12
    s_add_u32 s12, s7, s49
    s_mulk_i32 s6, 5120
    s_add_u32 s20, s6, s48
    s_add_u32 s6, s3, 35
    s_sub_u32 s7, s98, 43
    s_cmp_ge_u32 s3, 4
    s_cselect_b32 s6, s7, s6
    s_cmp_eq_u32 s3, 7
    s_cselect_b32 s6, 262144, s6
    s_lshl_b32 s7, s6, 12
    s_add_u32 s13, s7, s49
    s_mulk_i32 s6, 5120
    s_add_u32 s21, s6, s48
    s_add_u32 s6, s3, 42
    s_lshl_b32 s7, s6, 12
    s_add_u32 s14, s7, s49
    s_mulk_i32 s6, 5120
    s_add_u32 s22, s6, s48
    s_add_u32 s6, s3, 48
    s_lshl_b32 s7, s6, 12
    s_add_u32 s15, s7, s49
    s_mulk_i32 s6, 5120
    s_add_u32 s23, s6, s48
    s_mul_i32 s68, s3, 5120
    s_mul_i32 s69, s3, 10240
    s_cmp_lt_u32 s5, 4
    s_cselect_b32 s58, 16384, 0
    s_add_u32 s58, s58, 114688
    v_lshlrev_b32 v7, 3, v1
    v_mov_b32 v76, 0
    v_mov_b32 v77, 0
    ds_write_b64 v7, v[76:77] offset:9472
    s_cmp_lt_u32 s3, 4
    s_cbranch_scc1 Lpa_10
    s_lshl_b32 s6, s38, 5
    v_add_u32 v5, s6, v10
    v_sub_u32 v11, 63, v5
    v_sub_u32 v12, 32, v10
    v_and_b32 v12, 31, v12
    v_sub_u32 v13, 63, v10
    s_cmp_eq_u32 s38, 0
    s_cselect_b64 vcc, -1, 0
    v_cndmask_b32 v12, v13, v12, vcc
    s_cmp_eq_u32 s4, 0
    s_cselect_b64 vcc, -1, 0
    v_cndmask_b32 v11, v11, v12, vcc
    s_cmp_eq_u32 s39, 1
    s_cselect_b64 vcc, -1, 0
    v_cndmask_b32 v5, v5, v11, vcc
    v_bfe_u32 v11, v1, 2, 1
    v_and_b32 v12, 1, v1
    v_lshlrev_b32 v12, 4, v12
    v_mov_b32 v13, 0x3f80
    v_lshlrev_b32 v12, v12, v13
    v_cmp_eq_u32 vcc, v11, v4
    s_nop 1
    v_cndmask_b32 v12, 0, v12, vcc
    v_bfe_u32 v13, v1, 1, 1
    v_bfe_u32 v11, v1, 3, 2
    v_lshl_add_u32 v13, v11, 1, v13
    v_cmp_eq_u32 vcc, 0, v13
    s_nop 1
    v_cndmask_b32 v84, 0, v12, vcc
    v_cmp_eq_u32 vcc, 1, v13
    s_nop 1
    v_cndmask_b32 v85, 0, v12, vcc
    v_cmp_eq_u32 vcc, 2, v13
    s_nop 1
    v_cndmask_b32 v86, 0, v12, vcc
    v_cmp_eq_u32 vcc, 3, v13
    s_nop 1
    v_cndmask_b32 v87, 0, v12, vcc
    v_cmp_eq_u32 vcc, 4, v13
    s_nop 1
    v_cndmask_b32 v88, 0, v12, vcc
    v_cmp_eq_u32 vcc, 5, v13
    s_nop 1
    v_cndmask_b32 v89, 0, v12, vcc
    v_cmp_eq_u32 vcc, 6, v13
    s_nop 1
    v_cndmask_b32 v90, 0, v12, vcc
    v_cmp_eq_u32 vcc, 7, v13
    s_nop 1
    v_cndmask_b32 v91, 0, v12, vcc
Lpa_10:
    s_waitcnt vmcnt(0) lgkmcnt(0)
    s_barrier
    s_cmp_lg_u32 s3, 0
    s_cbranch_scc1 Lnf_11
    s_add_u32 s62, s41, 1
    v_mov_b32 v0, s62
    v_writelane_b32 v0, s27, 1
    v_lshlrev_b32 v7, 2, v1
    s_mov_b32 exec_hi, 0
    buffer_store_dword v0, v7, s[28:31], s45 offen sc1
    s_mov_b32 exec_hi, -1
Lnf_11:
    s_cmp_ge_u32 s3, 4
    s_cbranch_scc1 Lctl_16
    s_setprio 0
    v_min_u32 v253, 31, v1
    v_lshlrev_b32 v253, 13, v253
    s_add_u32 s60, s67, 0x760000
    buffer_load_dword v253, v253, s[28:31], s60 offen sc1
    s_add_u32 s59, s41, 1
    s_waitcnt vmcnt(0)
    s_mov_b32 s61, 0
Lpoll_18:
    v_subrev_u32 v253, s59, v253
    v_cmp_le_u32 vcc, 16, v253
    s_cbranch_vccz Lpd_19
    s_sleep 2
    v_min_u32 v253, 31, v1
    v_lshlrev_b32 v253, 13, v253
    s_add_u32 s60, s67, 0x760000
    buffer_load_dword v253, v253, s[28:31], s60 offen sc1
    s_waitcnt vmcnt(0)
    s_add_u32 s61, s61, 1
    s_cmp_lt_u32 s61, 200000
    s_cbranch_scc1 Lpoll_18
Lpd_19:
    s_add_u32 s6, s3, 4
    s_add_u32 s66, s46, 163840
    s_cmp_ge_u32 s6, s43
    s_cselect_b32 s66, 0x7f000000, s66
    s_add_u32 s64, s46, 0
    buffer_load_dwordx4 v[88:91], v2, s[28:31], s64 offen sc1
    s_add_u32 m0, s69, 0
    s_add_u32 s64, s46, 20480
    buffer_load_dwordx4 v2, s[28:31], s64 offen sc1 lds
    s_add_u32 s64, s46, 1024
    buffer_load_dwordx4 v[92:95], v2, s[28:31], s64 offen sc1
    s_add_u32 m0, s69, 1024
    s_add_u32 s64, s46, 21504
    buffer_load_dwordx4 v2, s[28:31], s64 offen sc1 lds
    s_add_u32 s64, s46, 2048
    buffer_load_dwordx4 v[96:99], v2, s[28:31], s64 offen sc1
    s_add_u32 m0, s69, 2048
    s_add_u32 s64, s46, 22528
    buffer_load_dwordx4 v2, s[28:31], s64 offen sc1 lds
    s_add_u32 s64, s46, 3072
    buffer_load_dwordx4 v[100:103], v2, s[28:31], s64 offen sc1
    s_add_u32 m0, s69, 3072
    s_add_u32 s64, s46, 23552
    buffer_load_dwordx4 v2, s[28:31], s64 offen sc1 lds
    s_add_u32 s64, s46, 4096
    buffer_load_dwordx4 v[104:107], v2, s[28:31], s64 offen sc1
    s_waitcnt vmcnt(8)
    s_add_u32 m0, s69, 4096
    s_add_u32 s64, s46, 24576
    buffer_load_dwordx4 v2, s[28:31], s64 offen sc1 lds
    s_waitcnt vmcnt(8)
    s_add_u32 s64, s46, 5120
    buffer_load_dwordx4 v[108:111], v2, s[28:31], s64 offen sc1
    s_waitcnt vmcnt(8)
    s_add_u32 m0, s69, 5120
    s_add_u32 s64, s46, 25600
    buffer_load_dwordx4 v2, s[28:31], s64 offen sc1 lds
    s_waitcnt vmcnt(8)
    s_add_u32 s64, s46, 6144
    buffer_load_dwordx4 v[112:115], v2, s[28:31], s64 offen sc1
    s_waitcnt vmcnt(8)
    s_add_u32 m0, s69, 6144
    s_add_u32 s64, s46, 26624
    buffer_load_dwordx4 v2, s[28:31], s64 offen sc1 lds
    s_waitcnt vmcnt(8)
    s_add_u32 s64, s46, 7168
    buffer_load_dwordx4 v[116:119], v2, s[28:31], s64 offen sc1
    s_waitcnt vmcnt(8)
    s_add_u32 m0, s69, 7168
    s_add_u32 s64, s46, 27648
    buffer_load_dwordx4 v2, s[28:31], s64 offen sc1 lds
    s_waitcnt vmcnt(8)
    s_add_u32 s64, s46, 8192
    buffer_load_dwordx4 v[120:123], v2, s[28:31], s64 offen sc1
    s_waitcnt vmcnt(8)
    s_add_u32 m0, s69, 8192
    s_add_u32 s64, s46, 28672
    buffer_load_dwordx4 v2, s[28:31], s64 offen sc1 lds
    s_waitcnt vmcnt(8)
    s_add_u32 s64, s46, 9216
    buffer_load_dwordx4 v[124:127], v2, s[28:31], s64 offen sc1
    s_waitcnt vmcnt(8)
    s_add_u32 s64, s46, 10240
    buffer_load_dwordx4 v[128:131], v2, s[28:31], s64 offen sc1
    s_waitcnt vmcnt(8)
    s_add_u32 s64, s46, 11264
    buffer_load_dwordx4 v[132:135], v2, s[28:31], s64 offen sc1
    s_waitcnt vmcnt(8)
    s_add_u32 m0, s69, 40960
    s_add_u32 s64, s66, 20480
    buffer_load_dwordx4 v2, s[28:31], s64 offen sc1 lds
    s_waitcnt vmcnt(8)
    s_add_u32 m0, s69, 41984
    s_add_u32 s64, s66, 21504
    buffer_load_dwordx4 v2, s[28:31], s64 offen sc1 lds
    s_waitcnt vmcnt(8)
    s_add_u32 m0, s69, 43008
    s_add_u32 s64, s66, 22528
    buffer_load_dwordx4 v2, s[28:31], s64 offen sc1 lds
    s_waitcnt vmcnt(8)
    s_add_u32 m0, s69, 44032
    s_add_u32 s64, s66, 23552
    buffer_load_dwordx4 v2, s[28:31], s64 offen sc1 lds
    s_waitcnt vmcnt(8)
    s_add_u32 m0, s69, 45056
    s_add_u32 s64, s66, 24576
    buffer_load_dwordx4 v2, s[28:31], s64 offen sc1 lds
    s_waitcnt vmcnt(8)
    s_add_u32 m0, s69, 46080
    s_add_u32 s64, s66, 25600
    buffer_load_dwordx4 v2, s[28:31], s64 offen sc1 lds
    s_waitcnt vmcnt(8)
    s_add_u32 m0, s69, 47104
    s_add_u32 s64, s66, 26624
    buffer_load_dwordx4 v2, s[28:31], s64 offen sc1 lds
    s_waitcnt vmcnt(8)
    s_add_u32 m0, s69, 48128
    s_add_u32 s64, s66, 27648
    buffer_load_dwordx4 v2, s[28:31], s64 offen sc1 lds
    s_waitcnt vmcnt(8)
    s_add_u32 m0, s69, 49152
    s_add_u32 s64, s66, 28672
    buffer_load_dwordx4 v2, s[28:31], s64 offen sc1 lds
    s_waitcnt vmcnt(8)
    buffer_load_dwordx4 v[136:139], v2, s[28:31], s16 offen offset:0 sc1
    s_waitcnt vmcnt(8)
    buffer_load_dwordx4 v[140:143], v2, s[28:31], s16 offen offset:1024 sc1
    s_waitcnt vmcnt(8)
    buffer_load_dwordx4 v[144:147], v2, s[28:31], s16 offen offset:2048 sc1
    s_waitcnt vmcnt(8)
    buffer_load_dwordx4 v[148:151], v2, s[28:31], s16 offen offset:3072 sc1
    s_waitcnt vmcnt(8)
    s_add_u32 s64, s16, 4096
    buffer_load_dwordx4 v[152:155], v2, s[28:31], s64 offen sc1
    s_waitcnt vmcnt(8)
    buffer_load_dwordx4 v[156:159], v2, s[28:31], s17 offen offset:0 sc1
    s_waitcnt vmcnt(8)
    buffer_load_dwordx4 v[160:163], v2, s[28:31], s17 offen offset:1024 sc1
    s_waitcnt vmcnt(8)
    buffer_load_dwordx4 v[164:167], v2, s[28:31], s17 offen offset:2048 sc1
    s_waitcnt vmcnt(8)
    buffer_load_dwordx4 v[168:171], v2, s[28:31], s17 offen offset:3072 sc1
    s_waitcnt vmcnt(8)
    s_add_u32 s64, s17, 4096
    buffer_load_dwordx4 v[172:175], v2, s[28:31], s64 offen sc1
    s_waitcnt vmcnt(8)
    buffer_load_dwordx4 v[176:179], v2, s[28:31], s18 offen offset:0 sc1
    s_waitcnt vmcnt(8)
    buffer_load_dwordx4 v[180:183], v2, s[28:31], s18 offen offset:1024 sc1
    s_waitcnt vmcnt(8)
    buffer_load_dwordx4 v[184:187], v2, s[28:31], s18 offen offset:2048 sc1
    s_waitcnt vmcnt(8)
    buffer_load_dwordx4 v[188:191], v2, s[28:31], s18 offen offset:3072 sc1
    s_waitcnt vmcnt(8)
    s_add_u32 s64, s18, 4096
    buffer_load_dwordx4 v[192:195], v2, s[28:31], s64 offen sc1
    s_waitcnt vmcnt(8)
    buffer_load_dwordx4 v[196:199], v2, s[28:31], s19 offen offset:0 sc1
    s_waitcnt vmcnt(8)
    buffer_load_dwordx4 v[200:203], v2, s[28:31], s19 offen offset:1024 sc1
    s_waitcnt vmcnt(8)
    buffer_load_dwordx4 v[204:207], v2, s[28:31], s19 offen offset:2048 sc1
    s_waitcnt vmcnt(8)
    s_lshl_b32 s6, s42, 6
    v_lshl_add_u32 v7, v10, 2, s6
    s_movk_i32 s7, 6912
    v_mad_u32_u24 v7, v4, s7, v7
    s_mov_b32 s7, 0x510000
    buffer_load_dword v16, v7, s[28:31], s7 offen sc1
    s_mov_b32 s7, 0x513600
    buffer_load_dword v17, v7, s[28:31], s7 offen sc1
    s_mov_b32 s7, 0x516c00
    buffer_load_dword v18, v7, s[28:31], s7 offen sc1
    s_mov_b32 s7, 0x51a200
    buffer_load_dword v19, v7, s[28:31], s7 offen sc1
    s_mov_b32 s7, 0x51d800
    buffer_load_dword v20, v7, s[28:31], s7 offen sc1
    s_mov_b32 s7, 0x520e00
    buffer_load_dword v21, v7, s[28:31], s7 offen sc1
    s_mov_b32 s7, 0x524400
    buffer_load_dword v22, v7, s[28:31], s7 offen sc1
    s_mov_b32 s7, 0x527a00
    buffer_load_dword v23, v7, s[28:31], s7 offen sc1
    s_mov_b32 s7, 0x52b000
    buffer_load_dword v24, v7, s[28:31], s7 offen sc1
    s_mov_b32 s7, 0x52e600
    buffer_load_dword v25, v7, s[28:31], s7 offen sc1
    s_waitcnt vmcnt(0)
    v_add_f32 v16, v16, v17
    v_add_f32 v16, v16, v18
    v_add_f32 v16, v16, v19
    v_add_f32 v16, v16, v20
    v_add_f32 v16, v16, v21
    v_add_f32 v16, v16, v22
    v_add_f32 v16, v16, v23
    v_add_f32 v16, v16, v24
    v_add_f32 v16, v16, v25
    v_mov_b32 v15, v16
    s_nop 1
    v_permlane32_swap_b32 v16, v15
    v_add_f32 v15, v16, v15
    s_lshl_b32 s6, s3, 7
    v_lshl_add_u32 v7, v10, 2, s6
    ds_write_b32 v7, v15 offset:19456
    v_add_u32 v5, 81920, v3
    v_add_u32 v6, 122880, v3
    s_waitcnt lgkmcnt(0)
    s_barrier
    v_mov_b32 v7, 9744
    ds_read_b32 v7, v7
    s_waitcnt lgkmcnt(0)
    v_readfirstlane_b32 s26, v7
    s_nop 1
    s_cmp_eq_u32 s26, 0
    s_cselect_b32 s6, 0x80000, 0
    s_add_u32 s50, s50, s6
    s_add_u32 s53, s53, s6
    s_setprio 3
    v_add_u32 v13, s69, v2
    ds_read_b128 v[48:51], v5 offset:0
    ds_read_b128 v[52:55], v5 offset:256
    ds_read_b128 v[56:59], v5 offset:512
    ds_read_b128 v[60:63], v5 offset:768
    ds_read_b128 v[80:83], v13 offset:0
    s_add_u32 s56, s46, 12288
    s_add_u32 s57, s46, 16384
    s_waitcnt lgkmcnt(0)
    v_mfma_f32_16x16x32_bf16 v[16:19], v[88:91], v[48:51], 0
    ds_read_b128 v[64:67], v5 offset:4096
    v_mfma_f32_16x16x32_bf16 v[20:23], v[88:91], v[52:55], 0
    ds_read_b128 v[68:71], v5 offset:4352
    v_mfma_f32_16x16x32_bf16 v[24:27], v[88:91], v[56:59], 0
    ds_read_b128 v[72:75], v5 offset:4608
    v_mfma_f32_16x16x32_bf16 v[28:31], v[88:91], v[60:63], 0
    ds_read_b128 v[76:79], v5 offset:4864
    v_mfma_f32_16x16x32_bf16 v[32:35], v[80:83], v[48:51], 0
    ds_read_b128 v[84:87], v13 offset:1024
    v_mfma_f32_16x16x32_bf16 v[36:39], v[80:83], v[52:55], 0
    s_add_u32 m0, s69, 0
    s_add_u32 s66, s46, 29696
    buffer_load_dwordx4 v2, s[28:31], s66 offen offset:0 sc1 lds
    v_mfma_f32_16x16x32_bf16 v[40:43], v[80:83], v[56:59], 0
    buffer_load_dwordx4 v[88:91], v2, s[28:31], s56 offen offset:0 sc1
    v_mfma_f32_16x16x32_bf16 v[44:47], v[80:83], v[60:63], 0
    s_waitcnt lgkmcnt(0)
    v_mfma_f32_16x16x32_bf16 v[16:19], v[92:95], v[64:67], v[16:19]
    ds_read_b128 v[48:51], v5 offset:8192
    v_mfma_f32_16x16x32_bf16 v[20:23], v[92:95], v[68:71], v[20:23]
    ds_read_b128 v[52:55], v5 offset:8448
    v_mfma_f32_16x16x32_bf16 v[24:27], v[92:95], v[72:75], v[24:27]
    ds_read_b128 v[56:59], v5 offset:8704
    v_mfma_f32_16x16x32_bf16 v[28:31], v[92:95], v[76:79], v[28:31]
    ds_read_b128 v[60:63], v5 offset:8960
    v_mfma_f32_16x16x32_bf16 v[32:35], v[84:87], v[64:67], v[32:35]
    ds_read_b128 v[80:83], v13 offset:2048
    v_mfma_f32_16x16x32_bf16 v[36:39], v[84:87], v[68:71], v[36:39]
    buffer_load_dwordx4 v2, s[28:31], s66 offen offset:1024 sc1 lds
    v_mfma_f32_16x16x32_bf16 v[40:43], v[84:87], v[72:75], v[40:43]
    buffer_load_dwordx4 v[92:95], v2, s[28:31], s56 offen offset:1024 sc1
    v_mfma_f32_16x16x32_bf16 v[44:47], v[84:87], v[76:79], v[44:47]
    s_waitcnt lgkmcnt(0)
    v_mfma_f32_16x16x32_bf16 v[16:19], v[96:99], v[48:51], v[16:19]
    ds_read_b128 v[64:67], v5 offset:12288
    v_mfma_f32_16x16x32_bf16 v[20:23], v[96:99], v[52:55], v[20:23]
    ds_read_b128 v[68:71], v5 offset:12544
    v_mfma_f32_16x16x32_bf16 v[24:27], v[96:99], v[56:59], v[24:27]
    ds_read_b128 v[72:75], v5 offset:12800
    v_mfma_f32_16x16x32_bf16 v[28:31], v[96:99], v[60:63], v[28:31]
    ds_read_b128 v[76:79], v5 offset:13056
    v_mfma_f32_16x16x32_bf16 v[32:35], v[80:83], v[48:51], v[32:35]
    ds_read_b128 v[84:87], v13 offset:3072
    v_mfma_f32_16x16x32_bf16 v[36:39], v[80:83], v[52:55], v[36:39]
    buffer_load_dwordx4 v2, s[28:31], s66 offen offset:2048 sc1 lds
    v_mfma_f32_16x16x32_bf16 v[40:43], v[80:83], v[56:59], v[40:43]
    buffer_load_dwordx4 v[96:99], v2, s[28:31], s56 offen offset:2048 sc1
    v_mfma_f32_16x16x32_bf16 v[44:47], v[80:83], v[60:63], v[44:47]
    s_waitcnt lgkmcnt(0)
    v_mfma_f32_16x16x32_bf16 v[16:19], v[100:103], v[64:67], v[16:19]
    ds_read_b128 v[48:51], v5 offset:16384
    v_mfma_f32_16x16x32_bf16 v[20:23], v[100:103], v[68:71], v[20:23]
    ds_read_b128 v[52:55], v5 offset:16640
    v_mfma_f32_16x16x32_bf16 v[24:27], v[100:103], v[72:75], v[24:27]
    ds_read_b128 v[56:59], v5 offset:16896
    v_mfma_f32_16x16x32_bf16 v[28:31], v[100:103], v[76:79], v[28:31]
    ds_read_b128 v[60:63], v5 offset:17152
    v_mfma_f32_16x16x32_bf16 v[32:35], v[84:87], v[64:67], v[32:35]
    ds_read_b128 v[80:83], v13 offset:4096
    v_mfma_f32_16x16x32_bf16 v[36:39], v[84:87], v[68:71], v[36:39]
    buffer_load_dwordx4 v2, s[28:31], s66 offen offset:3072 sc1 lds
    v_mfma_f32_16x16x32_bf16 v[40:43], v[84:87], v[72:75], v[40:43]
    buffer_load_dwordx4 v[100:103], v2, s[28:31], s56 offen offset:3072 sc1
    v_mfma_f32_16x16x32_bf16 v[44:47], v[84:87], v[76:79], v[44:47]
    s_waitcnt lgkmcnt(0)
    v_mfma_f32_16x16x32_bf16 v[16:19], v[104:107], v[48:51], v[16:19]
    ds_read_b128 v[64:67], v5 offset:20480
    v_mfma_f32_16x16x32_bf16 v[20:23], v[104:107], v[52:55], v[20:23]
    ds_read_b128 v[68:71], v5 offset:20736
    v_mfma_f32_16x16x32_bf16 v[24:27], v[104:107], v[56:59], v[24:27]
    ds_read_b128 v[72:75], v5 offset:20992
    v_mfma_f32_16x16x32_bf16 v[28:31], v[104:107], v[60:63], v[28:31]
    ds_read_b128 v[76:79], v5 offset:21248
    v_mfma_f32_16x16x32_bf16 v[32:35], v[80:83], v[48:51], v[32:35]
    ds_read_b128 v[84:87], v13 offset:5120
    v_mfma_f32_16x16x32_bf16 v[36:39], v[80:83], v[52:55], v[36:39]
    s_add_u32 m0, s69, 4096
    s_add_u32 s66, s46, 33792
    buffer_load_dwordx4 v2, s[28:31], s66 offen offset:0 sc1 lds
    v_mfma_f32_16x16x32_bf16 v[40:43], v[80:83], v[56:59], v[40:43]
    buffer_load_dwordx4 v[104:107], v2, s[28:31], s57 offen offset:0 sc1
    v_mfma_f32_16x16x32_bf16 v[44:47], v[80:83], v[60:63], v[44:47]
    s_waitcnt lgkmcnt(0)
    v_mfma_f32_16x16x32_bf16 v[16:19], v[108:111], v[64:67], v[16:19]
    ds_read_b128 v[48:51], v5 offset:24576
    v_mfma_f32_16x16x32_bf16 v[20:23], v[108:111], v[68:71], v[20:23]
    ds_read_b128 v[52:55], v5 offset:24832
    v_mfma_f32_16x16x32_bf16 v[24:27], v[108:111], v[72:75], v[24:27]
    ds_read_b128 v[56:59], v5 offset:25088
    v_mfma_f32_16x16x32_bf16 v[28:31], v[108:111], v[76:79], v[28:31]
    ds_read_b128 v[60:63], v5 offset:25344
    v_mfma_f32_16x16x32_bf16 v[32:35], v[84:87], v[64:67], v[32:35]
    ds_read_b128 v[80:83], v13 offset:6144
    v_mfma_f32_16x16x32_bf16 v[36:39], v[84:87], v[68:71], v[36:39]
    buffer_load_dwordx4 v2, s[28:31], s66 offen offset:1024 sc1 lds
    v_mfma_f32_16x16x32_bf16 v[40:43], v[84:87], v[72:75], v[40:43]
    buffer_load_dwordx4 v[108:111], v2, s[28:31], s57 offen offset:1024 sc1
    v_mfma_f32_16x16x32_bf16 v[44:47], v[84:87], v[76:79], v[44:47]
    v_mov_b32 v7, 9728
    ds_read_b32 v7, v7
    s_waitcnt lgkmcnt(1)
    v_mfma_f32_16x16x32_bf16 v[16:19], v[112:115], v[48:51], v[16:19]
    ds_read_b128 v[64:67], v5 offset:28672
    v_mfma_f32_16x16x32_bf16 v[20:23], v[112:115], v[52:55], v[20:23]
    ds_read_b128 v[68:71], v5 offset:28928
    v_mfma_f32_16x16x32_bf16 v[24:27], v[112:115], v[56:59], v[24:27]
    ds_read_b128 v[72:75], v5 offset:29184
    v_mfma_f32_16x16x32_bf16 v[28:31], v[112:115], v[60:63], v[28:31]
    ds_read_b128 v[76:79], v5 offset:29440
    v_mfma_f32_16x16x32_bf16 v[32:35], v[80:83], v[48:51], v[32:35]
    ds_read_b128 v[84:87], v13 offset:7168
    v_mfma_f32_16x16x32_bf16 v[36:39], v[80:83], v[52:55], v[36:39]
    buffer_load_dwordx4 v2, s[28:31], s66 offen offset:2048 sc1 lds
    v_mfma_f32_16x16x32_bf16 v[40:43], v[80:83], v[56:59], v[40:43]
    buffer_load_dwordx4 v[112:115], v2, s[28:31], s57 offen offset:2048 sc1
    v_mfma_f32_16x16x32_bf16 v[44:47], v[80:83], v[60:63], v[44:47]
    s_waitcnt lgkmcnt(5)
    v_cmp_gt_u32 vcc, 4, v7
    s_cbranch_vccz Lcd_21
    s_mov_b32 s61, 0
Lcw_20:
    v_mov_b32 v7, 9728
    ds_read_b32 v7, v7
    s_waitcnt lgkmcnt(0)
    v_cmp_gt_u32 vcc, 4, v7
    s_cbranch_vccz Lcd_21
    s_sleep 1
    s_add_u32 s61, s61, 1
    s_cmp_lt_u32 s61, 200000
    s_cbranch_scc1 Lcw_20
Lcd_21:
    s_waitcnt lgkmcnt(0)
    v_mfma_f32_16x16x32_bf16 v[16:19], v[116:119], v[64:67], v[16:19]
    ds_read_b128 v[48:51], v5 offset:32768
    v_mfma_f32_16x16x32_bf16 v[20:23], v[116:119], v[68:71], v[20:23]
    ds_read_b128 v[52:55], v5 offset:33024
    v_mfma_f32_16x16x32_bf16 v[24:27], v[116:119], v[72:75], v[24:27]
    ds_read_b128 v[56:59], v5 offset:33280
    v_mfma_f32_16x16x32_bf16 v[28:31], v[116:119], v[76:79], v[28:31]
    ds_read_b128 v[60:63], v5 offset:33536
    v_mfma_f32_16x16x32_bf16 v[32:35], v[84:87], v[64:67], v[32:35]
    ds_read_b128 v[80:83], v13 offset:8192
    v_mfma_f32_16x16x32_bf16 v[36:39], v[84:87], v[68:71], v[36:39]
    buffer_load_dwordx4 v2, s[28:31], s66 offen offset:3072 sc1 lds
    v_mfma_f32_16x16x32_bf16 v[40:43], v[84:87], v[72:75], v[40:43]
    buffer_load_dwordx4 v[116:119], v2, s[28:31], s57 offen offset:3072 sc1
    v_mfma_f32_16x16x32_bf16 v[44:47], v[84:87], v[76:79], v[44:47]
    s_waitcnt vmcnt(15) lgkmcnt(0)
    v_mfma_f32_16x16x32_bf16 v[16:19], v[120:123], v[48:51], v[16:19]
    ds_read_b128 v[64:67], v5 offset:36864
    v_mfma_f32_16x16x32_bf16 v[20:23], v[120:123], v[52:55], v[20:23]
    ds_read_b128 v[68:71], v5 offset:37120
    v_mfma_f32_16x16x32_bf16 v[24:27], v[120:123], v[56:59], v[24:27]
    ds_read_b128 v[72:75], v5 offset:37376
    v_mfma_f32_16x16x32_bf16 v[28:31], v[120:123], v[60:63], v[28:31]
    ds_read_b128 v[76:79], v5 offset:37632
    v_mfma_f32_16x16x32_bf16 v[32:35], v[80:83], v[48:51], v[32:35]
    ds_read_b128 v[84:87], v13 offset:0
    v_mfma_f32_16x16x32_bf16 v[36:39], v[80:83], v[52:55], v[36:39]
    s_add_u32 m0, s69, 8192
    s_add_u32 s66, s46, 37888
    buffer_load_dwordx4 v2, s[28:31], s66 offen offset:0 sc1 lds
    v_mfma_f32_16x16x32_bf16 v[40:43], v[80:83], v[56:59], v[40:43]
    buffer_load_dwordx4 v[208:211], v2, s[28:31], s19 offen offset:3072 sc1
    v_mfma_f32_16x16x32_bf16 v[44:47], v[80:83], v[60:63], v[44:47]
    s_waitcnt vmcnt(15) lgkmcnt(0)
    v_mfma_f32_16x16x32_bf16 v[16:19], v[124:127], v[64:67], v[16:19]
    ds_read_b128 v[48:51], v6 offset:0
    v_mfma_f32_16x16x32_bf16 v[20:23], v[124:127], v[68:71], v[20:23]
    ds_read_b128 v[52:55], v6 offset:256
    v_mfma_f32_16x16x32_bf16 v[24:27], v[124:127], v[72:75], v[24:27]
    ds_read_b128 v[56:59], v6 offset:512
    v_mfma_f32_16x16x32_bf16 v[28:31], v[124:127], v[76:79], v[28:31]
    ds_read_b128 v[60:63], v6 offset:768
    v_mfma_f32_16x16x32_bf16 v[32:35], v[84:87], v[64:67], v[32:35]
    ds_read_b128 v[80:83], v13 offset:1024
    v_mfma_f32_16x16x32_bf16 v[36:39], v[84:87], v[68:71], v[36:39]
    s_add_u32 m0, s69, 0
    s_add_u32 s66, s46, 38912
    buffer_load_dwordx4 v2, s[28:31], s66 offen offset:0 sc1 lds
    v_mfma_f32_16x16x32_bf16 v[40:43], v[84:87], v[72:75], v[40:43]
    s_add_u32 s64, s19, 4096
    buffer_load_dwordx4 v[212:215], v2, s[28:31], s64 offen sc1
    v_mfma_f32_16x16x32_bf16 v[44:47], v[84:87], v[76:79], v[44:47]
    s_waitcnt vmcnt(15) lgkmcnt(0)
    v_mfma_f32_16x16x32_bf16 v[16:19], v[128:131], v[48:51], v[16:19]
    ds_read_b128 v[64:67], v6 offset:4096
    v_mfma_f32_16x16x32_bf16 v[20:23], v[128:131], v[52:55], v[20:23]
    ds_read_b128 v[68:71], v6 offset:4352
    v_mfma_f32_16x16x32_bf16 v[24:27], v[128:131], v[56:59], v[24:27]
    ds_read_b128 v[72:75], v6 offset:4608
    v_mfma_f32_16x16x32_bf16 v[28:31], v[128:131], v[60:63], v[28:31]
    ds_read_b128 v[76:79], v6 offset:4864
    v_mfma_f32_16x16x32_bf16 v[32:35], v[80:83], v[48:51], v[32:35]
    ds_read_b128 v[84:87], v13 offset:2048
    v_mfma_f32_16x16x32_bf16 v[36:39], v[80:83], v[52:55], v[36:39]
    buffer_load_dwordx4 v2, s[28:31], s66 offen offset:1024 sc1 lds
    v_mfma_f32_16x16x32_bf16 v[40:43], v[80:83], v[56:59], v[40:43]
    buffer_load_dwordx4 v[216:219], v2, s[28:31], s20 offen offset:0 sc1
    v_mfma_f32_16x16x32_bf16 v[44:47], v[80:83], v[60:63], v[44:47]
    s_waitcnt vmcnt(15) lgkmcnt(0)
    v_mfma_f32_16x16x32_bf16 v[16:19], v[132:135], v[64:67], v[16:19]
    ds_read_b128 v[48:51], v6 offset:8192
    v_mfma_f32_16x16x32_bf16 v[20:23], v[132:135], v[68:71], v[20:23]
    ds_read_b128 v[52:55], v6 offset:8448
    v_mfma_f32_16x16x32_bf16 v[24:27], v[132:135], v[72:75], v[24:27]
    ds_read_b128 v[56:59], v6 offset:8704
    v_mfma_f32_16x16x32_bf16 v[28:31], v[132:135], v[76:79], v[28:31]
    ds_read_b128 v[60:63], v6 offset:8960
    v_mfma_f32_16x16x32_bf16 v[32:35], v[84:87], v[64:67], v[32:35]
    ds_read_b128 v[80:83], v13 offset:3072
    v_mfma_f32_16x16x32_bf16 v[36:39], v[84:87], v[68:71], v[36:39]
    buffer_load_dwordx4 v[220:223], v2, s[28:31], s20 offen offset:1024 sc1
    v_mfma_f32_16x16x32_bf16 v[40:43], v[84:87], v[72:75], v[40:43]
    buffer_load_dwordx4 v[224:227], v2, s[28:31], s20 offen offset:2048 sc1
    v_mfma_f32_16x16x32_bf16 v[44:47], v[84:87], v[76:79], v[44:47]
    s_waitcnt vmcnt(15) lgkmcnt(0)
    v_mfma_f32_16x16x32_bf16 v[16:19], v[88:91], v[48:51], v[16:19]
    ds_read_b128 v[64:67], v6 offset:12288
    ds_read_b128 v[68:71], v6 offset:12544
    v_mfma_f32_16x16x32_bf16 v[20:23], v[88:91], v[52:55], v[20:23]
    ds_read_b128 v[72:75], v6 offset:12800
    v_mfma_f32_16x16x32_bf16 v[24:27], v[88:91], v[56:59], v[24:27]
    ds_read_b128 v[76:79], v6 offset:13056
    v_mfma_f32_16x16x32_bf16 v[28:31], v[88:91], v[60:63], v[28:31]
    ds_read_b128 v[84:87], v13 offset:4096
    v_mfma_f32_16x16x32_bf16 v[32:35], v[80:83], v[48:51], v[32:35]
    buffer_load_dwordx4 v[228:231], v2, s[28:31], s20 offen offset:3072 sc1
    v_mfma_f32_16x16x32_bf16 v[36:39], v[80:83], v[52:55], v[36:39]
    s_add_u32 s64, s20, 4096
    buffer_load_dwordx4 v[232:235], v2, s[28:31], s64 offen sc1
    v_mfma_f32_16x16x32_bf16 v[40:43], v[80:83], v[56:59], v[40:43]
    buffer_load_dwordx4 v[120:123], v2, s[28:31], s23 offen offset:1024 sc1
    v_mfma_f32_16x16x32_bf16 v[44:47], v[80:83], v[60:63], v[44:47]
    buffer_load_dwordx4 v[124:127], v2, s[28:31], s23 offen offset:2048 sc1
    s_waitcnt vmcnt(17) lgkmcnt(0)
    v_mfma_f32_16x16x32_bf16 v[16:19], v[92:95], v[64:67], v[16:19]
    ds_read_b128 v[48:51], v6 offset:16384
    ds_read_b128 v[52:55], v6 offset:16640
    v_mfma_f32_16x16x32_bf16 v[20:23], v[92:95], v[68:71], v[20:23]
    ds_read_b128 v[56:59], v6 offset:16896
    v_mfma_f32_16x16x32_bf16 v[24:27], v[92:95], v[72:75], v[24:27]
    ds_read_b128 v[60:63], v6 offset:17152
    v_mfma_f32_16x16x32_bf16 v[28:31], v[92:95], v[76:79], v[28:31]
    ds_read_b128 v[80:83], v13 offset:5120
    v_mfma_f32_16x16x32_bf16 v[32:35], v[84:87], v[64:67], v[32:35]
    buffer_load_dwordx4 v[236:239], v2, s[28:31], s21 offen offset:0 sc1
    v_mfma_f32_16x16x32_bf16 v[36:39], v[84:87], v[68:71], v[36:39]
    buffer_load_dwordx4 v[240:243], v2, s[28:31], s21 offen offset:1024 sc1
    v_mfma_f32_16x16x32_bf16 v[40:43], v[84:87], v[72:75], v[40:43]
    buffer_load_dwordx4 v[128:131], v2, s[28:31], s23 offen offset:3072 sc1
    v_mfma_f32_16x16x32_bf16 v[44:47], v[84:87], v[76:79], v[44:47]
    s_add_u32 s64, s23, 4096
    buffer_load_dwordx4 v[132:135], v2, s[28:31], s64 offen sc1
    s_waitcnt vmcnt(19) lgkmcnt(0)
    v_mfma_f32_16x16x32_bf16 v[16:19], v[96:99], v[48:51], v[16:19]
    ds_read_b128 v[64:67], v6 offset:20480
    v_mfma_f32_16x16x32_bf16 v[20:23], v[96:99], v[52:55], v[20:23]
    ds_read_b128 v[68:71], v6 offset:20736
    v_mfma_f32_16x16x32_bf16 v[24:27], v[96:99], v[56:59], v[24:27]
    ds_read_b128 v[72:75], v6 offset:20992
    v_mfma_f32_16x16x32_bf16 v[28:31], v[96:99], v[60:63], v[28:31]
    ds_read_b128 v[76:79], v6 offset:21248
    v_mfma_f32_16x16x32_bf16 v[32:35], v[80:83], v[48:51], v[32:35]
    ds_read_b128 v[84:87], v13 offset:6144
    v_mfma_f32_16x16x32_bf16 v[36:39], v[80:83], v[52:55], v[36:39]
    buffer_load_dwordx4 v[244:247], v2, s[28:31], s21 offen offset:2048 sc1
    v_mfma_f32_16x16x32_bf16 v[40:43], v[80:83], v[56:59], v[40:43]
    buffer_load_dwordx4 v[248:251], v2, s[28:31], s21 offen offset:3072 sc1
    v_mfma_f32_16x16x32_bf16 v[44:47], v[80:83], v[60:63], v[44:47]
    s_waitcnt vmcnt(19) lgkmcnt(0)
    v_mfma_f32_16x16x32_bf16 v[16:19], v[100:103], v[64:67], v[16:19]
    ds_read_b128 v[48:51], v6 offset:24576
    v_mfma_f32_16x16x32_bf16 v[20:23], v[100:103], v[68:71], v[20:23]
    ds_read_b128 v[52:55], v6 offset:24832
    v_mfma_f32_16x16x32_bf16 v[24:27], v[100:103], v[72:75], v[24:27]
    ds_read_b128 v[56:59], v6 offset:25088
    v_mfma_f32_16x16x32_bf16 v[28:31], v[100:103], v[76:79], v[28:31]
    ds_read_b128 v[60:63], v6 offset:25344
    v_mfma_f32_16x16x32_bf16 v[32:35], v[84:87], v[64:67], v[32:35]
    ds_read_b128 v[80:83], v13 offset:7168
    v_mfma_f32_16x16x32_bf16 v[36:39], v[84:87], v[68:71], v[36:39]
    s_add_u32 s64, s21, 4096
    buffer_load_dwordx4 v[252:255], v2, s[28:31], s64 offen sc1
    v_mfma_f32_16x16x32_bf16 v[40:43], v[84:87], v[72:75], v[40:43]
    buffer_load_dwordx4 v[96:99], v2, s[28:31], s22 offen offset:0 sc1
    v_mfma_f32_16x16x32_bf16 v[44:47], v[84:87], v[76:79], v[44:47]
    s_waitcnt vmcnt(19) lgkmcnt(0)
    v_mfma_f32_16x16x32_bf16 v[16:19], v[104:107], v[48:51], v[16:19]
    ds_read_b128 v[64:67], v6 offset:28672
    v_mfma_f32_16x16x32_bf16 v[20:23], v[104:107], v[52:55], v[20:23]
    ds_read_b128 v[68:71], v6 offset:28928
    v_mfma_f32_16x16x32_bf16 v[24:27], v[104:107], v[56:59], v[24:27]
    ds_read_b128 v[72:75], v6 offset:29184
    v_mfma_f32_16x16x32_bf16 v[28:31], v[104:107], v[60:63], v[28:31]
    ds_read_b128 v[76:79], v6 offset:29440
    v_mfma_f32_16x16x32_bf16 v[32:35], v[80:83], v[48:51], v[32:35]
    ds_read_b128 v[84:87], v13 offset:8192
    v_mfma_f32_16x16x32_bf16 v[36:39], v[80:83], v[52:55], v[36:39]
    buffer_load_dwordx4 v[100:103], v2, s[28:31], s22 offen offset:1024 sc1
    v_mfma_f32_16x16x32_bf16 v[40:43], v[80:83], v[56:59], v[40:43]
    v_mfma_f32_16x16x32_bf16 v[44:47], v[80:83], v[60:63], v[44:47]
    s_waitcnt vmcnt(18) lgkmcnt(0)
    v_mfma_f32_16x16x32_bf16 v[16:19], v[108:111], v[64:67], v[16:19]
    ds_read_b128 v[48:51], v6 offset:32768
    v_mfma_f32_16x16x32_bf16 v[20:23], v[108:111], v[68:71], v[20:23]
    ds_read_b128 v[52:55], v6 offset:33024
    v_mfma_f32_16x16x32_bf16 v[24:27], v[108:111], v[72:75], v[24:27]
    ds_read_b128 v[56:59], v6 offset:33280
    v_mfma_f32_16x16x32_bf16 v[28:31], v[108:111], v[76:79], v[28:31]
    ds_read_b128 v[60:63], v6 offset:33536
    v_mfma_f32_16x16x32_bf16 v[32:35], v[84:87], v[64:67], v[32:35]
    ds_read_b128 v[80:83], v13 offset:0
    v_mfma_f32_16x16x32_bf16 v[36:39], v[84:87], v[68:71], v[36:39]
    buffer_load_dwordx4 v[104:107], v2, s[28:31], s22 offen offset:2048 sc1
    v_mfma_f32_16x16x32_bf16 v[40:43], v[84:87], v[72:75], v[40:43]
    v_mfma_f32_16x16x32_bf16 v[44:47], v[84:87], v[76:79], v[44:47]
    s_waitcnt vmcnt(17) lgkmcnt(0)
    v_mfma_f32_16x16x32_bf16 v[16:19], v[112:115], v[48:51], v[16:19]
    ds_read_b128 v[64:67], v6 offset:36864
    v_mfma_f32_16x16x32_bf16 v[20:23], v[112:115], v[52:55], v[20:23]
    ds_read_b128 v[68:71], v6 offset:37120
    v_mfma_f32_16x16x32_bf16 v[24:27], v[112:115], v[56:59], v[24:27]
    ds_read_b128 v[72:75], v6 offset:37376
    v_mfma_f32_16x16x32_bf16 v[28:31], v[112:115], v[60:63], v[28:31]
    ds_read_b128 v[76:79], v6 offset:37632
    v_mfma_f32_16x16x32_bf16 v[32:35], v[80:83], v[48:51], v[32:35]
    ds_read_b128 v[84:87], v13 offset:1024
    v_mfma_f32_16x16x32_bf16 v[36:39], v[80:83], v[52:55], v[36:39]
    buffer_load_dwordx4 v[108:111], v2, s[28:31], s22 offen offset:3072 sc1
    v_mfma_f32_16x16x32_bf16 v[40:43], v[80:83], v[56:59], v[40:43]
    v_mfma_f32_16x16x32_bf16 v[44:47], v[80:83], v[60:63], v[44:47]
    s_waitcnt lgkmcnt(0)
    v_mfma_f32_16x16x32_bf16 v[16:19], v[116:119], v[64:67], v[16:19]
    s_lshl_b32 s6, s3, 7
    v_lshl_add_u32 v7, v9, 4, s6
    ds_read_b128 v[48:51], v7 offset:19456
    ds_read_b128 v[52:55], v7 offset:19520
    v_mfma_f32_16x16x32_bf16 v[20:23], v[116:119], v[68:71], v[20:23]
    v_lshlrev_b32 v7, 2, v8
    ds_read_b32 v60, v7 offset:9472
    ds_read_b32 v61, v7 offset:9536
    ds_read_b32 v62, v7 offset:9600
    ds_read_b32 v63, v7 offset:9664
    ds_read_b32 v56, v7 offset:9216
    ds_read_b32 v57, v7 offset:9280
    ds_read_b32 v58, v7 offset:9344
    ds_read_b32 v59, v7 offset:9408
    v_mfma_f32_16x16x32_bf16 v[24:27], v[116:119], v[72:75], v[24:27]
    v_mfma_f32_16x16x32_bf16 v[28:31], v[116:119], v[76:79], v[28:31]
    v_mfma_f32_16x16x32_bf16 v[32:35], v[84:87], v[64:67], v[32:35]
    v_mfma_f32_16x16x32_bf16 v[36:39], v[84:87], v[68:71], v[36:39]
    v_mfma_f32_16x16x32_bf16 v[40:43], v[84:87], v[72:75], v[40:43]
    v_mfma_f32_16x16x32_bf16 v[44:47], v[84:87], v[76:79], v[44:47]
    s_setprio 3
    s_lshl_b32 s65, s42, 11
    s_add_u32 s65, s65, s49
    s_add_u32 s65, s65, 0x16e0000
    s_mov_b32 s61, 0
Lsw_22:
    s_waitcnt lgkmcnt(0)
    v_min_u32 v7, v60, v61
    v_min3_u32 v7, v7, v62, v63
    v_cmp_eq_u32 vcc, 0, v7
    s_cbranch_vccz Lsd_23
    s_sleep 1
    v_lshlrev_b32 v7, 2, v8
    ds_read_b32 v60, v7 offset:9472
    ds_read_b32 v61, v7 offset:9536
    ds_read_b32 v62, v7 offset:9600
    ds_read_b32 v63, v7 offset:9664
    ds_read_b32 v56, v7 offset:9216
    ds_read_b32 v57, v7 offset:9280
    ds_read_b32 v58, v7 offset:9344
    ds_read_b32 v59, v7 offset:9408
    s_add_u32 s61, s61, 1
    s_cmp_lt_u32 s61, 200000
    s_cbranch_scc1 Lsw_22
    s_waitcnt lgkmcnt(0)
Lsd_23:
    v_lshlrev_b32 v7, 10, v4
    v_lshl_add_u32 v7, v10, 4, v7
    v_fma_f32 v16, -v56, v48, v16
    v_fma_f32 v17, -v56, v49, v17
    v_fma_f32 v18, -v56, v50, v18
    v_fma_f32 v19, -v56, v51, v19
    v_fma_f32 v20, -v57, v48, v20
    v_fma_f32 v21, -v57, v49, v21
    v_fma_f32 v22, -v57, v50, v22
    v_fma_f32 v23, -v57, v51, v23
    v_mul_f32 v16, v16, v60
    v_mul_f32 v17, v17, v60
    v_mul_f32 v18, v18, v60
    v_mul_f32 v19, v19, v60
    v_mul_f32 v20, v20, v61
    v_mul_f32 v21, v21, v61
    v_mul_f32 v22, v22, v61
    v_mul_f32 v23, v23, v61
    v_cvt_pk_bf16_f32 v16, v16, v17
    v_cvt_pk_bf16_f32 v17, v18, v19
    v_cvt_pk_bf16_f32 v18, v20, v21
    v_cvt_pk_bf16_f32 v19, v22, v23
    v_pk_max_i16 v16, v16, 0
    v_pk_max_i16 v17, v17, 0
    v_pk_max_i16 v18, v18, 0
    v_pk_max_i16 v19, v19, 0
    s_nop 0
    v_permlane16_swap_b32 v16, v18
    v_permlane16_swap_b32 v17, v19
    buffer_store_dwordx4 v[16:19], v7, s[28:31], s65 offen offset:0 sc1
    v_fma_f32 v24, -v58, v48, v24
    v_fma_f32 v25, -v58, v49, v25
    v_fma_f32 v26, -v58, v50, v26
    v_fma_f32 v27, -v58, v51, v27
    v_fma_f32 v28, -v59, v48, v28
    v_fma_f32 v29, -v59, v49, v29
    v_fma_f32 v30, -v59, v50, v30
    v_fma_f32 v31, -v59, v51, v31
    v_mul_f32 v24, v24, v62
    v_mul_f32 v25, v25, v62
    v_mul_f32 v26, v26, v62
    v_mul_f32 v27, v27, v62
    v_mul_f32 v28, v28, v63
    v_mul_f32 v29, v29, v63
    v_mul_f32 v30, v30, v63
    v_mul_f32 v31, v31, v63
    v_cvt_pk_bf16_f32 v24, v24, v25
    v_cvt_pk_bf16_f32 v25, v26, v27
    v_cvt_pk_bf16_f32 v26, v28, v29
    v_cvt_pk_bf16_f32 v27, v30, v31
    v_pk_max_i16 v24, v24, 0
    v_pk_max_i16 v25, v25, 0
    v_pk_max_i16 v26, v26, 0
    v_pk_max_i16 v27, v27, 0
    s_nop 0
    v_permlane16_swap_b32 v24, v26
    v_permlane16_swap_b32 v25, v27
    buffer_store_dwordx4 v[24:27], v7, s[28:31], s65 offen offset:512 sc1
    v_fma_f32 v32, -v56, v52, v32
    v_fma_f32 v33, -v56, v53, v33
    v_fma_f32 v34, -v56, v54, v34
    v_fma_f32 v35, -v56, v55, v35
    v_fma_f32 v36, -v57, v52, v36
    v_fma_f32 v37, -v57, v53, v37
    v_fma_f32 v38, -v57, v54, v38
    v_fma_f32 v39, -v57, v55, v39
    v_mul_f32 v32, v32, v60
    v_mul_f32 v33, v33, v60
    v_mul_f32 v34, v34, v60
    v_mul_f32 v35, v35, v60
    v_mul_f32 v36, v36, v61
    v_mul_f32 v37, v37, v61
    v_mul_f32 v38, v38, v61
    v_mul_f32 v39, v39, v61
    v_cvt_pk_bf16_f32 v32, v32, v33
    v_cvt_pk_bf16_f32 v33, v34, v35
    v_cvt_pk_bf16_f32 v34, v36, v37
    v_cvt_pk_bf16_f32 v35, v38, v39
    v_pk_max_i16 v32, v32, 0
    v_pk_max_i16 v33, v33, 0
    v_pk_max_i16 v34, v34, 0
    v_pk_max_i16 v35, v35, 0
    s_nop 0
    v_permlane16_swap_b32 v32, v34
    v_permlane16_swap_b32 v33, v35
    buffer_store_dwordx4 v[32:35], v7, s[28:31], s65 offen offset:2048 sc1
    v_fma_f32 v40, -v58, v52, v40
    v_fma_f32 v41, -v58, v53, v41
    v_fma_f32 v42, -v58, v54, v42
    v_fma_f32 v43, -v58, v55, v43
    v_fma_f32 v44, -v59, v52, v44
    v_fma_f32 v45, -v59, v53, v45
    v_fma_f32 v46, -v59, v54, v46
    v_fma_f32 v47, -v59, v55, v47
    v_mul_f32 v40, v40, v62
    v_mul_f32 v41, v41, v62
    v_mul_f32 v42, v42, v62
    v_mul_f32 v43, v43, v62
    v_mul_f32 v44, v44, v63
    v_mul_f32 v45, v45, v63
    v_mul_f32 v46, v46, v63
    v_mul_f32 v47, v47, v63
    v_cvt_pk_bf16_f32 v40, v40, v41
    v_cvt_pk_bf16_f32 v41, v42, v43
    v_cvt_pk_bf16_f32 v42, v44, v45
    v_cvt_pk_bf16_f32 v43, v46, v47
    v_pk_max_i16 v40, v40, 0
    v_pk_max_i16 v41, v41, 0
    v_pk_max_i16 v42, v42, 0
    v_pk_max_i16 v43, v43, 0
    s_nop 0
    v_permlane16_swap_b32 v40, v42
    v_permlane16_swap_b32 v41, v43
    buffer_store_dwordx4 v[40:43], v7, s[28:31], s65 offen offset:2560 sc1
    v_mov_b32 v7, 9732
    v_mov_b32 v0, 1
    s_mov_b64 exec, 1
    ds_add_u32 v7, v0
    s_mov_b64 exec, -1
    s_add_u32 s64, s22, 4096
    buffer_load_dwordx4 v[112:115], v2, s[28:31], s64 offen sc1
    buffer_load_dwordx4 v[116:119], v2, s[28:31], s23 offen offset:0 sc1
    s_waitcnt vmcnt(2)
    s_add_u32 s62, s41, 4
    v_mov_b32 v0, s62
    v_writelane_b32 v0, s27, 1
    v_lshlrev_b32 v12, 2, v1
    s_mov_b32 exec_hi, 0
    s_add_u32 s62, s45, 0x80000
    buffer_store_dword v0, v12, s[28:31], s62 offen
    s_cmp_eq_u32 s26, 0
    s_cbranch_scc1 Lng_24
    buffer_store_dword v0, v12, s[28:31], s45 offen sc1
Lng_24:
    s_mov_b32 exec_hi, -1
    s_setprio 1
    s_lshl_b32 s7, s3, 7
    s_lshl_b32 s67, s4, 13
    s_cmp_eq_u32 s26, 0
    s_cselect_b32 s6, 0x80000, 0
    s_add_u32 s67, s67, s6
    s_add_u32 s67, s67, s7
    v_min_u32 v11, 7, v1
    v_lshlrev_b32 v11, 10, v11
    s_add_u32 s60, s67, 0x760000
    buffer_load_dword v11, v11, s[28:31], s60 offen sc1
    s_add_u32 s59, s41, 4
    s_waitcnt vmcnt(0)
    s_mov_b32 s61, 0
Lpoll_25:
    v_subrev_u32 v11, s59, v11
    v_cmp_le_u32 vcc, 16, v11
    s_cbranch_vccz Lpd_26
    s_sleep 2
    v_min_u32 v11, 7, v1
    v_lshlrev_b32 v11, 10, v11
    s_add_u32 s60, s67, 0x760000
    buffer_load_dword v11, v11, s[28:31], s60 offen sc1
    s_waitcnt vmcnt(0)
    s_add_u32 s61, s61, 1
    s_cmp_lt_u32 s61, 200000
    s_cbranch_scc1 Lpoll_25
Lpd_26:
    v_add_u32 v12, 0x16e0000, v3
    v_add_u32 v13, s69, v2
    v_add_u32 v11, 81920, v13
    buffer_load_dwordx4 v[56:59], v12, s[28:31], s8 offen offset:0 sc1
    buffer_load_dwordx4 v[60:63], v12, s[28:31], s9 offen offset:0 sc1
    buffer_load_dwordx4 v[64:67], v12, s[28:31], s10 offen offset:0 sc1
    buffer_load_dwordx4 v[68:71], v12, s[28:31], s11 offen offset:0 sc1
    buffer_load_dwordx4 v[72:75], v12, s[28:31], s12 offen offset:0 sc1
    buffer_load_dwordx4 v[76:79], v12, s[28:31], s13 offen offset:0 sc1
    buffer_load_dwordx4 v[80:83], v12, s[28:31], s14 offen offset:0 sc1
    buffer_load_dwordx4 v[84:87], v12, s[28:31], s15 offen offset:0 sc1
    buffer_load_dwordx4 v[88:91], v12, s[28:31], s8 offen offset:256 sc1
    buffer_load_dwordx4 v[92:95], v12, s[28:31], s9 offen offset:256 sc1
    s_setprio 1
    s_waitcnt vmcnt(9)
    v_mfma_f32_16x16x32_bf16 v[16:19], v[136:139], v[56:59], 0
    s_add_u32 m0, s69, 0
    s_add_u32 s64, s10, 256
    buffer_load_dwordx4 v12, s[28:31], s64 offen sc1 lds
    v_mfma_f32_16x16x32_bf16 v[20:23], v[140:143], v[56:59], 0
    s_add_u32 m0, s69, 1024
    s_add_u32 s64, s11, 256
    buffer_load_dwordx4 v12, s[28:31], s64 offen sc1 lds
    v_mfma_f32_16x16x32_bf16 v[24:27], v[144:147], v[56:59], 0
    v_mfma_f32_16x16x32_bf16 v[28:31], v[148:151], v[56:59], 0
    v_mfma_f32_16x16x32_bf16 v[32:35], v[152:155], v[56:59], 0
    s_waitcnt vmcnt(10)
    v_mfma_f32_16x16x32_bf16 v[16:19], v[156:159], v[60:63], v[16:19]
    s_add_u32 m0, s69, 2048
    s_add_u32 s64, s12, 256
    buffer_load_dwordx4 v12, s[28:31], s64 offen sc1 lds
    v_mfma_f32_16x16x32_bf16 v[20:23], v[160:163], v[60:63], v[20:23]
    s_add_u32 m0, s69, 3072
    s_add_u32 s64, s13, 256
    buffer_load_dwordx4 v12, s[28:31], s64 offen sc1 lds
    v_mfma_f32_16x16x32_bf16 v[24:27], v[164:167], v[60:63], v[24:27]
    buffer_load_dwordx4 v[56:59], v12, s[28:31], s11 offen offset:512 sc1
    v_mfma_f32_16x16x32_bf16 v[28:31], v[168:171], v[60:63], v[28:31]
    v_mfma_f32_16x16x32_bf16 v[32:35], v[172:175], v[60:63], v[32:35]
    s_waitcnt vmcnt(12)
    v_mfma_f32_16x16x32_bf16 v[16:19], v[176:179], v[64:67], v[16:19]
    s_add_u32 m0, s69, 4096
    s_add_u32 s64, s14, 256
    buffer_load_dwordx4 v12, s[28:31], s64 offen sc1 lds
    v_mfma_f32_16x16x32_bf16 v[20:23], v[180:183], v[64:67], v[20:23]
    s_add_u32 m0, s69, 5120
    s_add_u32 s64, s15, 256
    buffer_load_dwordx4 v12, s[28:31], s64 offen sc1 lds
    v_mfma_f32_16x16x32_bf16 v[24:27], v[184:187], v[64:67], v[24:27]
    buffer_load_dwordx4 v[60:63], v12, s[28:31], s12 offen offset:512 sc1
    v_mfma_f32_16x16x32_bf16 v[28:31], v[188:191], v[64:67], v[28:31]
    v_mfma_f32_16x16x32_bf16 v[32:35], v[192:195], v[64:67], v[32:35]
    s_waitcnt vmcnt(14)
    v_mfma_f32_16x16x32_bf16 v[16:19], v[196:199], v[68:71], v[16:19]
    s_add_u32 m0, s69, 6144
    s_add_u32 s64, s8, 512
    buffer_load_dwordx4 v12, s[28:31], s64 offen sc1 lds
    v_mfma_f32_16x16x32_bf16 v[20:23], v[200:203], v[68:71], v[20:23]
    s_add_u32 m0, s69, 7168
    s_add_u32 s64, s9, 512
    buffer_load_dwordx4 v12, s[28:31], s64 offen sc1 lds
    v_mfma_f32_16x16x32_bf16 v[24:27], v[204:207], v[68:71], v[24:27]
    buffer_load_dwordx4 v[64:67], v12, s[28:31], s13 offen offset:512 sc1
    v_mfma_f32_16x16x32_bf16 v[28:31], v[208:211], v[68:71], v[28:31]
    v_mfma_f32_16x16x32_bf16 v[32:35], v[212:215], v[68:71], v[32:35]
    s_waitcnt vmcnt(16)
    v_mfma_f32_16x16x32_bf16 v[16:19], v[216:219], v[72:75], v[16:19]
    s_add_u32 m0, s69, 8192
    s_add_u32 s64, s10, 512
    buffer_load_dwordx4 v12, s[28:31], s64 offen sc1 lds
    v_mfma_f32_16x16x32_bf16 v[20:23], v[220:223], v[72:75], v[20:23]
    buffer_load_dwordx4 v[68:71], v12, s[28:31], s14 offen offset:512 sc1
    v_mfma_f32_16x16x32_bf16 v[24:27], v[224:227], v[72:75], v[24:27]
    v_mfma_f32_16x16x32_bf16 v[28:31], v[228:231], v[72:75], v[28:31]
    v_mfma_f32_16x16x32_bf16 v[32:35], v[232:235], v[72:75], v[32:35]
    s_waitcnt vmcnt(17)
    v_mfma_f32_16x16x32_bf16 v[16:19], v[236:239], v[76:79], v[16:19]
    buffer_load_dwordx4 v[72:75], v12, s[28:31], s15 offen offset:512 sc1
    v_mfma_f32_16x16x32_bf16 v[20:23], v[240:243], v[76:79], v[20:23]
    v_mfma_f32_16x16x32_bf16 v[24:27], v[244:247], v[76:79], v[24:27]
    v_mfma_f32_16x16x32_bf16 v[28:31], v[248:251], v[76:79], v[28:31]
    v_mfma_f32_16x16x32_bf16 v[32:35], v[252:255], v[76:79], v[32:35]
    s_waitcnt vmcnt(17)
    v_mfma_f32_16x16x32_bf16 v[16:19], v[96:99], v[80:83], v[16:19]
    buffer_load_dwordx4 v[76:79], v12, s[28:31], s8 offen offset:768 sc1
    v_mfma_f32_16x16x32_bf16 v[20:23], v[100:103], v[80:83], v[20:23]
    v_mfma_f32_16x16x32_bf16 v[24:27], v[104:107], v[80:83], v[24:27]
    v_mfma_f32_16x16x32_bf16 v[28:31], v[108:111], v[80:83], v[28:31]
    v_mfma_f32_16x16x32_bf16 v[32:35], v[112:115], v[80:83], v[32:35]
    s_waitcnt vmcnt(14)
    v_mfma_f32_16x16x32_bf16 v[16:19], v[116:119], v[84:87], v[16:19]
    ds_read_b128 v[80:83], v13 offset:0
    v_mfma_f32_16x16x32_bf16 v[20:23], v[120:123], v[84:87], v[20:23]
    v_mfma_f32_16x16x32_bf16 v[24:27], v[124:127], v[84:87], v[24:27]
    v_mfma_f32_16x16x32_bf16 v[28:31], v[128:131], v[84:87], v[28:31]
    v_mfma_f32_16x16x32_bf16 v[32:35], v[132:135], v[84:87], v[32:35]
    s_waitcnt vmcnt(13)
    v_mfma_f32_16x16x32_bf16 v[36:39], v[136:139], v[88:91], 0
    ds_read_b128 v[84:87], v13 offset:1024
    v_mfma_f32_16x16x32_bf16 v[40:43], v[140:143], v[88:91], 0
    v_mov_b32 v7, 9732
    ds_read_b32 v7, v7
    v_mfma_f32_16x16x32_bf16 v[44:47], v[144:147], v[88:91], 0
    v_mfma_f32_16x16x32_bf16 v[48:51], v[148:151], v[88:91], 0
    v_mfma_f32_16x16x32_bf16 v[52:55], v[152:155], v[88:91], 0
    s_waitcnt lgkmcnt(0)
    v_cmp_gt_u32 vcc, 8, v7
    s_cbranch_vccz Lcd_28
    s_mov_b32 s61, 0
Lcw_27:
    v_mov_b32 v7, 9732
    ds_read_b32 v7, v7
    s_waitcnt lgkmcnt(0)
    v_cmp_gt_u32 vcc, 8, v7
    s_cbranch_vccz Lcd_28
    s_sleep 1
    s_add_u32 s61, s61, 1
    s_cmp_lt_u32 s61, 200000
    s_cbranch_scc1 Lcw_27
Lcd_28:
    v_mov_b32 v7, 9732
    v_mov_b32 v0, 1
    s_mov_b64 exec, 1
    ds_add_u32 v7, v0
    s_mov_b64 exec, -1
    s_waitcnt vmcnt(12)
    v_mfma_f32_16x16x32_bf16 v[36:39], v[156:159], v[92:95], v[36:39]
    ds_read_b128 v[88:91], v13 offset:2048
    v_mfma_f32_16x16x32_bf16 v[40:43], v[160:163], v[92:95], v[40:43]
    ds_write_b128 v11, v[16:19] offset:0
    v_mfma_f32_16x16x32_bf16 v[44:47], v[164:167], v[92:95], v[44:47]
    ds_write_b128 v11, v[20:23] offset:1024
    v_mfma_f32_16x16x32_bf16 v[48:51], v[168:171], v[92:95], v[48:51]
    v_mfma_f32_16x16x32_bf16 v[52:55], v[172:175], v[92:95], v[52:55]
    s_waitcnt vmcnt(11)
    v_mfma_f32_16x16x32_bf16 v[36:39], v[176:179], v[80:83], v[36:39]
    ds_read_b128 v[92:95], v13 offset:3072
    v_mfma_f32_16x16x32_bf16 v[40:43], v[180:183], v[80:83], v[40:43]
    ds_write_b128 v11, v[24:27] offset:2048
    v_mfma_f32_16x16x32_bf16 v[44:47], v[184:187], v[80:83], v[44:47]
    ds_write_b128 v11, v[28:31] offset:3072
    v_mfma_f32_16x16x32_bf16 v[48:51], v[188:191], v[80:83], v[48:51]
    v_mfma_f32_16x16x32_bf16 v[52:55], v[192:195], v[80:83], v[52:55]
    s_waitcnt vmcnt(9)
    v_mfma_f32_16x16x32_bf16 v[36:39], v[196:199], v[84:87], v[36:39]
    ds_read_b128 v[80:83], v13 offset:4096
    v_mfma_f32_16x16x32_bf16 v[40:43], v[200:203], v[84:87], v[40:43]
    ds_write_b128 v11, v[32:35] offset:4096
    v_mfma_f32_16x16x32_bf16 v[44:47], v[204:207], v[84:87], v[44:47]
    v_mfma_f32_16x16x32_bf16 v[48:51], v[208:211], v[84:87], v[48:51]
    v_mfma_f32_16x16x32_bf16 v[52:55], v[212:215], v[84:87], v[52:55]
    s_waitcnt vmcnt(8) lgkmcnt(7)
    v_mfma_f32_16x16x32_bf16 v[36:39], v[216:219], v[88:91], v[36:39]
    ds_read_b128 v[84:87], v13 offset:5120
    v_mfma_f32_16x16x32_bf16 v[40:43], v[220:223], v[88:91], v[40:43]
    v_mfma_f32_16x16x32_bf16 v[44:47], v[224:227], v[88:91], v[44:47]
    v_mfma_f32_16x16x32_bf16 v[48:51], v[228:231], v[88:91], v[48:51]
    v_mfma_f32_16x16x32_bf16 v[52:55], v[232:235], v[88:91], v[52:55]
    s_waitcnt vmcnt(6) lgkmcnt(5)
    v_mfma_f32_16x16x32_bf16 v[36:39], v[236:239], v[92:95], v[36:39]
    ds_read_b128 v[88:91], v13 offset:6144
    v_mfma_f32_16x16x32_bf16 v[40:43], v[240:243], v[92:95], v[40:43]
    v_mfma_f32_16x16x32_bf16 v[44:47], v[244:247], v[92:95], v[44:47]
    v_mfma_f32_16x16x32_bf16 v[48:51], v[248:251], v[92:95], v[48:51]
    v_mfma_f32_16x16x32_bf16 v[52:55], v[252:255], v[92:95], v[52:55]
    s_waitcnt vmcnt(5) lgkmcnt(3)
    v_mfma_f32_16x16x32_bf16 v[36:39], v[96:99], v[80:83], v[36:39]
    ds_read_b128 v[92:95], v13 offset:7168
    v_mfma_f32_16x16x32_bf16 v[40:43], v[100:103], v[80:83], v[40:43]
    v_mfma_f32_16x16x32_bf16 v[44:47], v[104:107], v[80:83], v[44:47]
    v_mfma_f32_16x16x32_bf16 v[48:51], v[108:111], v[80:83], v[48:51]
    v_mfma_f32_16x16x32_bf16 v[52:55], v[112:115], v[80:83], v[52:55]
    s_waitcnt vmcnt(3) lgkmcnt(2)
    v_mfma_f32_16x16x32_bf16 v[36:39], v[116:119], v[84:87], v[36:39]
    ds_read_b128 v[80:83], v13 offset:8192
    v_mfma_f32_16x16x32_bf16 v[40:43], v[120:123], v[84:87], v[40:43]
    v_mfma_f32_16x16x32_bf16 v[44:47], v[124:127], v[84:87], v[44:47]
    v_mfma_f32_16x16x32_bf16 v[48:51], v[128:131], v[84:87], v[48:51]
    v_mfma_f32_16x16x32_bf16 v[52:55], v[132:135], v[84:87], v[52:55]
    s_waitcnt lgkmcnt(2)
    v_mfma_f32_16x16x32_bf16 v[16:19], v[136:139], v[88:91], 0
    buffer_load_dwordx4 v[84:87], v12, s[28:31], s9 offen offset:768 sc1
    v_mfma_f32_16x16x32_bf16 v[20:23], v[140:143], v[88:91], 0
    v_mfma_f32_16x16x32_bf16 v[24:27], v[144:147], v[88:91], 0
    v_mfma_f32_16x16x32_bf16 v[28:31], v[148:151], v[88:91], 0
    v_mfma_f32_16x16x32_bf16 v[32:35], v[152:155], v[88:91], 0
    s_waitcnt lgkmcnt(1)
    v_mfma_f32_16x16x32_bf16 v[16:19], v[156:159], v[92:95], v[16:19]
    buffer_load_dwordx4 v[88:91], v12, s[28:31], s10 offen offset:768 sc1
    v_mfma_f32_16x16x32_bf16 v[20:23], v[160:163], v[92:95], v[20:23]
    ds_write_b128 v11, v[36:39] offset:5120
    v_mfma_f32_16x16x32_bf16 v[24:27], v[164:167], v[92:95], v[24:27]
    ds_write_b128 v11, v[40:43] offset:6144
    v_mfma_f32_16x16x32_bf16 v[28:31], v[168:171], v[92:95], v[28:31]
    v_mfma_f32_16x16x32_bf16 v[32:35], v[172:175], v[92:95], v[32:35]
    s_waitcnt lgkmcnt(2)
    v_mfma_f32_16x16x32_bf16 v[16:19], v[176:179], v[80:83], v[16:19]
    buffer_load_dwordx4 v[92:95], v12, s[28:31], s11 offen offset:768 sc1
    v_mfma_f32_16x16x32_bf16 v[20:23], v[180:183], v[80:83], v[20:23]
    ds_write_b128 v11, v[44:47] offset:7168
    v_mfma_f32_16x16x32_bf16 v[24:27], v[184:187], v[80:83], v[24:27]
    ds_write_b128 v11, v[48:51] offset:8192
    v_mfma_f32_16x16x32_bf16 v[28:31], v[188:191], v[80:83], v[28:31]
    v_mfma_f32_16x16x32_bf16 v[32:35], v[192:195], v[80:83], v[32:35]
    v_mfma_f32_16x16x32_bf16 v[16:19], v[196:199], v[56:59], v[16:19]
    buffer_load_dwordx4 v[80:83], v12, s[28:31], s12 offen offset:768 sc1
    v_mfma_f32_16x16x32_bf16 v[20:23], v[200:203], v[56:59], v[20:23]
    ds_write_b128 v11, v[52:55] offset:9216
    v_mfma_f32_16x16x32_bf16 v[24:27], v[204:207], v[56:59], v[24:27]
    v_mfma_f32_16x16x32_bf16 v[28:31], v[208:211], v[56:59], v[28:31]
    v_mfma_f32_16x16x32_bf16 v[32:35], v[212:215], v[56:59], v[32:35]
    v_mfma_f32_16x16x32_bf16 v[16:19], v[216:219], v[60:63], v[16:19]
    buffer_load_dwordx4 v[56:59], v12, s[28:31], s13 offen offset:768 sc1
    v_mfma_f32_16x16x32_bf16 v[20:23], v[220:223], v[60:63], v[20:23]
    v_mfma_f32_16x16x32_bf16 v[24:27], v[224:227], v[60:63], v[24:27]
    v_mfma_f32_16x16x32_bf16 v[28:31], v[228:231], v[60:63], v[28:31]
    v_mfma_f32_16x16x32_bf16 v[32:35], v[232:235], v[60:63], v[32:35]
    v_mfma_f32_16x16x32_bf16 v[16:19], v[236:239], v[64:67], v[16:19]
    buffer_load_dwordx4 v[60:63], v12, s[28:31], s14 offen offset:768 sc1
    v_mfma_f32_16x16x32_bf16 v[20:23], v[240:243], v[64:67], v[20:23]
    v_mfma_f32_16x16x32_bf16 v[24:27], v[244:247], v[64:67], v[24:27]
    v_mfma_f32_16x16x32_bf16 v[28:31], v[248:251], v[64:67], v[28:31]
    v_mfma_f32_16x16x32_bf16 v[32:35], v[252:255], v[64:67], v[32:35]
    s_waitcnt vmcnt(8)
    v_mfma_f32_16x16x32_bf16 v[16:19], v[96:99], v[68:71], v[16:19]
    buffer_load_dwordx4 v[64:67], v12, s[28:31], s15 offen offset:768 sc1
    v_mfma_f32_16x16x32_bf16 v[20:23], v[100:103], v[68:71], v[20:23]
    v_mfma_f32_16x16x32_bf16 v[24:27], v[104:107], v[68:71], v[24:27]
    v_mfma_f32_16x16x32_bf16 v[28:31], v[108:111], v[68:71], v[28:31]
    v_mfma_f32_16x16x32_bf16 v[32:35], v[112:115], v[68:71], v[32:35]
    s_waitcnt vmcnt(8)
    v_mfma_f32_16x16x32_bf16 v[16:19], v[116:119], v[72:75], v[16:19]
    v_mfma_f32_16x16x32_bf16 v[20:23], v[120:123], v[72:75], v[20:23]
    v_mfma_f32_16x16x32_bf16 v[24:27], v[124:127], v[72:75], v[24:27]
    v_mfma_f32_16x16x32_bf16 v[28:31], v[128:131], v[72:75], v[28:31]
    v_mfma_f32_16x16x32_bf16 v[32:35], v[132:135], v[72:75], v[32:35]
    s_waitcnt vmcnt(7) lgkmcnt(0)
    v_mfma_f32_16x16x32_bf16 v[36:39], v[136:139], v[76:79], 0
    v_mfma_f32_16x16x32_bf16 v[40:43], v[140:143], v[76:79], 0
    v_mfma_f32_16x16x32_bf16 v[44:47], v[144:147], v[76:79], 0
    v_mfma_f32_16x16x32_bf16 v[48:51], v[148:151], v[76:79], 0
    v_mfma_f32_16x16x32_bf16 v[52:55], v[152:155], v[76:79], 0
    s_waitcnt vmcnt(6)
    v_mfma_f32_16x16x32_bf16 v[36:39], v[156:159], v[84:87], v[36:39]
    ds_write_b128 v13, v[16:19] offset:0
    v_mfma_f32_16x16x32_bf16 v[40:43], v[160:163], v[84:87], v[40:43]
    ds_write_b128 v13, v[20:23] offset:1024
    v_mfma_f32_16x16x32_bf16 v[44:47], v[164:167], v[84:87], v[44:47]
    v_mfma_f32_16x16x32_bf16 v[48:51], v[168:171], v[84:87], v[48:51]
    v_mfma_f32_16x16x32_bf16 v[52:55], v[172:175], v[84:87], v[52:55]
    s_waitcnt vmcnt(5)
    v_mfma_f32_16x16x32_bf16 v[36:39], v[176:179], v[88:91], v[36:39]
    ds_write_b128 v13, v[24:27] offset:2048
    v_mfma_f32_16x16x32_bf16 v[40:43], v[180:183], v[88:91], v[40:43]
    ds_write_b128 v13, v[28:31] offset:3072
    v_mfma_f32_16x16x32_bf16 v[44:47], v[184:187], v[88:91], v[44:47]
    v_mfma_f32_16x16x32_bf16 v[48:51], v[188:191], v[88:91], v[48:51]
    v_mfma_f32_16x16x32_bf16 v[52:55], v[192:195], v[88:91], v[52:55]
    s_waitcnt vmcnt(4)
    v_mfma_f32_16x16x32_bf16 v[36:39], v[196:199], v[92:95], v[36:39]
    ds_write_b128 v13, v[32:35] offset:4096
    v_mfma_f32_16x16x32_bf16 v[40:43], v[200:203], v[92:95], v[40:43]
    v_mfma_f32_16x16x32_bf16 v[44:47], v[204:207], v[92:95], v[44:47]
    v_mfma_f32_16x16x32_bf16 v[48:51], v[208:211], v[92:95], v[48:51]
    v_mfma_f32_16x16x32_bf16 v[52:55], v[212:215], v[92:95], v[52:55]
    s_waitcnt vmcnt(3)
    v_mfma_f32_16x16x32_bf16 v[36:39], v[216:219], v[80:83], v[36:39]
    v_mfma_f32_16x16x32_bf16 v[40:43], v[220:223], v[80:83], v[40:43]
    v_mfma_f32_16x16x32_bf16 v[44:47], v[224:227], v[80:83], v[44:47]
    v_mfma_f32_16x16x32_bf16 v[48:51], v[228:231], v[80:83], v[48:51]
    v_mfma_f32_16x16x32_bf16 v[52:55], v[232:235], v[80:83], v[52:55]
    s_waitcnt vmcnt(2)
    v_mfma_f32_16x16x32_bf16 v[36:39], v[236:239], v[56:59], v[36:39]
    v_mfma_f32_16x16x32_bf16 v[40:43], v[240:243], v[56:59], v[40:43]
    v_mfma_f32_16x16x32_bf16 v[44:47], v[244:247], v[56:59], v[44:47]
    v_mfma_f32_16x16x32_bf16 v[48:51], v[248:251], v[56:59], v[48:51]
    v_mfma_f32_16x16x32_bf16 v[52:55], v[252:255], v[56:59], v[52:55]
    s_waitcnt vmcnt(1)
    v_mfma_f32_16x16x32_bf16 v[36:39], v[96:99], v[60:63], v[36:39]
    v_mfma_f32_16x16x32_bf16 v[40:43], v[100:103], v[60:63], v[40:43]
    v_mfma_f32_16x16x32_bf16 v[44:47], v[104:107], v[60:63], v[44:47]
    v_mfma_f32_16x16x32_bf16 v[48:51], v[108:111], v[60:63], v[48:51]
    v_mfma_f32_16x16x32_bf16 v[52:55], v[112:115], v[60:63], v[52:55]
    s_waitcnt vmcnt(0)
    v_mfma_f32_16x16x32_bf16 v[36:39], v[116:119], v[64:67], v[36:39]
    v_mfma_f32_16x16x32_bf16 v[40:43], v[120:123], v[64:67], v[40:43]
    v_mfma_f32_16x16x32_bf16 v[44:47], v[124:127], v[64:67], v[44:47]
    v_mfma_f32_16x16x32_bf16 v[48:51], v[128:131], v[64:67], v[48:51]
    v_mfma_f32_16x16x32_bf16 v[52:55], v[132:135], v[64:67], v[52:55]
    s_setprio 3
    s_nop 2
    ds_write_b128 v13, v[36:39] offset:5120
    ds_write_b128 v13, v[40:43] offset:6144
    ds_write_b128 v13, v[44:47] offset:7168
    ds_write_b128 v13, v[48:51] offset:8192
    s_cmp_lg_u32 s3, 0
    s_cbranch_scc1 L0_29
    s_mov_b32 s61, 0
Lcw_30:
    v_mov_b32 v7, 9732
    ds_read_b32 v7, v7
    s_waitcnt lgkmcnt(0)
    v_cmp_gt_u32 vcc, 16, v7
    s_cbranch_vccz Lcd_31
    s_sleep 1
    s_add_u32 s61, s61, 1
    s_cmp_lt_u32 s61, 200000
    s_cbranch_scc1 Lcw_30
Lcd_31:
L0_29:
    ds_write_b128 v13, v[52:55] offset:9216
    s_branch Ljoin_15
Lctl_16:
    s_setprio 3
    s_and_b32 s63, s3, 3
    s_lshl_b32 s67, s63, 16
    s_lshl_b32 s6, s5, 10
    s_add_u32 s67, s67, s6
    v_mul_u32_u24 v6, 192, v5
    v_add_u32 v6, 94208, v6
    s_cmp_eq_u32 s39, 1
    s_cselect_b64 s[76:77], -1, 0
    s_cmp_eq_u32 s5, 0
    s_cselect_b32 s7, 11, 0
    v_add_u32 v11, 0, v4
    v_sub_u32 v12, 9, v11
    v_cndmask_b32 v12, v11, v12, s[76:77]
    v_lshl_add_u32 v12, v12, 4, v6
    ds_read_b128 v[96:99], v12
    v_mov_b32 v13, s7
    v_cmp_eq_u32 vcc, 0, v11
    s_nop 1
    v_cndmask_b32 v13, v11, v13, vcc
    v_sub_u32 v12, 10, v11
    v_cndmask_b32 v12, v13, v12, s[76:77]
    v_lshl_add_u32 v12, v12, 4, v6
    ds_read_u16 v108, v12
    v_add_u32 v11, 2, v4
    v_sub_u32 v12, 9, v11
    v_cndmask_b32 v12, v11, v12, s[76:77]
    v_lshl_add_u32 v12, v12, 4, v6
    ds_read_b128 v[100:103], v12
    v_sub_u32 v12, 10, v11
    v_cndmask_b32 v12, v11, v12, s[76:77]
    v_lshl_add_u32 v12, v12, 4, v6
    ds_read_u16 v109, v12
    v_mov_b32 v11, 4
    v_sub_u32 v12, 9, v11
    v_cndmask_b32 v12, v11, v12, s[76:77]
    v_lshl_add_u32 v12, v12, 4, v6
    ds_read_b128 v[104:107], v12
    v_sub_u32 v12, 10, v11
    v_cndmask_b32 v12, v11, v12, s[76:77]
    v_lshl_add_u32 v12, v12, 4, v6
    ds_read_u16 v110, v12
    s_lshl_b32 s6, s38, 12
    s_add_u32 s6, s6, 106496
    v_add_u32 v11, s6, v2
    ds_read_b128 v[16:19], v11 offset:0
    ds_read_b128 v[20:23], v11 offset:1024
    ds_read_b128 v[24:27], v11 offset:2048
    ds_read_b128 v[28:31], v11 offset:3072
    s_lshl_b32 s6, s5, 2
    s_lshl_b32 s7, s39, 5
    s_add_u32 s6, s6, s7
    s_lshl_b32 s7, s5, 1
    s_add_u32 s7, s7, s39
    s_add_u32 s7, s7, 64
    s_sub_u32 s70, s7, s6
    s_lshl_b32 s70, s70, 10
    s_lshl_b32 s6, s6, 10
    v_lshlrev_b32 v5, 4, v5
    v_lshl_add_u32 v5, v4, 10, v5
    v_add_u32 v5, s6, v5
    s_cmp_eq_u32 s6, 32768
    s_cselect_b32 s6, 0xffff, 0
    v_mov_b32 v12, s6
    v_cmp_eq_u32 vcc, 0, v4
    s_nop 1
    v_cndmask_b32 v12, 0, v12, vcc
    s_waitcnt lgkmcnt(4)
    v_mov_b32 v11, 0xffff
    s_cmp_eq_u32 s39, 1
    s_cbranch_scc1 Lxr_32
    v_bfi_b32 v72, v11, v108, v96
    v_mov_b32 v73, v97
    v_mov_b32 v74, v98
    v_mov_b32 v75, v99
    v_bfi_b32 v76, v11, v109, v100
    v_mov_b32 v77, v101
    v_mov_b32 v78, v102
    v_mov_b32 v79, v103
    v_bfi_b32 v80, v11, v110, v104
    v_mov_b32 v81, v105
    v_mov_b32 v82, v106
    v_mov_b32 v83, v107
    s_branch Lxj_33
Lxr_32:
    v_bfi_b32 v72, v11, v108, v99
    v_bfi_b32 v73, v11, v99, v98
    v_bfi_b32 v74, v11, v98, v97
    v_bfi_b32 v75, v11, v97, v96
    v_bfi_b32 v76, v11, v109, v103
    v_bfi_b32 v77, v11, v103, v102
    v_bfi_b32 v78, v11, v102, v101
    v_bfi_b32 v79, v11, v101, v100
    v_bfi_b32 v80, v11, v110, v107
    v_bfi_b32 v81, v11, v107, v106
    v_bfi_b32 v82, v11, v106, v105
    v_bfi_b32 v83, v11, v105, v104
Lxj_33:
    v_min_u32 v7, 7, v1
    v_lshlrev_b32 v7, 13, v7
    s_add_u32 s60, s67, 0x760000
    buffer_load_dword v7, v7, s[28:31], s60 offen sc1
    v_mfma_f32_32x32x16_bf16 v[32:47], v[84:87], v[72:75], 0
    v_mfma_f32_32x32x16_bf16 v[48:63], v[84:87], v[80:83], 0
    v_mfma_f32_32x32x16_bf16 v[32:47], v[88:91], v[76:79], v[32:47]
    v_bfe_u32 v13, v1, 2, 2
    v_mul_u32_u24 v13, 192, v13
    s_movk_i32 s7, 3072
    v_mad_u32_u24 v13, v4, s7, v13
    v_bfe_u32 v11, v1, 1, 1
    v_lshl_add_u32 v13, v11, 3, v13
    s_mul_i32 s6, s38, 1536
    s_add_u32 s6, s6, s58
    v_add_u32 v111, s6, v13
    v_bfe_u32 v11, v1, 4, 1
    v_lshlrev_b32 v11, 1, v11
    v_and_b32 v0, 1, v1
    v_add_u32 v11, v11, v0
    v_lshl_add_u32 v13, v11, 4, v111
    v_mov_b32 v11, v72
    s_sub_u32 s6, s51, s4
    s_mul_i32 s6, s6, 49152
    s_sub_u32 s71, s6, 1536
    v_mul_lo_u32 v112, v4, s71
    v_add_u32 v112, v112, v2
    s_waitcnt lgkmcnt(0)
    s_lshl_b32 s6, s4, 3
    s_add_u32 s6, s6, s5
    s_mulk_i32 s6, 6144
    s_mul_i32 s7, s63, 1536
    s_add_u32 s66, s6, s7
    s_add_u32 s66, s66, 0x960000
    s_add_u32 s65, s66, s71
    s_mul_i32 s7, s63, 3072
    s_add_u32 m0, s7, s58
    s_add_u32 s59, s41, 1
    s_waitcnt vmcnt(0)
    s_mov_b32 s61, 0
Lpoll_34:
    v_subrev_u32 v7, s59, v7
    v_cmp_le_u32 vcc, 16, v7
    s_cbranch_vccz Lpd_35
    s_sleep 2
    v_min_u32 v7, 7, v1
    v_lshlrev_b32 v7, 13, v7
    s_add_u32 s60, s67, 0x760000
    buffer_load_dword v7, v7, s[28:31], s60 offen sc1
    s_waitcnt vmcnt(0)
    s_add_u32 s61, s61, 1
    s_cmp_lt_u32 s61, 200000
    s_cbranch_scc1 Lpoll_34
Lpd_35:
    buffer_load_dwordx4 v2, s[28:31], s66 offen sc1 lds
    buffer_load_dwordx4 v112, s[28:31], s66 offen offset:1024 sc1 lds
    buffer_load_dwordx4 v2, s[28:31], s65 offen offset:2048 sc1 lds
    v_and_b32 v114, 7, v1
    v_mov_b32 v115, s4
    v_mov_b32 v0, s52
    v_cmp_gt_u32 vcc, 8, v8
    s_nop 1
    v_cndmask_b32 v115, v0, v115, vcc
    v_lshl_add_u32 v114, v115, 3, v114
    v_lshlrev_b32 v114, 10, v114
    s_mov_b32 s60, 0x760000
    buffer_load_dwordx2 v[114:115], v114, s[28:31], s60 offen sc1
    s_waitcnt vmcnt(1)
    v_mov_b32 v7, 9736
    v_mov_b32 v0, 1
    s_mov_b64 exec, 1
    ds_add_u32 v7, v0
    s_mov_b64 exec, -1
    s_mov_b32 s61, 0
Lcw_36:
    v_mov_b32 v7, 9736
    ds_read_b32 v7, v7
    s_waitcnt lgkmcnt(0)
    v_cmp_gt_u32 vcc, 4, v7
    s_cbranch_vccz Lcd_37
    s_sleep 1
    s_add_u32 s61, s61, 1
    s_cmp_lt_u32 s61, 200000
    s_cbranch_scc1 Lcw_36
Lcd_37:
    ds_read_b64_tr_b16 v[64:65], v13 offset:0
    ds_read_b64_tr_b16 v[66:67], v13 offset:768
    ds_read_b64_tr_b16 v[80:81], v111 offset:64
    ds_read_b64_tr_b16 v[82:83], v111 offset:832
    ds_read_b64_tr_b16 v[68:69], v13 offset:6144
    ds_read_b64_tr_b16 v[70:71], v13 offset:6912
    ds_read_b64_tr_b16 v[84:85], v111 offset:6208
    ds_read_b64_tr_b16 v[86:87], v111 offset:6976
    ds_read_b64_tr_b16 v[72:73], v13 offset:80
    ds_read_b64_tr_b16 v[74:75], v13 offset:848
    ds_read_b64_tr_b16 v[88:89], v111 offset:144
    ds_read_b64_tr_b16 v[90:91], v111 offset:912
    ds_read_b64_tr_b16 v[76:77], v13 offset:6224
    ds_read_b64_tr_b16 v[78:79], v13 offset:6992
    ds_read_b64_tr_b16 v[92:93], v111 offset:6288
    ds_read_b64_tr_b16 v[94:95], v111 offset:7056
    s_add_u32 s63, s44, 0xf60000
    s_add_u32 s71, s63, s70
    s_waitcnt lgkmcnt(14)
    v_mfma_f32_32x32x16_bf16 v[32:47], v[64:67], v[16:19], v[32:47]
    s_waitcnt lgkmcnt(12)
    v_mfma_f32_32x32x16_bf16 v[48:63], v[80:83], v[16:19], v[48:63]
    s_waitcnt lgkmcnt(10)
    v_mfma_f32_32x32x16_bf16 v[32:47], v[68:71], v[20:23], v[32:47]
    s_waitcnt lgkmcnt(8)
    v_mfma_f32_32x32x16_bf16 v[48:63], v[84:87], v[20:23], v[48:63]
    s_waitcnt lgkmcnt(6)
    v_mfma_f32_32x32x16_bf16 v[32:47], v[72:75], v[24:27], v[32:47]
    s_waitcnt lgkmcnt(4)
    v_mfma_f32_32x32x16_bf16 v[48:63], v[88:91], v[24:27], v[48:63]
    s_waitcnt lgkmcnt(2)
    v_mfma_f32_32x32x16_bf16 v[32:47], v[76:79], v[28:31], v[32:47]
    s_waitcnt lgkmcnt(0)
    v_mfma_f32_32x32x16_bf16 v[48:63], v[92:95], v[28:31], v[48:63]
    s_nop 9
    v_cvt_pk_bf16_f32 v96, v32, v33
    v_cvt_pk_bf16_f32 v97, v34, v35
    v_cvt_pk_bf16_f32 v98, v36, v37
    v_cvt_pk_bf16_f32 v99, v38, v39
    v_cvt_pk_bf16_f32 v100, v40, v41
    v_cvt_pk_bf16_f32 v101, v42, v43
    v_cvt_pk_bf16_f32 v102, v44, v45
    v_cvt_pk_bf16_f32 v103, v46, v47
    v_bfi_b32 v96, v12, v11, v96
    buffer_store_dwordx4 v[100:103], v5, s[28:31], s63 offen offset:2048 sc1
    buffer_store_dwordx4 v[96:99], v5, s[28:31], s63 offen sc1
    v_cvt_pk_bf16_f32 v104, v48, v49
    v_cvt_pk_bf16_f32 v105, v50, v51
    v_cvt_pk_bf16_f32 v106, v52, v53
    v_cvt_pk_bf16_f32 v107, v54, v55
    s_mov_b32 exec_hi, 0
    buffer_store_dwordx4 v[104:107], v5, s[28:31], s71 offen sc1
    s_mov_b32 exec_hi, -1
    s_mov_b32 s7, 0x3f803f80
    v_mov_b32 v16, 0
    v_mov_b32 v17, 0
    v_mov_b32 v18, 0
    v_mov_b32 v19, 0
    v_dot2_f32_bf16 v16, v96, s7, v16
    v_dot2_f32_bf16 v17, v96, v96, v17
    v_dot2_f32_bf16 v16, v97, s7, v16
    v_dot2_f32_bf16 v17, v97, v97, v17
    v_dot2_f32_bf16 v16, v98, s7, v16
    v_dot2_f32_bf16 v17, v98, v98, v17
    v_dot2_f32_bf16 v16, v99, s7, v16
    v_dot2_f32_bf16 v17, v99, v99, v17
    v_dot2_f32_bf16 v16, v100, s7, v16
    v_dot2_f32_bf16 v17, v100, v100, v17
    v_dot2_f32_bf16 v16, v101, s7, v16
    v_dot2_f32_bf16 v17, v101, v101, v17
    v_dot2_f32_bf16 v16, v102, s7, v16
    v_dot2_f32_bf16 v17, v102, v102, v17
    v_dot2_f32_bf16 v16, v103, s7, v16
    v_dot2_f32_bf16 v17, v103, v103, v17
    s_mov_b32 exec_hi, 0
    v_dot2_f32_bf16 v16, v104, s7, v16
    v_dot2_f32_bf16 v17, v104, v104, v17
    v_dot2_f32_bf16 v16, v105, s7, v16
    v_dot2_f32_bf16 v17, v105, v105, v17
    v_dot2_f32_bf16 v16, v106, s7, v16
    v_dot2_f32_bf16 v17, v106, v106, v17
    v_dot2_f32_bf16 v16, v107, s7, v16
    v_dot2_f32_bf16 v17, v107, v107, v17
    s_mov_b32 exec_hi, -1
    v_bfe_u32 v7, v5, 4, 6
    v_lshlrev_b32 v7, 3, v7
    s_lshl_b32 s6, s39, 9
    v_add_u32 v7, s6, v7
    v_mov_b32 v18, v16
    v_mov_b32 v19, v17
    s_nop 0
    v_permlane32_swap_b32 v16, v18
    v_permlane32_swap_b32 v17, v19
    v_add_f32 v16, v16, v18
    v_add_f32 v17, v17, v19
    ds_write_b64 v7, v[16:17] offset:60416
    s_add_u32 s59, s41, 1
    s_waitcnt vmcnt(3)
    s_mov_b32 s61, 0
Lidp_38:
    v_subrev_u32 v114, s59, v114
    v_cmp_le_u32 vcc, 16, v114
    s_cbranch_vccz Lidd_39
    v_and_b32 v114, 7, v1
    v_mov_b32 v115, s4
    v_mov_b32 v0, s52
    v_cmp_gt_u32 vcc, 8, v8
    s_nop 1
    v_cndmask_b32 v115, v0, v115, vcc
    v_lshl_add_u32 v114, v115, 3, v114
    v_lshlrev_b32 v114, 10, v114
    s_mov_b32 s60, 0x760000
    buffer_load_dwordx2 v[114:115], v114, s[28:31], s60 offen sc1
    s_waitcnt vmcnt(0)
    s_add_u32 s61, s61, 1
    s_cmp_lt_u32 s61, 200000
    s_cbranch_scc1 Lidp_38
    v_mov_b32 v115, -1
Lidd_39:
    v_cmp_ne_u32 vcc, s27, v115
    s_nop 1
    s_or_b32 s26, vcc_lo, vcc_hi
    s_cselect_b32 s6, 0, 0x80000
    s_add_u32 s50, s50, s6
    s_add_u32 s53, s53, s6
    s_waitcnt vmcnt(0)
    v_mov_b32 v7, 9740
    v_mov_b32 v0, 1
    s_mov_b64 exec, 1
    ds_add_u32 v7, v0
    s_mov_b64 exec, -1
    s_mov_b32 s61, 0
Lcw_40:
    v_mov_b32 v7, 9740
    ds_read_b32 v7, v7
    s_waitcnt lgkmcnt(0)
    v_cmp_gt_u32 vcc, 4, v7
    s_cbranch_vccz Lcd_41
    s_sleep 1
    s_add_u32 s61, s61, 1
    s_cmp_lt_u32 s61, 200000
    s_cbranch_scc1 Lcw_40
Lcd_41:
    s_cmp_lg_u32 s3, 4
    s_cbranch_scc1 Lnf_42
    s_add_u32 s62, s41, 2
    v_mov_b32 v0, s62
    v_writelane_b32 v0, s27, 1
    v_lshlrev_b32 v7, 2, v1
    s_mov_b32 exec_hi, 0
    s_add_u32 s62, s45, 0x80000
    buffer_store_dword v0, v7, s[28:31], s62 offen
    s_cmp_eq_u32 s26, 0
    s_cbranch_scc1 Lng_43
    buffer_store_dword v0, v7, s[28:31], s45 offen sc1
Lng_43:
    s_mov_b32 exec_hi, -1
Lnf_42:
    s_lshl_b32 s65, s4, 12
    s_add_u32 s65, s65, 0x560000
    s_cmp_lg_u32 s3, 7
    s_cbranch_scc1 Ls1_44
    v_lshlrev_b32 v7, 3, v1
    ds_read_b64 v[16:17], v7 offset:60416
    ds_read_b64 v[18:19], v7 offset:60928
    s_lshl_b32 s6, s5, 9
    s_add_u32 s6, s6, s65
    s_waitcnt lgkmcnt(0)
    v_add_f32 v16, v16, v18
    v_add_f32 v17, v17, v19
    buffer_store_dwordx2 v[16:17], v7, s[28:31], s6 offen sc1
Ls1_44:
    s_lshl_b32 s7, s3, 11
    s_lshl_b32 s67, s4, 13
    s_cmp_eq_u32 s26, 0
    s_cselect_b32 s6, 0x80000, 0
    s_add_u32 s67, s67, s6
    s_add_u32 s67, s67, s7
    s_sub_u32 s67, s67, 7680
    v_min_u32 v7, 1, v1
    v_lshlrev_b32 v7, 10, v7
    s_add_u32 s60, s67, 0x760000
    buffer_load_dword v7, v7, s[28:31], s60 offen sc1
    s_and_b32 s6, s3, 3
    s_lshl_b32 s56, s6, 13
    s_lshl_b32 s57, s6, 12
    s_add_u32 s66, s63, s56
    s_add_u32 s70, s63, s57
    s_add_u32 s59, s41, 2
    s_waitcnt vmcnt(0)
    s_mov_b32 s61, 0
Lpoll_45:
    v_subrev_u32 v7, s59, v7
    v_cmp_le_u32 vcc, 16, v7
    s_cbranch_vccz Lpd_46
    s_sleep 2
    v_min_u32 v7, 1, v1
    v_lshlrev_b32 v7, 10, v7
    s_add_u32 s60, s67, 0x760000
    buffer_load_dword v7, v7, s[28:31], s60 offen sc1
    s_waitcnt vmcnt(0)
    s_add_u32 s61, s61, 1
    s_cmp_lt_u32 s61, 200000
    s_cbranch_scc1 Lpoll_45
Lpd_46:
    s_add_u32 m0, s56, 81920
    s_add_u32 s64, s66, 0x0
    buffer_load_dwordx4 v2, s[28:31], s64 offen offset:0 sc1 lds
    buffer_load_dwordx4 v2, s[28:31], s64 offen offset:1024 sc1 lds
    buffer_load_dwordx4 v2, s[28:31], s64 offen offset:2048 sc1 lds
    buffer_load_dwordx4 v2, s[28:31], s64 offen offset:3072 sc1 lds
    s_add_u32 m0, s56, 86016
    s_add_u32 s64, s66, 0x1000
    buffer_load_dwordx4 v2, s[28:31], s64 offen offset:0 sc1 lds
    buffer_load_dwordx4 v2, s[28:31], s64 offen offset:1024 sc1 lds
    buffer_load_dwordx4 v2, s[28:31], s64 offen offset:2048 sc1 lds
    buffer_load_dwordx4 v2, s[28:31], s64 offen offset:3072 sc1 lds
    s_add_u32 m0, s56, 114688
    s_add_u32 s64, s66, 0x8000
    buffer_load_dwordx4 v2, s[28:31], s64 offen offset:0 sc1 lds
    buffer_load_dwordx4 v2, s[28:31], s64 offen offset:1024 sc1 lds
    buffer_load_dwordx4 v2, s[28:31], s64 offen offset:2048 sc1 lds
    buffer_load_dwordx4 v2, s[28:31], s64 offen offset:3072 sc1 lds
    s_add_u32 m0, s56, 118784
    s_add_u32 s64, s66, 0x9000
    buffer_load_dwordx4 v2, s[28:31], s64 offen offset:0 sc1 lds
    buffer_load_dwordx4 v2, s[28:31], s64 offen offset:1024 sc1 lds
    buffer_load_dwordx4 v2, s[28:31], s64 offen offset:2048 sc1 lds
    buffer_load_dwordx4 v2, s[28:31], s64 offen offset:3072 sc1 lds
    s_add_u32 m0, s57, 147456
    s_add_u32 s64, s70, 0x10000
    buffer_load_dwordx4 v2, s[28:31], s64 offen offset:0 sc1 lds
    buffer_load_dwordx4 v2, s[28:31], s64 offen offset:1024 sc1 lds
    buffer_load_dwordx4 v2, s[28:31], s64 offen offset:2048 sc1 lds
    buffer_load_dwordx4 v2, s[28:31], s64 offen offset:3072 sc1 lds
    v_add_u32 v5, 81920, v3
    v_add_u32 v6, 122880, v3
    s_waitcnt vmcnt(12)
    v_mov_b32 v7, 9744
    v_mov_b32 v0, s26
    ds_write_b32 v7, v0
    s_waitcnt lgkmcnt(0)
    s_barrier
    s_cmp_eq_u32 s3, 7
    s_cbranch_scc1 LS_12
    s_cmp_lt_u32 s3, s43
    s_cbranch_scc1 Llate_17
    s_waitcnt vmcnt(0)
    v_mov_b32 v7, 9728
    v_mov_b32 v0, 1
    s_mov_b64 exec, 1
    ds_add_u32 v7, v0
    s_mov_b64 exec, -1
    v_mov_b32 v7, 9732
    v_mov_b32 v0, 1
    s_mov_b64 exec, 1
    ds_add_u32 v7, v0
    s_mov_b64 exec, -1
    buffer_load_dwordx4 v[136:139], v2, s[28:31], s16 offen offset:0 sc1
    buffer_load_dwordx4 v[140:143], v2, s[28:31], s16 offen offset:1024 sc1
    buffer_load_dwordx4 v[144:147], v2, s[28:31], s16 offen offset:2048 sc1
    buffer_load_dwordx4 v[148:151], v2, s[28:31], s16 offen offset:3072 sc1
    s_add_u32 s64, s16, 4096
    buffer_load_dwordx4 v[152:155], v2, s[28:31], s64 offen sc1
    buffer_load_dwordx4 v[156:159], v2, s[28:31], s17 offen offset:0 sc1
    buffer_load_dwordx4 v[160:163], v2, s[28:31], s17 offen offset:1024 sc1
    buffer_load_dwordx4 v[164:167], v2, s[28:31], s17 offen offset:2048 sc1
    buffer_load_dwordx4 v[168:171], v2, s[28:31], s17 offen offset:3072 sc1
    s_add_u32 s64, s17, 4096
    buffer_load_dwordx4 v[172:175], v2, s[28:31], s64 offen sc1
    buffer_load_dwordx4 v[176:179], v2, s[28:31], s18 offen offset:0 sc1
    buffer_load_dwordx4 v[180:183], v2, s[28:31], s18 offen offset:1024 sc1
    buffer_load_dwordx4 v[184:187], v2, s[28:31], s18 offen offset:2048 sc1
    buffer_load_dwordx4 v[188:191], v2, s[28:31], s18 offen offset:3072 sc1
    s_add_u32 s64, s18, 4096
    buffer_load_dwordx4 v[192:195], v2, s[28:31], s64 offen sc1
    buffer_load_dwordx4 v[196:199], v2, s[28:31], s19 offen offset:0 sc1
    buffer_load_dwordx4 v[200:203], v2, s[28:31], s19 offen offset:1024 sc1
    buffer_load_dwordx4 v[204:207], v2, s[28:31], s19 offen offset:2048 sc1
    buffer_load_dwordx4 v[208:211], v2, s[28:31], s19 offen offset:3072 sc1
    s_add_u32 s64, s19, 4096
    buffer_load_dwordx4 v[212:215], v2, s[28:31], s64 offen sc1
    s_branch Lg2_14
Llate_17:
    s_setprio 2
    s_add_u32 s64, s46, 0
    buffer_load_dwordx4 v[88:91], v2, s[28:31], s64 offen sc1
    s_add_u32 s64, s46, 1024
    buffer_load_dwordx4 v[92:95], v2, s[28:31], s64 offen sc1
    s_add_u32 s64, s46, 2048
    buffer_load_dwordx4 v[96:99], v2, s[28:31], s64 offen sc1
    s_add_u32 s64, s46, 3072
    buffer_load_dwordx4 v[100:103], v2, s[28:31], s64 offen sc1
    s_waitcnt vmcnt(4)
    v_mov_b32 v7, 9728
    v_mov_b32 v0, 1
    s_mov_b64 exec, 1
    ds_add_u32 v7, v0
    s_mov_b64 exec, -1
    s_lshl_b32 s6, s42, 6
    v_lshl_add_u32 v7, v10, 2, s6
    s_movk_i32 s7, 6912
    v_mad_u32_u24 v7, v4, s7, v7
    s_mov_b32 s7, 0x510000
    buffer_load_dword v16, v7, s[28:31], s7 offen sc1
    s_mov_b32 s7, 0x513600
    buffer_load_dword v17, v7, s[28:31], s7 offen sc1
    s_mov_b32 s7, 0x516c00
    buffer_load_dword v18, v7, s[28:31], s7 offen sc1
    s_mov_b32 s7, 0x51a200
    buffer_load_dword v19, v7, s[28:31], s7 offen sc1
    s_mov_b32 s7, 0x51d800
    buffer_load_dword v20, v7, s[28:31], s7 offen sc1
    s_mov_b32 s7, 0x520e00
    buffer_load_dword v21, v7, s[28:31], s7 offen sc1
    s_mov_b32 s7, 0x524400
    buffer_load_dword v22, v7, s[28:31], s7 offen sc1
    s_mov_b32 s7, 0x527a00
    buffer_load_dword v23, v7, s[28:31], s7 offen sc1
    s_mov_b32 s7, 0x52b000
    buffer_load_dword v24, v7, s[28:31], s7 offen sc1
    s_mov_b32 s7, 0x52e600
    buffer_load_dword v25, v7, s[28:31], s7 offen sc1
    s_add_u32 s64, s46, 4096
    buffer_load_dwordx4 v[104:107], v2, s[28:31], s64 offen sc1
    s_add_u32 s64, s46, 5120
    buffer_load_dwordx4 v[108:111], v2, s[28:31], s64 offen sc1
    s_add_u32 s64, s46, 6144
    buffer_load_dwordx4 v[112:115], v2, s[28:31], s64 offen sc1
    s_add_u32 s64, s46, 7168
    buffer_load_dwordx4 v[116:119], v2, s[28:31], s64 offen sc1
    s_add_u32 s64, s46, 8192
    buffer_load_dwordx4 v[120:123], v2, s[28:31], s64 offen sc1
    s_add_u32 s64, s46, 9216
    buffer_load_dwordx4 v[124:127], v2, s[28:31], s64 offen sc1
    s_add_u32 s64, s46, 10240
    buffer_load_dwordx4 v[128:131], v2, s[28:31], s64 offen sc1
    s_add_u32 s64, s46, 11264
    buffer_load_dwordx4 v[132:135], v2, s[28:31], s64 offen sc1
    buffer_load_dwordx4 v[136:139], v2, s[28:31], s16 offen offset:0 sc1
    buffer_load_dwordx4 v[140:143], v2, s[28:31], s16 offen offset:1024 sc1
    buffer_load_dwordx4 v[144:147], v2, s[28:31], s16 offen offset:2048 sc1
    buffer_load_dwordx4 v[148:151], v2, s[28:31], s16 offen offset:3072 sc1
    s_add_u32 s64, s16, 4096
    buffer_load_dwordx4 v[152:155], v2, s[28:31], s64 offen sc1
    buffer_load_dwordx4 v[156:159], v2, s[28:31], s17 offen offset:0 sc1
    buffer_load_dwordx4 v[160:163], v2, s[28:31], s17 offen offset:1024 sc1
    buffer_load_dwordx4 v[164:167], v2, s[28:31], s17 offen offset:2048 sc1
    s_waitcnt vmcnt(16)
    v_add_f32 v16, v16, v17
    v_add_f32 v16, v16, v18
    v_add_f32 v16, v16, v19
    v_add_f32 v16, v16, v20
    v_add_f32 v16, v16, v21
    v_add_f32 v16, v16, v22
    v_add_f32 v16, v16, v23
    v_add_f32 v16, v16, v24
    v_add_f32 v16, v16, v25
    v_mov_b32 v15, v16
    s_nop 1
    v_permlane32_swap_b32 v16, v15
    v_add_f32 v15, v16, v15
    s_lshl_b32 s6, s3, 7
    v_lshl_add_u32 v7, v10, 2, s6
    ds_write_b32 v7, v15 offset:19456
    v_add_u32 v13, s69, v2
    ds_read_b128 v[48:51], v5 offset:0
    ds_read_b128 v[52:55], v5 offset:256
    ds_read_b128 v[56:59], v5 offset:512
    ds_read_b128 v[60:63], v5 offset:768
    ds_read_b128 v[80:83], v13 offset:0
    s_add_u32 s56, s46, 12288
    s_add_u32 s57, s46, 16384
    s_waitcnt lgkmcnt(0)
    v_mfma_f32_16x16x32_bf16 v[16:19], v[88:91], v[48:51], 0
    ds_read_b128 v[64:67], v5 offset:4096
    v_mfma_f32_16x16x32_bf16 v[20:23], v[88:91], v[52:55], 0
    ds_read_b128 v[68:71], v5 offset:4352
    v_mfma_f32_16x16x32_bf16 v[24:27], v[88:91], v[56:59], 0
    ds_read_b128 v[72:75], v5 offset:4608
    v_mfma_f32_16x16x32_bf16 v[28:31], v[88:91], v[60:63], 0
    ds_read_b128 v[76:79], v5 offset:4864
    v_mfma_f32_16x16x32_bf16 v[32:35], v[80:83], v[48:51], 0
    ds_read_b128 v[84:87], v13 offset:1024
    v_mfma_f32_16x16x32_bf16 v[36:39], v[80:83], v[52:55], 0
    s_add_u32 m0, s69, 0
    s_add_u32 s66, s46, 29696
    buffer_load_dwordx4 v2, s[28:31], s66 offen offset:0 sc1 lds
    v_mfma_f32_16x16x32_bf16 v[40:43], v[80:83], v[56:59], 0
    buffer_load_dwordx4 v[88:91], v2, s[28:31], s56 offen offset:0 sc1
    v_mfma_f32_16x16x32_bf16 v[44:47], v[80:83], v[60:63], 0
    s_waitcnt lgkmcnt(0)
    v_mfma_f32_16x16x32_bf16 v[16:19], v[92:95], v[64:67], v[16:19]
    ds_read_b128 v[48:51], v5 offset:8192
    v_mfma_f32_16x16x32_bf16 v[20:23], v[92:95], v[68:71], v[20:23]
    ds_read_b128 v[52:55], v5 offset:8448
    v_mfma_f32_16x16x32_bf16 v[24:27], v[92:95], v[72:75], v[24:27]
    ds_read_b128 v[56:59], v5 offset:8704
    v_mfma_f32_16x16x32_bf16 v[28:31], v[92:95], v[76:79], v[28:31]
    ds_read_b128 v[60:63], v5 offset:8960
    v_mfma_f32_16x16x32_bf16 v[32:35], v[84:87], v[64:67], v[32:35]
    ds_read_b128 v[80:83], v13 offset:2048
    v_mfma_f32_16x16x32_bf16 v[36:39], v[84:87], v[68:71], v[36:39]
    buffer_load_dwordx4 v2, s[28:31], s66 offen offset:1024 sc1 lds
    v_mfma_f32_16x16x32_bf16 v[40:43], v[84:87], v[72:75], v[40:43]
    buffer_load_dwordx4 v[92:95], v2, s[28:31], s56 offen offset:1024 sc1
    v_mfma_f32_16x16x32_bf16 v[44:47], v[84:87], v[76:79], v[44:47]
    s_waitcnt lgkmcnt(0)
    v_mfma_f32_16x16x32_bf16 v[16:19], v[96:99], v[48:51], v[16:19]
    ds_read_b128 v[64:67], v5 offset:12288
    v_mfma_f32_16x16x32_bf16 v[20:23], v[96:99], v[52:55], v[20:23]
    ds_read_b128 v[68:71], v5 offset:12544
    v_mfma_f32_16x16x32_bf16 v[24:27], v[96:99], v[56:59], v[24:27]
    ds_read_b128 v[72:75], v5 offset:12800
    v_mfma_f32_16x16x32_bf16 v[28:31], v[96:99], v[60:63], v[28:31]
    ds_read_b128 v[76:79], v5 offset:13056
    v_mfma_f32_16x16x32_bf16 v[32:35], v[80:83], v[48:51], v[32:35]
    ds_read_b128 v[84:87], v13 offset:3072
    v_mfma_f32_16x16x32_bf16 v[36:39], v[80:83], v[52:55], v[36:39]
    buffer_load_dwordx4 v2, s[28:31], s66 offen offset:2048 sc1 lds
    v_mfma_f32_16x16x32_bf16 v[40:43], v[80:83], v[56:59], v[40:43]
    buffer_load_dwordx4 v[96:99], v2, s[28:31], s56 offen offset:2048 sc1
    v_mfma_f32_16x16x32_bf16 v[44:47], v[80:83], v[60:63], v[44:47]
    s_waitcnt lgkmcnt(0)
    v_mfma_f32_16x16x32_bf16 v[16:19], v[100:103], v[64:67], v[16:19]
    ds_read_b128 v[48:51], v5 offset:16384
    v_mfma_f32_16x16x32_bf16 v[20:23], v[100:103], v[68:71], v[20:23]
    ds_read_b128 v[52:55], v5 offset:16640
    v_mfma_f32_16x16x32_bf16 v[24:27], v[100:103], v[72:75], v[24:27]
    ds_read_b128 v[56:59], v5 offset:16896
    v_mfma_f32_16x16x32_bf16 v[28:31], v[100:103], v[76:79], v[28:31]
    ds_read_b128 v[60:63], v5 offset:17152
    v_mfma_f32_16x16x32_bf16 v[32:35], v[84:87], v[64:67], v[32:35]
    ds_read_b128 v[80:83], v13 offset:4096
    v_mfma_f32_16x16x32_bf16 v[36:39], v[84:87], v[68:71], v[36:39]
    buffer_load_dwordx4 v2, s[28:31], s66 offen offset:3072 sc1 lds
    v_mfma_f32_16x16x32_bf16 v[40:43], v[84:87], v[72:75], v[40:43]
    buffer_load_dwordx4 v[100:103], v2, s[28:31], s56 offen offset:3072 sc1
    v_mfma_f32_16x16x32_bf16 v[44:47], v[84:87], v[76:79], v[44:47]
    s_waitcnt vmcnt(23) lgkmcnt(0)
    v_mfma_f32_16x16x32_bf16 v[16:19], v[104:107], v[48:51], v[16:19]
    ds_read_b128 v[64:67], v5 offset:20480
    v_mfma_f32_16x16x32_bf16 v[20:23], v[104:107], v[52:55], v[20:23]
    ds_read_b128 v[68:71], v5 offset:20736
    v_mfma_f32_16x16x32_bf16 v[24:27], v[104:107], v[56:59], v[24:27]
    ds_read_b128 v[72:75], v5 offset:20992
    v_mfma_f32_16x16x32_bf16 v[28:31], v[104:107], v[60:63], v[28:31]
    ds_read_b128 v[76:79], v5 offset:21248
    v_mfma_f32_16x16x32_bf16 v[32:35], v[80:83], v[48:51], v[32:35]
    ds_read_b128 v[84:87], v13 offset:5120
    v_mfma_f32_16x16x32_bf16 v[36:39], v[80:83], v[52:55], v[36:39]
    s_add_u32 m0, s69, 4096
    s_add_u32 s66, s46, 33792
    buffer_load_dwordx4 v2, s[28:31], s66 offen offset:0 sc1 lds
    v_mfma_f32_16x16x32_bf16 v[40:43], v[80:83], v[56:59], v[40:43]
    buffer_load_dwordx4 v[104:107], v2, s[28:31], s57 offen offset:0 sc1
    v_mfma_f32_16x16x32_bf16 v[44:47], v[80:83], v[60:63], v[44:47]
    s_waitcnt vmcnt(24) lgkmcnt(0)
    v_mfma_f32_16x16x32_bf16 v[16:19], v[108:111], v[64:67], v[16:19]
    ds_read_b128 v[48:51], v5 offset:24576
    v_mfma_f32_16x16x32_bf16 v[20:23], v[108:111], v[68:71], v[20:23]
    ds_read_b128 v[52:55], v5 offset:24832
    v_mfma_f32_16x16x32_bf16 v[24:27], v[108:111], v[72:75], v[24:27]
    ds_read_b128 v[56:59], v5 offset:25088
    v_mfma_f32_16x16x32_bf16 v[28:31], v[108:111], v[76:79], v[28:31]
    ds_read_b128 v[60:63], v5 offset:25344
    v_mfma_f32_16x16x32_bf16 v[32:35], v[84:87], v[64:67], v[32:35]
    ds_read_b128 v[80:83], v13 offset:6144
    v_mfma_f32_16x16x32_bf16 v[36:39], v[84:87], v[68:71], v[36:39]
    buffer_load_dwordx4 v2, s[28:31], s66 offen offset:1024 sc1 lds
    v_mfma_f32_16x16x32_bf16 v[40:43], v[84:87], v[72:75], v[40:43]
    buffer_load_dwordx4 v[108:111], v2, s[28:31], s57 offen offset:1024 sc1
    v_mfma_f32_16x16x32_bf16 v[44:47], v[84:87], v[76:79], v[44:47]
    v_mov_b32 v7, 9728
    ds_read_b32 v7, v7
    s_waitcnt vmcnt(25) lgkmcnt(1)
    v_mfma_f32_16x16x32_bf16 v[16:19], v[112:115], v[48:51], v[16:19]
    ds_read_b128 v[64:67], v5 offset:28672
    v_mfma_f32_16x16x32_bf16 v[20:23], v[112:115], v[52:55], v[20:23]
    ds_read_b128 v[68:71], v5 offset:28928
    v_mfma_f32_16x16x32_bf16 v[24:27], v[112:115], v[56:59], v[24:27]
    ds_read_b128 v[72:75], v5 offset:29184
    v_mfma_f32_16x16x32_bf16 v[28:31], v[112:115], v[60:63], v[28:31]
    ds_read_b128 v[76:79], v5 offset:29440
    v_mfma_f32_16x16x32_bf16 v[32:35], v[80:83], v[48:51], v[32:35]
    ds_read_b128 v[84:87], v13 offset:7168
    v_mfma_f32_16x16x32_bf16 v[36:39], v[80:83], v[52:55], v[36:39]
    buffer_load_dwordx4 v2, s[28:31], s66 offen offset:2048 sc1 lds
    v_mfma_f32_16x16x32_bf16 v[40:43], v[80:83], v[56:59], v[40:43]
    buffer_load_dwordx4 v[112:115], v2, s[28:31], s57 offen offset:2048 sc1
    v_mfma_f32_16x16x32_bf16 v[44:47], v[80:83], v[60:63], v[44:47]
    s_waitcnt lgkmcnt(5)
    v_cmp_gt_u32 vcc, 4, v7
    s_cbranch_vccz Lcd_48
    s_mov_b32 s61, 0
Lcw_47:
    v_mov_b32 v7, 9728
    ds_read_b32 v7, v7
    s_waitcnt lgkmcnt(0)
    v_cmp_gt_u32 vcc, 4, v7
    s_cbranch_vccz Lcd_48
    s_sleep 1
    s_add_u32 s61, s61, 1
    s_cmp_lt_u32 s61, 200000
    s_cbranch_scc1 Lcw_47
Lcd_48:
    s_waitcnt vmcnt(26) lgkmcnt(0)
    v_mfma_f32_16x16x32_bf16 v[16:19], v[116:119], v[64:67], v[16:19]
    ds_read_b128 v[48:51], v5 offset:32768
    v_mfma_f32_16x16x32_bf16 v[20:23], v[116:119], v[68:71], v[20:23]
    ds_read_b128 v[52:55], v5 offset:33024
    v_mfma_f32_16x16x32_bf16 v[24:27], v[116:119], v[72:75], v[24:27]
    ds_read_b128 v[56:59], v5 offset:33280
    v_mfma_f32_16x16x32_bf16 v[28:31], v[116:119], v[76:79], v[28:31]
    ds_read_b128 v[60:63], v5 offset:33536
    v_mfma_f32_16x16x32_bf16 v[32:35], v[84:87], v[64:67], v[32:35]
    ds_read_b128 v[80:83], v13 offset:8192
    v_mfma_f32_16x16x32_bf16 v[36:39], v[84:87], v[68:71], v[36:39]
    buffer_load_dwordx4 v2, s[28:31], s66 offen offset:3072 sc1 lds
    v_mfma_f32_16x16x32_bf16 v[40:43], v[84:87], v[72:75], v[40:43]
    buffer_load_dwordx4 v[116:119], v2, s[28:31], s57 offen offset:3072 sc1
    v_mfma_f32_16x16x32_bf16 v[44:47], v[84:87], v[76:79], v[44:47]
    s_waitcnt vmcnt(15) lgkmcnt(0)
    v_mfma_f32_16x16x32_bf16 v[16:19], v[120:123], v[48:51], v[16:19]
    ds_read_b128 v[64:67], v5 offset:36864
    v_mfma_f32_16x16x32_bf16 v[20:23], v[120:123], v[52:55], v[20:23]
    ds_read_b128 v[68:71], v5 offset:37120
    v_mfma_f32_16x16x32_bf16 v[24:27], v[120:123], v[56:59], v[24:27]
    ds_read_b128 v[72:75], v5 offset:37376
    v_mfma_f32_16x16x32_bf16 v[28:31], v[120:123], v[60:63], v[28:31]
    ds_read_b128 v[76:79], v5 offset:37632
    v_mfma_f32_16x16x32_bf16 v[32:35], v[80:83], v[48:51], v[32:35]
    ds_read_b128 v[84:87], v13 offset:0
    v_mfma_f32_16x16x32_bf16 v[36:39], v[80:83], v[52:55], v[36:39]
    s_add_u32 m0, s69, 8192
    s_add_u32 s66, s46, 37888
    buffer_load_dwordx4 v2, s[28:31], s66 offen offset:0 sc1 lds
    v_mfma_f32_16x16x32_bf16 v[40:43], v[80:83], v[56:59], v[40:43]
    buffer_load_dwordx4 v[168:171], v2, s[28:31], s17 offen offset:3072 sc1
    v_mfma_f32_16x16x32_bf16 v[44:47], v[80:83], v[60:63], v[44:47]
    s_waitcnt vmcnt(15) lgkmcnt(0)
    v_mfma_f32_16x16x32_bf16 v[16:19], v[124:127], v[64:67], v[16:19]
    ds_read_b128 v[48:51], v6 offset:0
    v_mfma_f32_16x16x32_bf16 v[20:23], v[124:127], v[68:71], v[20:23]
    ds_read_b128 v[52:55], v6 offset:256
    v_mfma_f32_16x16x32_bf16 v[24:27], v[124:127], v[72:75], v[24:27]
    ds_read_b128 v[56:59], v6 offset:512
    v_mfma_f32_16x16x32_bf16 v[28:31], v[124:127], v[76:79], v[28:31]
    ds_read_b128 v[60:63], v6 offset:768
    v_mfma_f32_16x16x32_bf16 v[32:35], v[84:87], v[64:67], v[32:35]
    ds_read_b128 v[80:83], v13 offset:1024
    v_mfma_f32_16x16x32_bf16 v[36:39], v[84:87], v[68:71], v[36:39]
    s_add_u32 m0, s69, 0
    s_add_u32 s66, s46, 38912
    buffer_load_dwordx4 v2, s[28:31], s66 offen offset:0 sc1 lds
    v_mfma_f32_16x16x32_bf16 v[40:43], v[84:87], v[72:75], v[40:43]
    s_add_u32 s64, s17, 4096
    buffer_load_dwordx4 v[172:175], v2, s[28:31], s64 offen sc1
    v_mfma_f32_16x16x32_bf16 v[44:47], v[84:87], v[76:79], v[44:47]
    s_waitcnt vmcnt(15) lgkmcnt(0)
    v_mfma_f32_16x16x32_bf16 v[16:19], v[128:131], v[48:51], v[16:19]
    ds_read_b128 v[64:67], v6 offset:4096
    v_mfma_f32_16x16x32_bf16 v[20:23], v[128:131], v[52:55], v[20:23]
    ds_read_b128 v[68:71], v6 offset:4352
    v_mfma_f32_16x16x32_bf16 v[24:27], v[128:131], v[56:59], v[24:27]
    ds_read_b128 v[72:75], v6 offset:4608
    v_mfma_f32_16x16x32_bf16 v[28:31], v[128:131], v[60:63], v[28:31]
    ds_read_b128 v[76:79], v6 offset:4864
    v_mfma_f32_16x16x32_bf16 v[32:35], v[80:83], v[48:51], v[32:35]
    ds_read_b128 v[84:87], v13 offset:2048
    v_mfma_f32_16x16x32_bf16 v[36:39], v[80:83], v[52:55], v[36:39]
    buffer_load_dwordx4 v2, s[28:31], s66 offen offset:1024 sc1 lds
    v_mfma_f32_16x16x32_bf16 v[40:43], v[80:83], v[56:59], v[40:43]
    buffer_load_dwordx4 v[176:179], v2, s[28:31], s18 offen offset:0 sc1
    v_mfma_f32_16x16x32_bf16 v[44:47], v[80:83], v[60:63], v[44:47]
    s_waitcnt vmcnt(15) lgkmcnt(0)
    v_mfma_f32_16x16x32_bf16 v[16:19], v[132:135], v[64:67], v[16:19]
    ds_read_b128 v[48:51], v6 offset:8192
    v_mfma_f32_16x16x32_bf16 v[20:23], v[132:135], v[68:71], v[20:23]
    ds_read_b128 v[52:55], v6 offset:8448
    v_mfma_f32_16x16x32_bf16 v[24:27], v[132:135], v[72:75], v[24:27]
    ds_read_b128 v[56:59], v6 offset:8704
    v_mfma_f32_16x16x32_bf16 v[28:31], v[132:135], v[76:79], v[28:31]
    ds_read_b128 v[60:63], v6 offset:8960
    v_mfma_f32_16x16x32_bf16 v[32:35], v[84:87], v[64:67], v[32:35]
    ds_read_b128 v[80:83], v13 offset:3072
    v_mfma_f32_16x16x32_bf16 v[36:39], v[84:87], v[68:71], v[36:39]
    buffer_load_dwordx4 v[180:183], v2, s[28:31], s18 offen offset:1024 sc1
    v_mfma_f32_16x16x32_bf16 v[40:43], v[84:87], v[72:75], v[40:43]
    buffer_load_dwordx4 v[184:187], v2, s[28:31], s18 offen offset:2048 sc1
    v_mfma_f32_16x16x32_bf16 v[44:47], v[84:87], v[76:79], v[44:47]
    s_waitcnt vmcnt(15) lgkmcnt(0)
    v_mfma_f32_16x16x32_bf16 v[16:19], v[88:91], v[48:51], v[16:19]
    ds_read_b128 v[64:67], v6 offset:12288
    v_mfma_f32_16x16x32_bf16 v[20:23], v[88:91], v[52:55], v[20:23]
    ds_read_b128 v[68:71], v6 offset:12544
    v_mfma_f32_16x16x32_bf16 v[24:27], v[88:91], v[56:59], v[24:27]
    ds_read_b128 v[72:75], v6 offset:12800
    v_mfma_f32_16x16x32_bf16 v[28:31], v[88:91], v[60:63], v[28:31]
    ds_read_b128 v[76:79], v6 offset:13056
    v_mfma_f32_16x16x32_bf16 v[32:35], v[80:83], v[48:51], v[32:35]
    ds_read_b128 v[84:87], v13 offset:4096
    v_mfma_f32_16x16x32_bf16 v[36:39], v[80:83], v[52:55], v[36:39]
    buffer_load_dwordx4 v[188:191], v2, s[28:31], s18 offen offset:3072 sc1
    v_mfma_f32_16x16x32_bf16 v[40:43], v[80:83], v[56:59], v[40:43]
    s_add_u32 s64, s18, 4096
    buffer_load_dwordx4 v[192:195], v2, s[28:31], s64 offen sc1
    v_mfma_f32_16x16x32_bf16 v[44:47], v[80:83], v[60:63], v[44:47]
    s_waitcnt vmcnt(15) lgkmcnt(0)
    v_mfma_f32_16x16x32_bf16 v[16:19], v[92:95], v[64:67], v[16:19]
    ds_read_b128 v[48:51], v6 offset:16384
    v_mfma_f32_16x16x32_bf16 v[20:23], v[92:95], v[68:71], v[20:23]
    ds_read_b128 v[52:55], v6 offset:16640
    v_mfma_f32_16x16x32_bf16 v[24:27], v[92:95], v[72:75], v[24:27]
    ds_read_b128 v[56:59], v6 offset:16896
    v_mfma_f32_16x16x32_bf16 v[28:31], v[92:95], v[76:79], v[28:31]
    ds_read_b128 v[60:63], v6 offset:17152
    v_mfma_f32_16x16x32_bf16 v[32:35], v[84:87], v[64:67], v[32:35]
    ds_read_b128 v[80:83], v13 offset:5120
    v_mfma_f32_16x16x32_bf16 v[36:39], v[84:87], v[68:71], v[36:39]
    buffer_load_dwordx4 v[196:199], v2, s[28:31], s19 offen offset:0 sc1
    v_mfma_f32_16x16x32_bf16 v[40:43], v[84:87], v[72:75], v[40:43]
    v_mfma_f32_16x16x32_bf16 v[44:47], v[84:87], v[76:79], v[44:47]
    s_waitcnt vmcnt(14) lgkmcnt(0)
    v_mfma_f32_16x16x32_bf16 v[16:19], v[96:99], v[48:51], v[16:19]
    ds_read_b128 v[64:67], v6 offset:20480
    v_mfma_f32_16x16x32_bf16 v[20:23], v[96:99], v[52:55], v[20:23]
    ds_read_b128 v[68:71], v6 offset:20736
    v_mfma_f32_16x16x32_bf16 v[24:27], v[96:99], v[56:59], v[24:27]
    ds_read_b128 v[72:75], v6 offset:20992
    v_mfma_f32_16x16x32_bf16 v[28:31], v[96:99], v[60:63], v[28:31]
    ds_read_b128 v[76:79], v6 offset:21248
    v_mfma_f32_16x16x32_bf16 v[32:35], v[80:83], v[48:51], v[32:35]
    ds_read_b128 v[84:87], v13 offset:6144
    v_mfma_f32_16x16x32_bf16 v[36:39], v[80:83], v[52:55], v[36:39]
    v_mfma_f32_16x16x32_bf16 v[40:43], v[80:83], v[56:59], v[40:43]
    v_mfma_f32_16x16x32_bf16 v[44:47], v[80:83], v[60:63], v[44:47]
    s_waitcnt vmcnt(12) lgkmcnt(0)
    v_mfma_f32_16x16x32_bf16 v[16:19], v[100:103], v[64:67], v[16:19]
    ds_read_b128 v[48:51], v6 offset:24576
    v_mfma_f32_16x16x32_bf16 v[20:23], v[100:103], v[68:71], v[20:23]
    ds_read_b128 v[52:55], v6 offset:24832
    v_mfma_f32_16x16x32_bf16 v[24:27], v[100:103], v[72:75], v[24:27]
    ds_read_b128 v[56:59], v6 offset:25088
    v_mfma_f32_16x16x32_bf16 v[28:31], v[100:103], v[76:79], v[28:31]
    ds_read_b128 v[60:63], v6 offset:25344
    v_mfma_f32_16x16x32_bf16 v[32:35], v[84:87], v[64:67], v[32:35]
    ds_read_b128 v[80:83], v13 offset:7168
    v_mfma_f32_16x16x32_bf16 v[36:39], v[84:87], v[68:71], v[36:39]
    v_mfma_f32_16x16x32_bf16 v[40:43], v[84:87], v[72:75], v[40:43]
    v_mfma_f32_16x16x32_bf16 v[44:47], v[84:87], v[76:79], v[44:47]
    s_waitcnt vmcnt(10) lgkmcnt(0)
    v_mfma_f32_16x16x32_bf16 v[16:19], v[104:107], v[48:51], v[16:19]
    ds_read_b128 v[64:67], v6 offset:28672
    v_mfma_f32_16x16x32_bf16 v[20:23], v[104:107], v[52:55], v[20:23]
    ds_read_b128 v[68:71], v6 offset:28928
    v_mfma_f32_16x16x32_bf16 v[24:27], v[104:107], v[56:59], v[24:27]
    ds_read_b128 v[72:75], v6 offset:29184
    v_mfma_f32_16x16x32_bf16 v[28:31], v[104:107], v[60:63], v[28:31]
    ds_read_b128 v[76:79], v6 offset:29440
    v_mfma_f32_16x16x32_bf16 v[32:35], v[80:83], v[48:51], v[32:35]
    ds_read_b128 v[84:87], v13 offset:8192
    v_mfma_f32_16x16x32_bf16 v[36:39], v[80:83], v[52:55], v[36:39]
    v_mfma_f32_16x16x32_bf16 v[40:43], v[80:83], v[56:59], v[40:43]
    v_mfma_f32_16x16x32_bf16 v[44:47], v[80:83], v[60:63], v[44:47]
    s_waitcnt vmcnt(8) lgkmcnt(0)
    v_mfma_f32_16x16x32_bf16 v[16:19], v[108:111], v[64:67], v[16:19]
    ds_read_b128 v[48:51], v6 offset:32768
    v_mfma_f32_16x16x32_bf16 v[20:23], v[108:111], v[68:71], v[20:23]
    ds_read_b128 v[52:55], v6 offset:33024
    v_mfma_f32_16x16x32_bf16 v[24:27], v[108:111], v[72:75], v[24:27]
    ds_read_b128 v[56:59], v6 offset:33280
    v_mfma_f32_16x16x32_bf16 v[28:31], v[108:111], v[76:79], v[28:31]
    ds_read_b128 v[60:63], v6 offset:33536
    v_mfma_f32_16x16x32_bf16 v[32:35], v[84:87], v[64:67], v[32:35]
    ds_read_b128 v[80:83], v13 offset:0
    v_mfma_f32_16x16x32_bf16 v[36:39], v[84:87], v[68:71], v[36:39]
    v_mfma_f32_16x16x32_bf16 v[40:43], v[84:87], v[72:75], v[40:43]
    v_mfma_f32_16x16x32_bf16 v[44:47], v[84:87], v[76:79], v[44:47]
    s_waitcnt vmcnt(6) lgkmcnt(0)
    v_mfma_f32_16x16x32_bf16 v[16:19], v[112:115], v[48:51], v[16:19]
    ds_read_b128 v[64:67], v6 offset:36864
    v_mfma_f32_16x16x32_bf16 v[20:23], v[112:115], v[52:55], v[20:23]
    ds_read_b128 v[68:71], v6 offset:37120
    v_mfma_f32_16x16x32_bf16 v[24:27], v[112:115], v[56:59], v[24:27]
    ds_read_b128 v[72:75], v6 offset:37376
    v_mfma_f32_16x16x32_bf16 v[28:31], v[112:115], v[60:63], v[28:31]
    ds_read_b128 v[76:79], v6 offset:37632
    v_mfma_f32_16x16x32_bf16 v[32:35], v[80:83], v[48:51], v[32:35]
    ds_read_b128 v[84:87], v13 offset:1024
    v_mfma_f32_16x16x32_bf16 v[36:39], v[80:83], v[52:55], v[36:39]
    v_mfma_f32_16x16x32_bf16 v[40:43], v[80:83], v[56:59], v[40:43]
    v_mfma_f32_16x16x32_bf16 v[44:47], v[80:83], v[60:63], v[44:47]
    s_waitcnt lgkmcnt(0)
    v_mfma_f32_16x16x32_bf16 v[16:19], v[116:119], v[64:67], v[16:19]
    s_lshl_b32 s6, s3, 7
    v_lshl_add_u32 v7, v9, 4, s6
    ds_read_b128 v[48:51], v7 offset:19456
    ds_read_b128 v[52:55], v7 offset:19520
    v_mfma_f32_16x16x32_bf16 v[20:23], v[116:119], v[68:71], v[20:23]
    v_lshlrev_b32 v7, 2, v8
    ds_read_b32 v60, v7 offset:9472
    ds_read_b32 v61, v7 offset:9536
    ds_read_b32 v62, v7 offset:9600
    ds_read_b32 v63, v7 offset:9664
    ds_read_b32 v56, v7 offset:9216
    ds_read_b32 v57, v7 offset:9280
    ds_read_b32 v58, v7 offset:9344
    ds_read_b32 v59, v7 offset:9408
    v_mfma_f32_16x16x32_bf16 v[24:27], v[116:119], v[72:75], v[24:27]
    v_mfma_f32_16x16x32_bf16 v[28:31], v[116:119], v[76:79], v[28:31]
    v_mfma_f32_16x16x32_bf16 v[32:35], v[84:87], v[64:67], v[32:35]
    v_mfma_f32_16x16x32_bf16 v[36:39], v[84:87], v[68:71], v[36:39]
    v_mfma_f32_16x16x32_bf16 v[40:43], v[84:87], v[72:75], v[40:43]
    v_mfma_f32_16x16x32_bf16 v[44:47], v[84:87], v[76:79], v[44:47]
    s_setprio 3
    s_lshl_b32 s65, s42, 11
    s_add_u32 s65, s65, s49
    s_add_u32 s65, s65, 0x16e0000
    s_mov_b32 s61, 0
Lsw_49:
    s_waitcnt lgkmcnt(0)
    v_min_u32 v7, v60, v61
    v_min3_u32 v7, v7, v62, v63
    v_cmp_eq_u32 vcc, 0, v7
    s_cbranch_vccz Lsd_50
    s_sleep 1
    v_lshlrev_b32 v7, 2, v8
    ds_read_b32 v60, v7 offset:9472
    ds_read_b32 v61, v7 offset:9536
    ds_read_b32 v62, v7 offset:9600
    ds_read_b32 v63, v7 offset:9664
    ds_read_b32 v56, v7 offset:9216
    ds_read_b32 v57, v7 offset:9280
    ds_read_b32 v58, v7 offset:9344
    ds_read_b32 v59, v7 offset:9408
    s_add_u32 s61, s61, 1
    s_cmp_lt_u32 s61, 200000
    s_cbranch_scc1 Lsw_49
    s_waitcnt lgkmcnt(0)
Lsd_50:
    v_lshlrev_b32 v7, 10, v4
    v_lshl_add_u32 v7, v10, 4, v7
    v_fma_f32 v16, -v56, v48, v16
    v_fma_f32 v17, -v56, v49, v17
    v_fma_f32 v18, -v56, v50, v18
    v_fma_f32 v19, -v56, v51, v19
    v_fma_f32 v20, -v57, v48, v20
    v_fma_f32 v21, -v57, v49, v21
    v_fma_f32 v22, -v57, v50, v22
    v_fma_f32 v23, -v57, v51, v23
    v_mul_f32 v16, v16, v60
    v_mul_f32 v17, v17, v60
    v_mul_f32 v18, v18, v60
    v_mul_f32 v19, v19, v60
    v_mul_f32 v20, v20, v61
    v_mul_f32 v21, v21, v61
    v_mul_f32 v22, v22, v61
    v_mul_f32 v23, v23, v61
    v_cvt_pk_bf16_f32 v16, v16, v17
    v_cvt_pk_bf16_f32 v17, v18, v19
    v_cvt_pk_bf16_f32 v18, v20, v21
    v_cvt_pk_bf16_f32 v19, v22, v23
    v_pk_max_i16 v16, v16, 0
    v_pk_max_i16 v17, v17, 0
    v_pk_max_i16 v18, v18, 0
    v_pk_max_i16 v19, v19, 0
    s_nop 0
    v_permlane16_swap_b32 v16, v18
    v_permlane16_swap_b32 v17, v19
    buffer_store_dwordx4 v[16:19], v7, s[28:31], s65 offen offset:0 sc1
    v_fma_f32 v24, -v58, v48, v24
    v_fma_f32 v25, -v58, v49, v25
    v_fma_f32 v26, -v58, v50, v26
    v_fma_f32 v27, -v58, v51, v27
    v_fma_f32 v28, -v59, v48, v28
    v_fma_f32 v29, -v59, v49, v29
    v_fma_f32 v30, -v59, v50, v30
    v_fma_f32 v31, -v59, v51, v31
    v_mul_f32 v24, v24, v62
    v_mul_f32 v25, v25, v62
    v_mul_f32 v26, v26, v62
    v_mul_f32 v27, v27, v62
    v_mul_f32 v28, v28, v63
    v_mul_f32 v29, v29, v63
    v_mul_f32 v30, v30, v63
    v_mul_f32 v31, v31, v63
    v_cvt_pk_bf16_f32 v24, v24, v25
    v_cvt_pk_bf16_f32 v25, v26, v27
    v_cvt_pk_bf16_f32 v26, v28, v29
    v_cvt_pk_bf16_f32 v27, v30, v31
    v_pk_max_i16 v24, v24, 0
    v_pk_max_i16 v25, v25, 0
    v_pk_max_i16 v26, v26, 0
    v_pk_max_i16 v27, v27, 0
    s_nop 0
    v_permlane16_swap_b32 v24, v26
    v_permlane16_swap_b32 v25, v27
    buffer_store_dwordx4 v[24:27], v7, s[28:31], s65 offen offset:512 sc1
    v_fma_f32 v32, -v56, v52, v32
    v_fma_f32 v33, -v56, v53, v33
    v_fma_f32 v34, -v56, v54, v34
    v_fma_f32 v35, -v56, v55, v35
    v_fma_f32 v36, -v57, v52, v36
    v_fma_f32 v37, -v57, v53, v37
    v_fma_f32 v38, -v57, v54, v38
    v_fma_f32 v39, -v57, v55, v39
    v_mul_f32 v32, v32, v60
    v_mul_f32 v33, v33, v60
    v_mul_f32 v34, v34, v60
    v_mul_f32 v35, v35, v60
    v_mul_f32 v36, v36, v61
    v_mul_f32 v37, v37, v61
    v_mul_f32 v38, v38, v61
    v_mul_f32 v39, v39, v61
    v_cvt_pk_bf16_f32 v32, v32, v33
    v_cvt_pk_bf16_f32 v33, v34, v35
    v_cvt_pk_bf16_f32 v34, v36, v37
    v_cvt_pk_bf16_f32 v35, v38, v39
    v_pk_max_i16 v32, v32, 0
    v_pk_max_i16 v33, v33, 0
    v_pk_max_i16 v34, v34, 0
    v_pk_max_i16 v35, v35, 0
    s_nop 0
    v_permlane16_swap_b32 v32, v34
    v_permlane16_swap_b32 v33, v35
    buffer_store_dwordx4 v[32:35], v7, s[28:31], s65 offen offset:2048 sc1
    v_fma_f32 v40, -v58, v52, v40
    v_fma_f32 v41, -v58, v53, v41
    v_fma_f32 v42, -v58, v54, v42
    v_fma_f32 v43, -v58, v55, v43
    v_fma_f32 v44, -v59, v52, v44
    v_fma_f32 v45, -v59, v53, v45
    v_fma_f32 v46, -v59, v54, v46
    v_fma_f32 v47, -v59, v55, v47
    v_mul_f32 v40, v40, v62
    v_mul_f32 v41, v41, v62
    v_mul_f32 v42, v42, v62
    v_mul_f32 v43, v43, v62
    v_mul_f32 v44, v44, v63
    v_mul_f32 v45, v45, v63
    v_mul_f32 v46, v46, v63
    v_mul_f32 v47, v47, v63
    v_cvt_pk_bf16_f32 v40, v40, v41
    v_cvt_pk_bf16_f32 v41, v42, v43
    v_cvt_pk_bf16_f32 v42, v44, v45
    v_cvt_pk_bf16_f32 v43, v46, v47
    v_pk_max_i16 v40, v40, 0
    v_pk_max_i16 v41, v41, 0
    v_pk_max_i16 v42, v42, 0
    v_pk_max_i16 v43, v43, 0
    s_nop 0
    v_permlane16_swap_b32 v40, v42
    v_permlane16_swap_b32 v41, v43
    buffer_store_dwordx4 v[40:43], v7, s[28:31], s65 offen offset:2560 sc1
    v_mov_b32 v7, 9732
    v_mov_b32 v0, 1
    s_mov_b64 exec, 1
    ds_add_u32 v7, v0
    s_mov_b64 exec, -1
    buffer_load_dwordx4 v[200:203], v2, s[28:31], s19 offen offset:1024 sc1
    buffer_load_dwordx4 v[204:207], v2, s[28:31], s19 offen offset:2048 sc1
    buffer_load_dwordx4 v[208:211], v2, s[28:31], s19 offen offset:3072 sc1
    s_add_u32 s64, s19, 4096
    buffer_load_dwordx4 v[212:215], v2, s[28:31], s64 offen sc1
    s_waitcnt vmcnt(4)
Lg2_14:
    s_add_u32 s62, s41, 4
    v_mov_b32 v0, s62
    v_writelane_b32 v0, s27, 1
    v_lshlrev_b32 v12, 2, v1
    s_mov_b32 exec_hi, 0
    s_add_u32 s62, s45, 0x80000
    buffer_store_dword v0, v12, s[28:31], s62 offen
    s_cmp_eq_u32 s26, 0
    s_cbranch_scc1 Lng_51
    buffer_store_dword v0, v12, s[28:31], s45 offen sc1
Lng_51:
    s_mov_b32 exec_hi, -1
    buffer_load_dwordx4 v[216:219], v2, s[28:31], s20 offen offset:0 sc1
    buffer_load_dwordx4 v[220:223], v2, s[28:31], s20 offen offset:1024 sc1
    buffer_load_dwordx4 v[224:227], v2, s[28:31], s20 offen offset:2048 sc1
    buffer_load_dwordx4 v[228:231], v2, s[28:31], s20 offen offset:3072 sc1
    s_add_u32 s64, s20, 4096
    buffer_load_dwordx4 v[232:235], v2, s[28:31], s64 offen sc1
    buffer_load_dwordx4 v[236:239], v2, s[28:31], s21 offen offset:0 sc1
    buffer_load_dwordx4 v[240:243], v2, s[28:31], s21 offen offset:1024 sc1
    buffer_load_dwordx4 v[244:247], v2, s[28:31], s21 offen offset:2048 sc1
    buffer_load_dwordx4 v[248:251], v2, s[28:31], s21 offen offset:3072 sc1
    s_add_u32 s64, s21, 4096
    buffer_load_dwordx4 v[252:255], v2, s[28:31], s64 offen sc1
    s_lshl_b32 s7, s3, 11
    s_lshl_b32 s67, s4, 13
    s_cmp_eq_u32 s26, 0
    s_cselect_b32 s6, 0x80000, 0
    s_add_u32 s67, s67, s6
    s_add_u32 s67, s67, s7
    v_and_b32 v11, 3, v1
    v_min_u32 v11, 2, v11
    v_lshlrev_b32 v11, 7, v11
    v_lshl_add_u32 v11, v4, 10, v11
    s_add_u32 s60, s67, 0x75e200
    buffer_load_dword v11, v11, s[28:31], s60 offen sc1
    s_add_u32 s59, s41, 4
    s_waitcnt vmcnt(0)
    s_mov_b32 s61, 0
Lpoll_52:
    v_subrev_u32 v11, s59, v11
    v_cmp_le_u32 vcc, 16, v11
    s_cbranch_vccz Lpd_53
    s_sleep 2
    v_and_b32 v11, 3, v1
    v_min_u32 v11, 2, v11
    v_lshlrev_b32 v11, 7, v11
    v_lshl_add_u32 v11, v4, 10, v11
    s_add_u32 s60, s67, 0x75e200
    buffer_load_dword v11, v11, s[28:31], s60 offen sc1
    s_waitcnt vmcnt(0)
    s_add_u32 s61, s61, 1
    s_cmp_lt_u32 s61, 200000
    s_cbranch_scc1 Lpoll_52
Lpd_53:
    v_add_u32 v12, 0x16e0000, v3
    v_add_u32 v13, s69, v2
    v_add_u32 v11, 81920, v13
    buffer_load_dwordx4 v[96:99], v12, s[28:31], s8 offen offset:0 sc1
    buffer_load_dwordx4 v[100:103], v12, s[28:31], s9 offen offset:0 sc1
    buffer_load_dwordx4 v[104:107], v12, s[28:31], s10 offen offset:0 sc1
    buffer_load_dwordx4 v[108:111], v12, s[28:31], s11 offen offset:0 sc1
    buffer_load_dwordx4 v[112:115], v12, s[28:31], s12 offen offset:0 sc1
    buffer_load_dwordx4 v[116:119], v12, s[28:31], s13 offen offset:0 sc1
    buffer_load_dwordx4 v[120:123], v12, s[28:31], s8 offen offset:256 sc1
    buffer_load_dwordx4 v[124:127], v12, s[28:31], s9 offen offset:256 sc1
    buffer_load_dwordx4 v[128:131], v12, s[28:31], s10 offen offset:256 sc1
    buffer_load_dwordx4 v[132:135], v12, s[28:31], s11 offen offset:256 sc1
    s_mov_b32 s61, 0
Lcw_54:
    v_mov_b32 v7, 9732
    ds_read_b32 v7, v7
    s_waitcnt lgkmcnt(0)
    v_cmp_gt_u32 vcc, 8, v7
    s_cbranch_vccz Lcd_55
    s_sleep 1
    s_add_u32 s61, s61, 1
    s_cmp_lt_u32 s61, 200000
    s_cbranch_scc1 Lcw_54
Lcd_55:
    v_mov_b32 v7, 9732
    v_mov_b32 v0, 1
    s_mov_b64 exec, 1
    ds_add_u32 v7, v0
    s_mov_b64 exec, -1
    s_setprio 0
    s_waitcnt vmcnt(9)
    v_mfma_f32_16x16x32_bf16 v[16:19], v[136:139], v[96:99], 0
    s_add_u32 m0, s69, 0
    s_add_u32 s64, s12, 256
    buffer_load_dwordx4 v12, s[28:31], s64 offen sc1 lds
    v_mfma_f32_16x16x32_bf16 v[20:23], v[140:143], v[96:99], 0
    s_add_u32 m0, s69, 1024
    s_add_u32 s64, s13, 256
    buffer_load_dwordx4 v12, s[28:31], s64 offen sc1 lds
    v_mfma_f32_16x16x32_bf16 v[24:27], v[144:147], v[96:99], 0
    v_mfma_f32_16x16x32_bf16 v[28:31], v[148:151], v[96:99], 0
    v_mfma_f32_16x16x32_bf16 v[32:35], v[152:155], v[96:99], 0
    s_waitcnt vmcnt(10)
    v_mfma_f32_16x16x32_bf16 v[16:19], v[156:159], v[100:103], v[16:19]
    s_add_u32 m0, s69, 2048
    s_add_u32 s64, s8, 512
    buffer_load_dwordx4 v12, s[28:31], s64 offen sc1 lds
    v_mfma_f32_16x16x32_bf16 v[20:23], v[160:163], v[100:103], v[20:23]
    s_add_u32 m0, s69, 3072
    s_add_u32 s64, s9, 512
    buffer_load_dwordx4 v12, s[28:31], s64 offen sc1 lds
    v_mfma_f32_16x16x32_bf16 v[24:27], v[164:167], v[100:103], v[24:27]
    buffer_load_dwordx4 v[96:99], v12, s[28:31], s9 offen offset:768 sc1
    v_mfma_f32_16x16x32_bf16 v[28:31], v[168:171], v[100:103], v[28:31]
    v_mfma_f32_16x16x32_bf16 v[32:35], v[172:175], v[100:103], v[32:35]
    s_waitcnt vmcnt(12)
    v_mfma_f32_16x16x32_bf16 v[16:19], v[176:179], v[104:107], v[16:19]
    s_add_u32 m0, s69, 4096
    s_add_u32 s64, s10, 512
    buffer_load_dwordx4 v12, s[28:31], s64 offen sc1 lds
    v_mfma_f32_16x16x32_bf16 v[20:23], v[180:183], v[104:107], v[20:23]
    s_add_u32 m0, s69, 5120
    s_add_u32 s64, s11, 512
    buffer_load_dwordx4 v12, s[28:31], s64 offen sc1 lds
    v_mfma_f32_16x16x32_bf16 v[24:27], v[184:187], v[104:107], v[24:27]
    buffer_load_dwordx4 v[100:103], v12, s[28:31], s10 offen offset:768 sc1
    v_mfma_f32_16x16x32_bf16 v[28:31], v[188:191], v[104:107], v[28:31]
    v_mfma_f32_16x16x32_bf16 v[32:35], v[192:195], v[104:107], v[32:35]
    s_waitcnt vmcnt(14)
    v_mfma_f32_16x16x32_bf16 v[16:19], v[196:199], v[108:111], v[16:19]
    s_add_u32 m0, s69, 6144
    s_add_u32 s64, s12, 512
    buffer_load_dwordx4 v12, s[28:31], s64 offen sc1 lds
    v_mfma_f32_16x16x32_bf16 v[20:23], v[200:203], v[108:111], v[20:23]
    s_add_u32 m0, s69, 7168
    s_add_u32 s64, s13, 512
    buffer_load_dwordx4 v12, s[28:31], s64 offen sc1 lds
    v_mfma_f32_16x16x32_bf16 v[24:27], v[204:207], v[108:111], v[24:27]
    buffer_load_dwordx4 v[104:107], v12, s[28:31], s11 offen offset:768 sc1
    v_mfma_f32_16x16x32_bf16 v[28:31], v[208:211], v[108:111], v[28:31]
    v_mfma_f32_16x16x32_bf16 v[32:35], v[212:215], v[108:111], v[32:35]
    s_waitcnt vmcnt(16)
    v_mfma_f32_16x16x32_bf16 v[16:19], v[216:219], v[112:115], v[16:19]
    s_add_u32 m0, s69, 8192
    s_add_u32 s64, s8, 768
    buffer_load_dwordx4 v12, s[28:31], s64 offen sc1 lds
    v_mfma_f32_16x16x32_bf16 v[20:23], v[220:223], v[112:115], v[20:23]
    buffer_load_dwordx4 v[108:111], v12, s[28:31], s12 offen offset:768 sc1
    v_mfma_f32_16x16x32_bf16 v[24:27], v[224:227], v[112:115], v[24:27]
    v_mfma_f32_16x16x32_bf16 v[28:31], v[228:231], v[112:115], v[28:31]
    v_mfma_f32_16x16x32_bf16 v[32:35], v[232:235], v[112:115], v[32:35]
    s_waitcnt vmcnt(17)
    v_mfma_f32_16x16x32_bf16 v[16:19], v[236:239], v[116:119], v[16:19]
    buffer_load_dwordx4 v[112:115], v12, s[28:31], s13 offen offset:768 sc1
    v_mfma_f32_16x16x32_bf16 v[20:23], v[240:243], v[116:119], v[20:23]
    v_mfma_f32_16x16x32_bf16 v[24:27], v[244:247], v[116:119], v[24:27]
    v_mfma_f32_16x16x32_bf16 v[28:31], v[248:251], v[116:119], v[28:31]
    v_mfma_f32_16x16x32_bf16 v[32:35], v[252:255], v[116:119], v[32:35]
    s_waitcnt vmcnt(17)
    v_mfma_f32_16x16x32_bf16 v[36:39], v[136:139], v[120:123], 0
    v_mfma_f32_16x16x32_bf16 v[40:43], v[140:143], v[120:123], 0
    v_mfma_f32_16x16x32_bf16 v[44:47], v[144:147], v[120:123], 0
    v_mfma_f32_16x16x32_bf16 v[48:51], v[148:151], v[120:123], 0
    v_mfma_f32_16x16x32_bf16 v[52:55], v[152:155], v[120:123], 0
    s_waitcnt vmcnt(13)
    v_mfma_f32_16x16x32_bf16 v[36:39], v[156:159], v[124:127], v[36:39]
    ds_read_b128 v[120:123], v13 offset:0
    v_mfma_f32_16x16x32_bf16 v[40:43], v[160:163], v[124:127], v[40:43]
    ds_write_b128 v11, v[16:19] offset:0
    v_mfma_f32_16x16x32_bf16 v[44:47], v[164:167], v[124:127], v[44:47]
    ds_write_b128 v11, v[20:23] offset:1024
    v_mfma_f32_16x16x32_bf16 v[48:51], v[168:171], v[124:127], v[48:51]
    v_mfma_f32_16x16x32_bf16 v[52:55], v[172:175], v[124:127], v[52:55]
    s_waitcnt vmcnt(12)
    v_mfma_f32_16x16x32_bf16 v[36:39], v[176:179], v[128:131], v[36:39]
    ds_read_b128 v[124:127], v13 offset:1024
    v_mfma_f32_16x16x32_bf16 v[40:43], v[180:183], v[128:131], v[40:43]
    ds_write_b128 v11, v[24:27] offset:2048
    v_mfma_f32_16x16x32_bf16 v[44:47], v[184:187], v[128:131], v[44:47]
    ds_write_b128 v11, v[28:31] offset:3072
    v_mfma_f32_16x16x32_bf16 v[48:51], v[188:191], v[128:131], v[48:51]
    v_mfma_f32_16x16x32_bf16 v[52:55], v[192:195], v[128:131], v[52:55]
    s_waitcnt vmcnt(11)
    v_mfma_f32_16x16x32_bf16 v[36:39], v[196:199], v[132:135], v[36:39]
    ds_read_b128 v[128:131], v13 offset:2048
    v_mfma_f32_16x16x32_bf16 v[40:43], v[200:203], v[132:135], v[40:43]
    ds_write_b128 v11, v[32:35] offset:4096
    v_mfma_f32_16x16x32_bf16 v[44:47], v[204:207], v[132:135], v[44:47]
    v_mfma_f32_16x16x32_bf16 v[48:51], v[208:211], v[132:135], v[48:51]
    v_mfma_f32_16x16x32_bf16 v[52:55], v[212:215], v[132:135], v[52:55]
    s_waitcnt vmcnt(10) lgkmcnt(7)
    v_mfma_f32_16x16x32_bf16 v[36:39], v[216:219], v[120:123], v[36:39]
    ds_read_b128 v[132:135], v13 offset:3072
    v_mfma_f32_16x16x32_bf16 v[40:43], v[220:223], v[120:123], v[40:43]
    v_mfma_f32_16x16x32_bf16 v[44:47], v[224:227], v[120:123], v[44:47]
    v_mfma_f32_16x16x32_bf16 v[48:51], v[228:231], v[120:123], v[48:51]
    v_mfma_f32_16x16x32_bf16 v[52:55], v[232:235], v[120:123], v[52:55]
    s_waitcnt vmcnt(8) lgkmcnt(5)
    v_mfma_f32_16x16x32_bf16 v[36:39], v[236:239], v[124:127], v[36:39]
    ds_read_b128 v[120:123], v13 offset:4096
    v_mfma_f32_16x16x32_bf16 v[40:43], v[240:243], v[124:127], v[40:43]
    v_mfma_f32_16x16x32_bf16 v[44:47], v[244:247], v[124:127], v[44:47]
    v_mfma_f32_16x16x32_bf16 v[48:51], v[248:251], v[124:127], v[48:51]
    v_mfma_f32_16x16x32_bf16 v[52:55], v[252:255], v[124:127], v[52:55]
    s_waitcnt vmcnt(7) lgkmcnt(3)
    v_mfma_f32_16x16x32_bf16 v[56:59], v[136:139], v[128:131], 0
    ds_read_b128 v[124:127], v13 offset:5120
    v_mfma_f32_16x16x32_bf16 v[60:63], v[140:143], v[128:131], 0
    v_mfma_f32_16x16x32_bf16 v[64:67], v[144:147], v[128:131], 0
    v_mfma_f32_16x16x32_bf16 v[68:71], v[148:151], v[128:131], 0
    v_mfma_f32_16x16x32_bf16 v[72:75], v[152:155], v[128:131], 0
    s_waitcnt vmcnt(5) lgkmcnt(2)
    v_mfma_f32_16x16x32_bf16 v[56:59], v[156:159], v[132:135], v[56:59]
    ds_read_b128 v[128:131], v13 offset:6144
    v_mfma_f32_16x16x32_bf16 v[60:63], v[160:163], v[132:135], v[60:63]
    ds_write_b128 v11, v[36:39] offset:5120
    v_mfma_f32_16x16x32_bf16 v[64:67], v[164:167], v[132:135], v[64:67]
    ds_write_b128 v11, v[40:43] offset:6144
    v_mfma_f32_16x16x32_bf16 v[68:71], v[168:171], v[132:135], v[68:71]
    v_mfma_f32_16x16x32_bf16 v[72:75], v[172:175], v[132:135], v[72:75]
    s_waitcnt vmcnt(4) lgkmcnt(4)
    v_mfma_f32_16x16x32_bf16 v[56:59], v[176:179], v[120:123], v[56:59]
    ds_read_b128 v[132:135], v13 offset:7168
    v_mfma_f32_16x16x32_bf16 v[60:63], v[180:183], v[120:123], v[60:63]
    ds_write_b128 v11, v[44:47] offset:7168
    v_mfma_f32_16x16x32_bf16 v[64:67], v[184:187], v[120:123], v[64:67]
    ds_write_b128 v11, v[48:51] offset:8192
    v_mfma_f32_16x16x32_bf16 v[68:71], v[188:191], v[120:123], v[68:71]
    v_mfma_f32_16x16x32_bf16 v[72:75], v[192:195], v[120:123], v[72:75]
    s_waitcnt vmcnt(2) lgkmcnt(6)
    v_mfma_f32_16x16x32_bf16 v[56:59], v[196:199], v[124:127], v[56:59]
    ds_read_b128 v[120:123], v13 offset:8192
    v_mfma_f32_16x16x32_bf16 v[60:63], v[200:203], v[124:127], v[60:63]
    ds_write_b128 v11, v[52:55] offset:9216
    v_mfma_f32_16x16x32_bf16 v[64:67], v[204:207], v[124:127], v[64:67]
    v_mfma_f32_16x16x32_bf16 v[68:71], v[208:211], v[124:127], v[68:71]
    v_mfma_f32_16x16x32_bf16 v[72:75], v[212:215], v[124:127], v[72:75]
    s_waitcnt lgkmcnt(7)
    v_mfma_f32_16x16x32_bf16 v[56:59], v[216:219], v[128:131], v[56:59]
    v_mfma_f32_16x16x32_bf16 v[60:63], v[220:223], v[128:131], v[60:63]
    v_mfma_f32_16x16x32_bf16 v[64:67], v[224:227], v[128:131], v[64:67]
    v_mfma_f32_16x16x32_bf16 v[68:71], v[228:231], v[128:131], v[68:71]
    v_mfma_f32_16x16x32_bf16 v[72:75], v[232:235], v[128:131], v[72:75]
    s_waitcnt lgkmcnt(4)
    v_mfma_f32_16x16x32_bf16 v[56:59], v[236:239], v[132:135], v[56:59]
    v_mfma_f32_16x16x32_bf16 v[60:63], v[240:243], v[132:135], v[60:63]
    v_mfma_f32_16x16x32_bf16 v[64:67], v[244:247], v[132:135], v[64:67]
    v_mfma_f32_16x16x32_bf16 v[68:71], v[248:251], v[132:135], v[68:71]
    v_mfma_f32_16x16x32_bf16 v[72:75], v[252:255], v[132:135], v[72:75]
    s_waitcnt lgkmcnt(1)
    v_mfma_f32_16x16x32_bf16 v[76:79], v[136:139], v[120:123], 0
    v_mfma_f32_16x16x32_bf16 v[80:83], v[140:143], v[120:123], 0
    v_mfma_f32_16x16x32_bf16 v[84:87], v[144:147], v[120:123], 0
    v_mfma_f32_16x16x32_bf16 v[88:91], v[148:151], v[120:123], 0
    v_mfma_f32_16x16x32_bf16 v[92:95], v[152:155], v[120:123], 0
    v_mfma_f32_16x16x32_bf16 v[76:79], v[156:159], v[96:99], v[76:79]
    ds_write_b128 v13, v[56:59] offset:0
    v_mfma_f32_16x16x32_bf16 v[80:83], v[160:163], v[96:99], v[80:83]
    ds_write_b128 v13, v[60:63] offset:1024
    v_mfma_f32_16x16x32_bf16 v[84:87], v[164:167], v[96:99], v[84:87]
    v_mfma_f32_16x16x32_bf16 v[88:91], v[168:171], v[96:99], v[88:91]
    v_mfma_f32_16x16x32_bf16 v[92:95], v[172:175], v[96:99], v[92:95]
    v_mfma_f32_16x16x32_bf16 v[76:79], v[176:179], v[100:103], v[76:79]
    ds_write_b128 v13, v[64:67] offset:2048
    v_mfma_f32_16x16x32_bf16 v[80:83], v[180:183], v[100:103], v[80:83]
    ds_write_b128 v13, v[68:71] offset:3072
    v_mfma_f32_16x16x32_bf16 v[84:87], v[184:187], v[100:103], v[84:87]
    v_mfma_f32_16x16x32_bf16 v[88:91], v[188:191], v[100:103], v[88:91]
    v_mfma_f32_16x16x32_bf16 v[92:95], v[192:195], v[100:103], v[92:95]
    v_mfma_f32_16x16x32_bf16 v[76:79], v[196:199], v[104:107], v[76:79]
    ds_write_b128 v13, v[72:75] offset:4096
    v_mfma_f32_16x16x32_bf16 v[80:83], v[200:203], v[104:107], v[80:83]
    v_mfma_f32_16x16x32_bf16 v[84:87], v[204:207], v[104:107], v[84:87]
    v_mfma_f32_16x16x32_bf16 v[88:91], v[208:211], v[104:107], v[88:91]
    v_mfma_f32_16x16x32_bf16 v[92:95], v[212:215], v[104:107], v[92:95]
    s_waitcnt vmcnt(1)
    v_mfma_f32_16x16x32_bf16 v[76:79], v[216:219], v[108:111], v[76:79]
    v_mfma_f32_16x16x32_bf16 v[80:83], v[220:223], v[108:111], v[80:83]
    v_mfma_f32_16x16x32_bf16 v[84:87], v[224:227], v[108:111], v[84:87]
    v_mfma_f32_16x16x32_bf16 v[88:91], v[228:231], v[108:111], v[88:91]
    v_mfma_f32_16x16x32_bf16 v[92:95], v[232:235], v[108:111], v[92:95]
    s_waitcnt vmcnt(0)
    v_mfma_f32_16x16x32_bf16 v[76:79], v[236:239], v[112:115], v[76:79]
    v_mfma_f32_16x16x32_bf16 v[80:83], v[240:243], v[112:115], v[80:83]
    v_mfma_f32_16x16x32_bf16 v[84:87], v[244:247], v[112:115], v[84:87]
    v_mfma_f32_16x16x32_bf16 v[88:91], v[248:251], v[112:115], v[88:91]
    v_mfma_f32_16x16x32_bf16 v[92:95], v[252:255], v[112:115], v[92:95]
    s_setprio 3
    s_nop 2
    ds_write_b128 v13, v[76:79] offset:5120
    ds_write_b128 v13, v[80:83] offset:6144
    ds_write_b128 v13, v[84:87] offset:7168
    ds_write_b128 v13, v[88:91] offset:8192
    ds_write_b128 v13, v[92:95] offset:9216
    s_branch Ljoin_15
LS_12:
    s_add_u32 s62, s41, 3
    v_mov_b32 v0, s62
    v_writelane_b32 v0, s27, 1
    v_lshlrev_b32 v12, 2, v1
    s_mov_b32 exec_hi, 0
    s_add_u32 s62, s45, 0x80000
    buffer_store_dword v0, v12, s[28:31], s62 offen
    s_cmp_eq_u32 s26, 0
    s_cbranch_scc1 Lng_56
    buffer_store_dword v0, v12, s[28:31], s45 offen sc1
Lng_56:
    s_mov_b32 exec_hi, -1
    s_setprio 3
    s_waitcnt vmcnt(1)
    v_mov_b32 v7, 9728
    v_mov_b32 v0, 1
    s_mov_b64 exec, 1
    ds_add_u32 v7, v0
    s_mov_b64 exec, -1
    s_lshl_b32 s67, s4, 13
    s_cmp_eq_u32 s26, 0
    s_cselect_b32 s6, 0x80000, 0
    s_add_u32 s67, s67, s6
    s_add_u32 s60, s67, 0x760380
    s_add_u32 s59, s41, 3
    s_mov_b32 s61, 0
Lsp_57:
    v_and_b32 v7, 7, v1
    v_lshlrev_b32 v7, 10, v7
    buffer_load_dword v7, v7, s[28:31], s60 offen sc1
    s_waitcnt vmcnt(0)
    v_subrev_u32 v7, s59, v7
    v_cmp_le_u32 vcc, 16, v7
    s_cbranch_vccz Lsd_58
    s_sleep 2
    s_add_u32 s61, s61, 1
    s_cmp_lt_u32 s61, 200000
    s_cbranch_scc1 Lsp_57
Lsd_58:
    v_lshlrev_b32 v7, 3, v1
    buffer_load_dwordx2 v[16:17], v7, s[28:31], s65 offen offset:0 sc1
    buffer_load_dwordx2 v[18:19], v7, s[28:31], s65 offen offset:512 sc1
    buffer_load_dwordx2 v[20:21], v7, s[28:31], s65 offen offset:1024 sc1
    buffer_load_dwordx2 v[22:23], v7, s[28:31], s65 offen offset:1536 sc1
    buffer_load_dwordx2 v[24:25], v7, s[28:31], s65 offen offset:2048 sc1
    buffer_load_dwordx2 v[26:27], v7, s[28:31], s65 offen offset:2560 sc1
    buffer_load_dwordx2 v[28:29], v7, s[28:31], s65 offen offset:3072 sc1
    buffer_load_dwordx2 v[30:31], v7, s[28:31], s65 offen offset:3584 sc1
    v_lshlrev_b32 v7, 2, v1
    s_mov_b32 s7, 0x3acccccd
    s_waitcnt vmcnt(0)
    v_add_f32 v16, v16, v18
    v_add_f32 v17, v17, v19
    v_add_f32 v16, v16, v20
    v_add_f32 v17, v17, v21
    v_add_f32 v16, v16, v22
    v_add_f32 v17, v17, v23
    v_add_f32 v16, v16, v24
    v_add_f32 v17, v17, v25
    v_add_f32 v16, v16, v26
    v_add_f32 v17, v17, v27
    v_add_f32 v16, v16, v28
    v_add_f32 v17, v17, v29
    v_add_f32 v16, v16, v30
    v_add_f32 v17, v17, v31
    v_mul_f32 v16, s7, v16
    v_mul_f32 v17, s7, v17
    v_fma_f32 v17, -v16, v16, v17
    v_max_f32 v17, 0, v17
    v_add_f32 v17, 0x3727c5ac, v17
    v_rsq_f32 v17, v17
    ds_write_b32 v7, v16 offset:9216
    ds_write_b32 v7, v17 offset:9472
    s_mov_b32 s61, 0
Lcw_59:
    v_mov_b32 v7, 9728
    ds_read_b32 v7, v7
    s_waitcnt lgkmcnt(0)
    v_cmp_gt_u32 vcc, 4, v7
    s_cbranch_vccz Lcd_60
    s_sleep 1
    s_add_u32 s61, s61, 1
    s_cmp_lt_u32 s61, 200000
    s_cbranch_scc1 Lcw_59
Lcd_60:
    s_setprio 0
    s_cmp_ge_u32 s5, 4
    s_cselect_b64 s[70:71], -1, 0
    v_and_b32 v11, 7, v8
    v_sub_u32 v12, 8, v11
    v_cndmask_b32 v12, v11, v12, s[70:71]
    v_lshrrev_b32 v13, 3, v8
    v_add_u32 v0, 2, v13
    v_cmp_eq_u32 vcc, 0, v11
    s_nop 1
    v_cndmask_b32 v12, v12, 0, vcc
    v_cndmask_b32 v13, v13, v0, vcc
    v_and_b32 v0, 1, v12
    v_lshlrev_b32 v0, 4, v0
    v_mov_b32 v36, 0x3f80
    v_lshlrev_b32 v0, v0, v36
    v_cmp_eq_u32 vcc, v13, v9
    s_nop 1
    v_cndmask_b32 v0, 0, v0, vcc
    v_lshrrev_b32 v12, 1, v12
    v_cmp_eq_u32 vcc, 0, v12
    s_nop 1
    v_cndmask_b32 v32, 0, v0, vcc
    v_cmp_eq_u32 vcc, 1, v12
    s_nop 1
    v_cndmask_b32 v33, 0, v0, vcc
    v_cmp_eq_u32 vcc, 2, v12
    s_nop 1
    v_cndmask_b32 v34, 0, v0, vcc
    v_cmp_eq_u32 vcc, 3, v12
    s_nop 1
    v_cndmask_b32 v35, 0, v0, vcc
    ds_write_b128 v2, v[32:35] offset:29696
    v_lshlrev_b32 v37, 2, v1
    s_mul_i32 s6, s5, 10
    v_cmp_le_u32 s[72:73], 2, v9
    v_and_b32 v11, 1, v9
    v_add3_u32 v11, v11, s6, 0
    v_sub_u32 v12, 119, v11
    v_cndmask_b32 v12, v11, v12, s[70:71]
    v_sub_u32 v13, 120, v11
    v_cndmask_b32 v13, v11, v13, s[70:71]
    v_cmp_eq_u32 vcc, 0, v13
    s_nop 1
    v_cndmask_b32 v13, v13, 40, vcc
    v_cmp_eq_u32 vcc, 80, v13
    s_nop 1
    v_cndmask_b32 v13, v13, 0, vcc
    v_cndmask_b32 v12, v12, v13, s[72:73]
    v_mul_u32_u24 v13, 13108, v12
    v_lshrrev_b32 v13, 16, v13
    v_sub_u32 v11, v12, v13
    v_mul_u32_u24 v0, 5, v13
    v_sub_u32 v12, v12, v0
    v_and_b32 v0, 7, v13
    v_lshrrev_b32 v13, 3, v13
    v_lshl_add_u32 v13, v0, 1, v13
    v_add_u32 v13, 64, v13
    v_cmp_eq_u32 vcc, 4, v12
    s_nop 1
    v_cndmask_b32 v11, v11, v13, vcc
    v_lshlrev_b32 v11, 10, v11
    v_lshl_add_u32 v11, v8, 4, v11
    v_add_u32 v11, 81920, v11
    ds_write_b32 v37, v11 offset:39936
    v_and_b32 v11, 1, v9
    v_add3_u32 v11, v11, s6, 2
    v_sub_u32 v12, 119, v11
    v_cndmask_b32 v12, v11, v12, s[70:71]
    v_sub_u32 v13, 120, v11
    v_cndmask_b32 v13, v11, v13, s[70:71]
    v_cndmask_b32 v12, v12, v13, s[72:73]
    v_mul_u32_u24 v13, 13108, v12
    v_lshrrev_b32 v13, 16, v13
    v_sub_u32 v11, v12, v13
    v_mul_u32_u24 v0, 5, v13
    v_sub_u32 v12, v12, v0
    v_and_b32 v0, 7, v13
    v_lshrrev_b32 v13, 3, v13
    v_lshl_add_u32 v13, v0, 1, v13
    v_add_u32 v13, 64, v13
    v_cmp_eq_u32 vcc, 4, v12
    s_nop 1
    v_cndmask_b32 v11, v11, v13, vcc
    v_lshlrev_b32 v11, 10, v11
    v_lshl_add_u32 v11, v8, 4, v11
    v_add_u32 v11, 81920, v11
    ds_write_b32 v37, v11 offset:40192
    v_and_b32 v11, 1, v9
    v_add3_u32 v11, v11, s6, 4
    v_sub_u32 v12, 119, v11
    v_cndmask_b32 v12, v11, v12, s[70:71]
    v_sub_u32 v13, 120, v11
    v_cndmask_b32 v13, v11, v13, s[70:71]
    v_cndmask_b32 v12, v12, v13, s[72:73]
    v_mul_u32_u24 v13, 13108, v12
    v_lshrrev_b32 v13, 16, v13
    v_sub_u32 v11, v12, v13
    v_mul_u32_u24 v0, 5, v13
    v_sub_u32 v12, v12, v0
    v_and_b32 v0, 7, v13
    v_lshrrev_b32 v13, 3, v13
    v_lshl_add_u32 v13, v0, 1, v13
    v_add_u32 v13, 64, v13
    v_cmp_eq_u32 vcc, 4, v12
    s_nop 1
    v_cndmask_b32 v11, v11, v13, vcc
    v_lshlrev_b32 v11, 10, v11
    v_lshl_add_u32 v11, v8, 4, v11
    v_add_u32 v11, 81920, v11
    ds_write_b32 v37, v11 offset:40448
    v_and_b32 v11, 1, v9
    v_add3_u32 v11, v11, s6, 6
    v_sub_u32 v12, 119, v11
    v_cndmask_b32 v12, v11, v12, s[70:71]
    v_sub_u32 v13, 120, v11
    v_cndmask_b32 v13, v11, v13, s[70:71]
    v_cndmask_b32 v12, v12, v13, s[72:73]
    v_mul_u32_u24 v13, 13108, v12
    v_lshrrev_b32 v13, 16, v13
    v_sub_u32 v11, v12, v13
    v_mul_u32_u24 v0, 5, v13
    v_sub_u32 v12, v12, v0
    v_and_b32 v0, 7, v13
    v_lshrrev_b32 v13, 3, v13
    v_lshl_add_u32 v13, v0, 1, v13
    v_add_u32 v13, 64, v13
    v_cmp_eq_u32 vcc, 4, v12
    s_nop 1
    v_cndmask_b32 v11, v11, v13, vcc
    v_lshlrev_b32 v11, 10, v11
    v_lshl_add_u32 v11, v8, 4, v11
    v_add_u32 v11, 81920, v11
    ds_write_b32 v37, v11 offset:40704
    v_and_b32 v11, 1, v9
    v_add3_u32 v11, v11, s6, 8
    v_sub_u32 v12, 119, v11
    v_cndmask_b32 v12, v11, v12, s[70:71]
    v_sub_u32 v13, 120, v11
    v_cndmask_b32 v13, v11, v13, s[70:71]
    v_cndmask_b32 v12, v12, v13, s[72:73]
    v_mul_u32_u24 v13, 13108, v12
    v_lshrrev_b32 v13, 16, v13
    v_sub_u32 v11, v12, v13
    v_mul_u32_u24 v0, 5, v13
    v_sub_u32 v12, v12, v0
    v_and_b32 v0, 7, v13
    v_lshrrev_b32 v13, 3, v13
    v_lshl_add_u32 v13, v0, 1, v13
    v_add_u32 v13, 64, v13
    v_cmp_eq_u32 vcc, 4, v12
    s_nop 1
    v_cndmask_b32 v11, v11, v13, vcc
    v_lshlrev_b32 v11, 10, v11
    v_lshl_add_u32 v11, v8, 4, v11
    v_add_u32 v11, 81920, v11
    ds_write_b32 v37, v11 offset:50176
    v_lshlrev_b32 v7, 2, v1
    ds_read_b128 v[96:99], v2 offset:29696
    ds_read_b32 v0, v7 offset:39936
    ds_read_b32 v11, v7 offset:40192
    ds_read_b32 v12, v7 offset:40448
    ds_read_b32 v13, v7 offset:40704
    ds_read_b32 v7, v7 offset:50176
    s_waitcnt lgkmcnt(0)
    ds_read_b128 v[100:103], v0 offset:0
    ds_read_b128 v[104:107], v0 offset:256
    ds_read_b128 v[108:111], v0 offset:512
    ds_read_b128 v[112:115], v0 offset:768
    ds_read_b128 v[116:119], v11 offset:0
    ds_read_b128 v[120:123], v11 offset:256
    ds_read_b128 v[124:127], v11 offset:512
    ds_read_b128 v[128:131], v11 offset:768
    s_waitcnt lgkmcnt(4)
    v_mfma_f32_16x16x32_bf16 v[16:19], v[96:99], v[100:103], 0
    v_mfma_f32_16x16x32_bf16 v[36:39], v[96:99], v[104:107], 0
    v_mfma_f32_16x16x32_bf16 v[56:59], v[96:99], v[108:111], 0
    v_mfma_f32_16x16x32_bf16 v[76:79], v[96:99], v[112:115], 0
    ds_read_b128 v[100:103], v12 offset:0
    ds_read_b128 v[104:107], v12 offset:256
    ds_read_b128 v[108:111], v12 offset:512
    ds_read_b128 v[112:115], v12 offset:768
    s_waitcnt lgkmcnt(4)
    v_mfma_f32_16x16x32_bf16 v[20:23], v[96:99], v[116:119], 0
    v_mfma_f32_16x16x32_bf16 v[40:43], v[96:99], v[120:123], 0
    v_mfma_f32_16x16x32_bf16 v[60:63], v[96:99], v[124:127], 0
    v_mfma_f32_16x16x32_bf16 v[80:83], v[96:99], v[128:131], 0
    ds_read_b128 v[116:119], v13 offset:0
    ds_read_b128 v[120:123], v13 offset:256
    ds_read_b128 v[124:127], v13 offset:512
    ds_read_b128 v[128:131], v13 offset:768
    s_waitcnt lgkmcnt(4)
    v_mfma_f32_16x16x32_bf16 v[24:27], v[96:99], v[100:103], 0
    v_mfma_f32_16x16x32_bf16 v[44:47], v[96:99], v[104:107], 0
    v_mfma_f32_16x16x32_bf16 v[64:67], v[96:99], v[108:111], 0
    v_mfma_f32_16x16x32_bf16 v[84:87], v[96:99], v[112:115], 0
    ds_read_b128 v[100:103], v7 offset:0
    ds_read_b128 v[104:107], v7 offset:256
    ds_read_b128 v[108:111], v7 offset:512
    ds_read_b128 v[112:115], v7 offset:768
    s_waitcnt lgkmcnt(4)
    v_mfma_f32_16x16x32_bf16 v[28:31], v[96:99], v[116:119], 0
    v_mfma_f32_16x16x32_bf16 v[48:51], v[96:99], v[120:123], 0
    v_mfma_f32_16x16x32_bf16 v[68:71], v[96:99], v[124:127], 0
    v_mfma_f32_16x16x32_bf16 v[88:91], v[96:99], v[128:131], 0
    s_waitcnt lgkmcnt(0)
    v_mfma_f32_16x16x32_bf16 v[32:35], v[96:99], v[100:103], 0
    v_mfma_f32_16x16x32_bf16 v[52:55], v[96:99], v[104:107], 0
    v_mfma_f32_16x16x32_bf16 v[72:75], v[96:99], v[108:111], 0
    v_mfma_f32_16x16x32_bf16 v[92:95], v[96:99], v[112:115], 0
    s_setprio 0
    v_mov_b32 v7, 9732
    v_mov_b32 v0, 1
    s_mov_b64 exec, 1
    ds_add_u32 v7, v0
    s_mov_b64 exec, -1
    buffer_load_dwordx4 v[136:139], v2, s[28:31], s16 offen offset:0 sc1
    buffer_load_dwordx4 v[140:143], v2, s[28:31], s16 offen offset:1024 sc1
    buffer_load_dwordx4 v[144:147], v2, s[28:31], s16 offen offset:2048 sc1
    buffer_load_dwordx4 v[148:151], v2, s[28:31], s16 offen offset:3072 sc1
    s_add_u32 s64, s16, 4096
    buffer_load_dwordx4 v[152:155], v2, s[28:31], s64 offen sc1
    buffer_load_dwordx4 v[156:159], v2, s[28:31], s17 offen offset:0 sc1
    buffer_load_dwordx4 v[160:163], v2, s[28:31], s17 offen offset:1024 sc1
    buffer_load_dwordx4 v[164:167], v2, s[28:31], s17 offen offset:2048 sc1
    buffer_load_dwordx4 v[168:171], v2, s[28:31], s17 offen offset:3072 sc1
    s_add_u32 s64, s17, 4096
    buffer_load_dwordx4 v[172:175], v2, s[28:31], s64 offen sc1
    buffer_load_dwordx4 v[176:179], v2, s[28:31], s18 offen offset:0 sc1
    buffer_load_dwordx4 v[180:183], v2, s[28:31], s18 offen offset:1024 sc1
    buffer_load_dwordx4 v[184:187], v2, s[28:31], s18 offen offset:2048 sc1
    buffer_load_dwordx4 v[188:191], v2, s[28:31], s18 offen offset:3072 sc1
    s_add_u32 s64, s18, 4096
    buffer_load_dwordx4 v[192:195], v2, s[28:31], s64 offen sc1
    buffer_load_dwordx4 v[196:199], v2, s[28:31], s19 offen offset:0 sc1
    buffer_load_dwordx4 v[200:203], v2, s[28:31], s19 offen offset:1024 sc1
    buffer_load_dwordx4 v[204:207], v2, s[28:31], s19 offen offset:2048 sc1
    buffer_load_dwordx4 v[208:211], v2, s[28:31], s19 offen offset:3072 sc1
    s_add_u32 s64, s19, 4096
    buffer_load_dwordx4 v[212:215], v2, s[28:31], s64 offen sc1
    s_sleep 40
    s_lshl_b32 s7, s3, 11
    s_lshl_b32 s67, s4, 13
    s_cmp_eq_u32 s26, 0
    s_cselect_b32 s6, 0x80000, 0
    s_add_u32 s67, s67, s6
    s_add_u32 s67, s67, s7
    v_and_b32 v11, 3, v1
    v_min_u32 v11, 2, v11
    v_lshlrev_b32 v11, 7, v11
    v_lshl_add_u32 v11, v4, 10, v11
    s_add_u32 s60, s67, 0x75e200
    buffer_load_dword v11, v11, s[28:31], s60 offen sc1
    s_add_u32 s59, s41, 4
    s_waitcnt vmcnt(0)
    s_mov_b32 s61, 0
Lpoll_61:
    v_subrev_u32 v11, s59, v11
    v_cmp_le_u32 vcc, 16, v11
    s_cbranch_vccz Lpd_62
    s_sleep 2
    v_and_b32 v11, 3, v1
    v_min_u32 v11, 2, v11
    v_lshlrev_b32 v11, 7, v11
    v_lshl_add_u32 v11, v4, 10, v11
    s_add_u32 s60, s67, 0x75e200
    buffer_load_dword v11, v11, s[28:31], s60 offen sc1
    s_waitcnt vmcnt(0)
    s_add_u32 s61, s61, 1
    s_cmp_lt_u32 s61, 200000
    s_cbranch_scc1 Lpoll_61
Lpd_62:
    v_add_u32 v12, 0x16e0000, v3
    v_add_u32 v13, s69, v2
    v_add_u32 v11, 81920, v13
    buffer_load_dwordx4 v[96:99], v12, s[28:31], s8 offen offset:0 sc1
    buffer_load_dwordx4 v[100:103], v12, s[28:31], s9 offen offset:0 sc1
    buffer_load_dwordx4 v[104:107], v12, s[28:31], s10 offen offset:0 sc1
    buffer_load_dwordx4 v[108:111], v12, s[28:31], s11 offen offset:0 sc1
    buffer_load_dwordx4 v[112:115], v12, s[28:31], s8 offen offset:256 sc1
    buffer_load_dwordx4 v[116:119], v12, s[28:31], s9 offen offset:256 sc1
    buffer_load_dwordx4 v[120:123], v12, s[28:31], s10 offen offset:256 sc1
    buffer_load_dwordx4 v[124:127], v12, s[28:31], s11 offen offset:256 sc1
    buffer_load_dwordx4 v[128:131], v12, s[28:31], s8 offen offset:512 sc1
    buffer_load_dwordx4 v[132:135], v12, s[28:31], s9 offen offset:512 sc1
    s_mov_b32 s61, 0
Lcw_63:
    v_mov_b32 v7, 9732
    ds_read_b32 v7, v7
    s_waitcnt lgkmcnt(0)
    v_cmp_gt_u32 vcc, 8, v7
    s_cbranch_vccz Lcd_64
    s_sleep 1
    s_add_u32 s61, s61, 1
    s_cmp_lt_u32 s61, 200000
    s_cbranch_scc1 Lcw_63
Lcd_64:
    v_mov_b32 v7, 9732
    v_mov_b32 v0, 1
    s_mov_b64 exec, 1
    ds_add_u32 v7, v0
    s_mov_b64 exec, -1
    s_setprio 0
    s_waitcnt vmcnt(9)
    v_mfma_f32_16x16x32_bf16 v[16:19], v[136:139], v[96:99], v[16:19]
    s_add_u32 m0, s69, 0
    s_add_u32 s64, s10, 512
    buffer_load_dwordx4 v12, s[28:31], s64 offen sc1 lds
    v_mfma_f32_16x16x32_bf16 v[20:23], v[140:143], v[96:99], v[20:23]
    s_add_u32 m0, s69, 1024
    s_add_u32 s64, s11, 512
    buffer_load_dwordx4 v12, s[28:31], s64 offen sc1 lds
    v_mfma_f32_16x16x32_bf16 v[24:27], v[144:147], v[96:99], v[24:27]
    v_mfma_f32_16x16x32_bf16 v[28:31], v[148:151], v[96:99], v[28:31]
    v_mfma_f32_16x16x32_bf16 v[32:35], v[152:155], v[96:99], v[32:35]
    s_waitcnt vmcnt(10)
    v_mfma_f32_16x16x32_bf16 v[16:19], v[156:159], v[100:103], v[16:19]
    s_add_u32 m0, s69, 2048
    s_add_u32 s64, s8, 768
    buffer_load_dwordx4 v12, s[28:31], s64 offen sc1 lds
    v_mfma_f32_16x16x32_bf16 v[20:23], v[160:163], v[100:103], v[20:23]
    s_add_u32 m0, s69, 3072
    s_add_u32 s64, s9, 768
    buffer_load_dwordx4 v12, s[28:31], s64 offen sc1 lds
    v_mfma_f32_16x16x32_bf16 v[24:27], v[164:167], v[100:103], v[24:27]
    v_mfma_f32_16x16x32_bf16 v[28:31], v[168:171], v[100:103], v[28:31]
    v_mfma_f32_16x16x32_bf16 v[32:35], v[172:175], v[100:103], v[32:35]
    s_waitcnt vmcnt(11)
    v_mfma_f32_16x16x32_bf16 v[16:19], v[176:179], v[104:107], v[16:19]
    s_add_u32 m0, s69, 4096
    s_add_u32 s64, s10, 768
    buffer_load_dwordx4 v12, s[28:31], s64 offen sc1 lds
    v_mfma_f32_16x16x32_bf16 v[20:23], v[180:183], v[104:107], v[20:23]
    s_add_u32 m0, s69, 5120
    s_add_u32 s64, s11, 768
    buffer_load_dwordx4 v12, s[28:31], s64 offen sc1 lds
    v_mfma_f32_16x16x32_bf16 v[24:27], v[184:187], v[104:107], v[24:27]
    v_mfma_f32_16x16x32_bf16 v[28:31], v[188:191], v[104:107], v[28:31]
    v_mfma_f32_16x16x32_bf16 v[32:35], v[192:195], v[104:107], v[32:35]
    s_waitcnt vmcnt(12)
    v_mfma_f32_16x16x32_bf16 v[16:19], v[196:199], v[108:111], v[16:19]
    v_mfma_f32_16x16x32_bf16 v[20:23], v[200:203], v[108:111], v[20:23]
    v_mfma_f32_16x16x32_bf16 v[24:27], v[204:207], v[108:111], v[24:27]
    v_mfma_f32_16x16x32_bf16 v[28:31], v[208:211], v[108:111], v[28:31]
    v_mfma_f32_16x16x32_bf16 v[32:35], v[212:215], v[108:111], v[32:35]
    s_waitcnt vmcnt(11)
    v_mfma_f32_16x16x32_bf16 v[36:39], v[136:139], v[112:115], v[36:39]
    v_mfma_f32_16x16x32_bf16 v[40:43], v[140:143], v[112:115], v[40:43]
    v_mfma_f32_16x16x32_bf16 v[44:47], v[144:147], v[112:115], v[44:47]
    v_mfma_f32_16x16x32_bf16 v[48:51], v[148:151], v[112:115], v[48:51]
    v_mfma_f32_16x16x32_bf16 v[52:55], v[152:155], v[112:115], v[52:55]
    s_waitcnt vmcnt(10)
    v_mfma_f32_16x16x32_bf16 v[36:39], v[156:159], v[116:119], v[36:39]
    ds_write_b128 v11, v[16:19] offset:0
    v_mfma_f32_16x16x32_bf16 v[40:43], v[160:163], v[116:119], v[40:43]
    ds_write_b128 v11, v[20:23] offset:1024
    v_mfma_f32_16x16x32_bf16 v[44:47], v[164:167], v[116:119], v[44:47]
    v_mfma_f32_16x16x32_bf16 v[48:51], v[168:171], v[116:119], v[48:51]
    v_mfma_f32_16x16x32_bf16 v[52:55], v[172:175], v[116:119], v[52:55]
    s_waitcnt vmcnt(9)
    v_mfma_f32_16x16x32_bf16 v[36:39], v[176:179], v[120:123], v[36:39]
    ds_write_b128 v11, v[24:27] offset:2048
    v_mfma_f32_16x16x32_bf16 v[40:43], v[180:183], v[120:123], v[40:43]
    ds_write_b128 v11, v[28:31] offset:3072
    v_mfma_f32_16x16x32_bf16 v[44:47], v[184:187], v[120:123], v[44:47]
    v_mfma_f32_16x16x32_bf16 v[48:51], v[188:191], v[120:123], v[48:51]
    v_mfma_f32_16x16x32_bf16 v[52:55], v[192:195], v[120:123], v[52:55]
    s_waitcnt vmcnt(5)
    v_mfma_f32_16x16x32_bf16 v[36:39], v[196:199], v[124:127], v[36:39]
    ds_read_b128 v[120:123], v13 offset:0
    v_mfma_f32_16x16x32_bf16 v[40:43], v[200:203], v[124:127], v[40:43]
    ds_write_b128 v11, v[32:35] offset:4096
    v_mfma_f32_16x16x32_bf16 v[44:47], v[204:207], v[124:127], v[44:47]
    v_mfma_f32_16x16x32_bf16 v[48:51], v[208:211], v[124:127], v[48:51]
    v_mfma_f32_16x16x32_bf16 v[52:55], v[212:215], v[124:127], v[52:55]
    s_waitcnt vmcnt(4)
    v_mfma_f32_16x16x32_bf16 v[56:59], v[136:139], v[128:131], v[56:59]
    ds_read_b128 v[124:127], v13 offset:1024
    v_mfma_f32_16x16x32_bf16 v[60:63], v[140:143], v[128:131], v[60:63]
    v_mfma_f32_16x16x32_bf16 v[64:67], v[144:147], v[128:131], v[64:67]
    v_mfma_f32_16x16x32_bf16 v[68:71], v[148:151], v[128:131], v[68:71]
    v_mfma_f32_16x16x32_bf16 v[72:75], v[152:155], v[128:131], v[72:75]
    s_waitcnt vmcnt(3)
    v_mfma_f32_16x16x32_bf16 v[56:59], v[156:159], v[132:135], v[56:59]
    ds_read_b128 v[128:131], v13 offset:2048
    v_mfma_f32_16x16x32_bf16 v[60:63], v[160:163], v[132:135], v[60:63]
    ds_write_b128 v11, v[36:39] offset:5120
    v_mfma_f32_16x16x32_bf16 v[64:67], v[164:167], v[132:135], v[64:67]
    ds_write_b128 v11, v[40:43] offset:6144
    v_mfma_f32_16x16x32_bf16 v[68:71], v[168:171], v[132:135], v[68:71]
    v_mfma_f32_16x16x32_bf16 v[72:75], v[172:175], v[132:135], v[72:75]
    s_waitcnt vmcnt(2) lgkmcnt(5)
    v_mfma_f32_16x16x32_bf16 v[56:59], v[176:179], v[120:123], v[56:59]
    ds_read_b128 v[132:135], v13 offset:3072
    v_mfma_f32_16x16x32_bf16 v[60:63], v[180:183], v[120:123], v[60:63]
    ds_write_b128 v11, v[44:47] offset:7168
    v_mfma_f32_16x16x32_bf16 v[64:67], v[184:187], v[120:123], v[64:67]
    ds_write_b128 v11, v[48:51] offset:8192
    v_mfma_f32_16x16x32_bf16 v[68:71], v[188:191], v[120:123], v[68:71]
    v_mfma_f32_16x16x32_bf16 v[72:75], v[192:195], v[120:123], v[72:75]
    s_waitcnt vmcnt(1) lgkmcnt(6)
    v_mfma_f32_16x16x32_bf16 v[56:59], v[196:199], v[124:127], v[56:59]
    ds_read_b128 v[120:123], v13 offset:4096
    v_mfma_f32_16x16x32_bf16 v[60:63], v[200:203], v[124:127], v[60:63]
    ds_write_b128 v11, v[52:55] offset:9216
    v_mfma_f32_16x16x32_bf16 v[64:67], v[204:207], v[124:127], v[64:67]
    v_mfma_f32_16x16x32_bf16 v[68:71], v[208:211], v[124:127], v[68:71]
    v_mfma_f32_16x16x32_bf16 v[72:75], v[212:215], v[124:127], v[72:75]
    s_waitcnt vmcnt(0) lgkmcnt(7)
    v_mfma_f32_16x16x32_bf16 v[76:79], v[136:139], v[128:131], v[76:79]
    ds_read_b128 v[124:127], v13 offset:5120
    v_mfma_f32_16x16x32_bf16 v[80:83], v[140:143], v[128:131], v[80:83]
    v_mfma_f32_16x16x32_bf16 v[84:87], v[144:147], v[128:131], v[84:87]
    v_mfma_f32_16x16x32_bf16 v[88:91], v[148:151], v[128:131], v[88:91]
    v_mfma_f32_16x16x32_bf16 v[92:95], v[152:155], v[128:131], v[92:95]
    s_waitcnt lgkmcnt(0)
    v_mfma_f32_16x16x32_bf16 v[76:79], v[156:159], v[132:135], v[76:79]
    ds_write_b128 v13, v[56:59] offset:0
    v_mfma_f32_16x16x32_bf16 v[80:83], v[160:163], v[132:135], v[80:83]
    ds_write_b128 v13, v[60:63] offset:1024
    v_mfma_f32_16x16x32_bf16 v[84:87], v[164:167], v[132:135], v[84:87]
    v_mfma_f32_16x16x32_bf16 v[88:91], v[168:171], v[132:135], v[88:91]
    v_mfma_f32_16x16x32_bf16 v[92:95], v[172:175], v[132:135], v[92:95]
    v_mfma_f32_16x16x32_bf16 v[76:79], v[176:179], v[120:123], v[76:79]
    ds_write_b128 v13, v[64:67] offset:2048
    v_mfma_f32_16x16x32_bf16 v[80:83], v[180:183], v[120:123], v[80:83]
    ds_write_b128 v13, v[68:71] offset:3072
    v_mfma_f32_16x16x32_bf16 v[84:87], v[184:187], v[120:123], v[84:87]
    v_mfma_f32_16x16x32_bf16 v[88:91], v[188:191], v[120:123], v[88:91]
    v_mfma_f32_16x16x32_bf16 v[92:95], v[192:195], v[120:123], v[92:95]
    v_mfma_f32_16x16x32_bf16 v[76:79], v[196:199], v[124:127], v[76:79]
    ds_write_b128 v13, v[72:75] offset:4096
    v_mfma_f32_16x16x32_bf16 v[80:83], v[200:203], v[124:127], v[80:83]
    v_mfma_f32_16x16x32_bf16 v[84:87], v[204:207], v[124:127], v[84:87]
    v_mfma_f32_16x16x32_bf16 v[88:91], v[208:211], v[124:127], v[88:91]
    v_mfma_f32_16x16x32_bf16 v[92:95], v[212:215], v[124:127], v[92:95]
    s_setprio 3
    s_nop 1
    ds_write_b128 v13, v[76:79] offset:5120
    s_nop 0
    ds_write_b128 v13, v[80:83] offset:6144
    ds_write_b128 v13, v[84:87] offset:7168
    ds_write_b128 v13, v[88:91] offset:8192
    ds_write_b128 v13, v[92:95] offset:9216
Ljoin_15:
    s_nop 1
    s_cmp_ge_u32 s3, 4
    s_cbranch_scc1 Lg_65
    s_waitcnt lgkmcnt(0)
    s_mul_i32 s6, s5, 40
    s_min_u32 s7, s3, 4
    s_lshl_b32 s7, s7, 3
    s_add_u32 s6, s6, s7
    v_and_b32 v124, 7, v1
    v_add_u32 v124, s6, v124
    v_mov_b32 v0, 320
    v_cmp_eq_u32 vcc, 0, v124
    s_nop 1
    v_cndmask_b32 v124, v124, v0, vcc
    v_lshlrev_b32 v125, 3, v9
    v_mul_u32_u24 v125, v124, v125
    v_mov_b32 v11, 160
    v_cmp_gt_u32 vcc, 8, v8
    s_nop 1
    v_cndmask_b32 v0, v0, v11, vcc
    v_add_u32 v125, v125, v0
    s_mov_b32 s7, 0x666667
    v_mul_hi_u32 v0, v125, s7
    v_mul_u32_u24 v0, 640, v0
    v_sub_u32 v125, v125, v0
    v_cvt_f32_i32 v125, v125
    v_cvt_f32_u32 v124, v124
    v_mul_f32 v125, 0x3acccccd, v125
    v_mul_f32 v124, 0x3acccccd, v124
    v_fmamk_f32 v116, v124, 0x00000000, v125
    v_fmamk_f32 v117, v124, 0x3f800000, v125
    v_fmamk_f32 v118, v124, 0x40000000, v125
    v_fmamk_f32 v119, v124, 0x40400000, v125
    v_fmamk_f32 v120, v124, 0x40800000, v125
    v_fmamk_f32 v121, v124, 0x40a00000, v125
    v_fmamk_f32 v122, v124, 0x40c00000, v125
    v_fmamk_f32 v123, v124, 0x40e00000, v125
    v_sin_f32 v116, v116
    v_sin_f32 v117, v117
    v_sin_f32 v118, v118
    v_sin_f32 v119, v119
    v_sin_f32 v120, v120
    v_sin_f32 v121, v121
    v_sin_f32 v122, v122
    v_sin_f32 v123, v123
    v_cvt_pk_bf16_f32 v16, v116, v117
    v_cvt_pk_bf16_f32 v17, v118, v119
    v_cvt_pk_bf16_f32 v18, v120, v121
    v_cvt_pk_bf16_f32 v19, v122, v123
    v_fmamk_f32 v116, v124, 0x42000000, v125
    v_fmamk_f32 v117, v124, 0x42040000, v125
    v_fmamk_f32 v118, v124, 0x42080000, v125
    v_fmamk_f32 v119, v124, 0x420c0000, v125
    v_fmamk_f32 v120, v124, 0x42100000, v125
    v_fmamk_f32 v121, v124, 0x42140000, v125
    v_fmamk_f32 v122, v124, 0x42180000, v125
    v_fmamk_f32 v123, v124, 0x421c0000, v125
    v_sin_f32 v116, v116
    v_sin_f32 v117, v117
    v_sin_f32 v118, v118
    v_sin_f32 v119, v119
    v_sin_f32 v120, v120
    v_sin_f32 v121, v121
    v_sin_f32 v122, v122
    v_sin_f32 v123, v123
    v_cvt_pk_bf16_f32 v20, v116, v117
    v_cvt_pk_bf16_f32 v21, v118, v119
    v_cvt_pk_bf16_f32 v22, v120, v121
    v_cvt_pk_bf16_f32 v23, v122, v123
    v_fmamk_f32 v116, v124, 0x42800000, v125
    v_fmamk_f32 v117, v124, 0x42820000, v125
    v_fmamk_f32 v118, v124, 0x42840000, v125
    v_fmamk_f32 v119, v124, 0x42860000, v125
    v_fmamk_f32 v120, v124, 0x42880000, v125
    v_fmamk_f32 v121, v124, 0x428a0000, v125
    v_fmamk_f32 v122, v124, 0x428c0000, v125
    v_fmamk_f32 v123, v124, 0x428e0000, v125
    v_sin_f32 v116, v116
    v_sin_f32 v117, v117
    v_sin_f32 v118, v118
    v_sin_f32 v119, v119
    v_sin_f32 v120, v120
    v_sin_f32 v121, v121
    v_sin_f32 v122, v122
    v_sin_f32 v123, v123
    v_cvt_pk_bf16_f32 v24, v116, v117
    v_cvt_pk_bf16_f32 v25, v118, v119
    v_cvt_pk_bf16_f32 v26, v120, v121
    v_cvt_pk_bf16_f32 v27, v122, v123
    v_fmamk_f32 v116, v124, 0x42c00000, v125
    v_fmamk_f32 v117, v124, 0x42c20000, v125
    v_fmamk_f32 v118, v124, 0x42c40000, v125
    v_fmamk_f32 v119, v124, 0x42c60000, v125
    v_fmamk_f32 v120, v124, 0x42c80000, v125
    v_fmamk_f32 v121, v124, 0x42ca0000, v125
    v_fmamk_f32 v122, v124, 0x42cc0000, v125
    v_fmamk_f32 v123, v124, 0x42ce0000, v125
    v_sin_f32 v116, v116
    v_sin_f32 v117, v117
    v_sin_f32 v118, v118
    v_sin_f32 v119, v119
    v_sin_f32 v120, v120
    v_sin_f32 v121, v121
    v_sin_f32 v122, v122
    v_sin_f32 v123, v123
    v_cvt_pk_bf16_f32 v28, v116, v117
    v_cvt_pk_bf16_f32 v29, v118, v119
    v_cvt_pk_bf16_f32 v30, v120, v121
    v_cvt_pk_bf16_f32 v31, v122, v123
    v_fmamk_f32 v116, v124, 0x43000000, v125
    v_fmamk_f32 v117, v124, 0x43010000, v125
    v_fmamk_f32 v118, v124, 0x43020000, v125
    v_fmamk_f32 v119, v124, 0x43030000, v125
    v_fmamk_f32 v120, v124, 0x43040000, v125
    v_fmamk_f32 v121, v124, 0x43050000, v125
    v_fmamk_f32 v122, v124, 0x43060000, v125
    v_fmamk_f32 v123, v124, 0x43070000, v125
    v_sin_f32 v116, v116
    v_sin_f32 v117, v117
    v_sin_f32 v118, v118
    v_sin_f32 v119, v119
    v_sin_f32 v120, v120
    v_sin_f32 v121, v121
    v_sin_f32 v122, v122
    v_sin_f32 v123, v123
    v_cvt_pk_bf16_f32 v32, v116, v117
    v_cvt_pk_bf16_f32 v33, v118, v119
    v_cvt_pk_bf16_f32 v34, v120, v121
    v_cvt_pk_bf16_f32 v35, v122, v123
    v_mov_b32 v13, 0x80008000
    v_lshrrev_b32 v0, 1, v1
    v_lshrrev_b32 v12, 3, v1
    v_and_b32 v12, v12, v1
    v_xor_b32 v0, v0, v12
    v_and_b32 v0, 1, v0
    v_cmp_eq_u32 vcc, 1, v0
    s_nop 1
    v_cndmask_b32 v12, 0, v13, vcc
    v_and_b32 v0, 1, v1
    v_cmp_eq_u32 vcc, 1, v0
    s_nop 1
    v_cndmask_b32 v124, 0, v13, vcc
    v_xor_b32 v36, v16, v12
    v_xor_b32 v37, v17, v12
    v_xor_b32 v38, v18, v12
    v_xor_b32 v39, v19, v12
    v_xor_b32 v40, v20, v12
    v_xor_b32 v41, v21, v12
    v_xor_b32 v42, v22, v12
    v_xor_b32 v43, v23, v12
    v_xor_b32 v44, v24, v12
    v_xor_b32 v45, v25, v12
    v_xor_b32 v46, v26, v12
    v_xor_b32 v47, v27, v12
    v_xor_b32 v48, v28, v12
    v_xor_b32 v49, v29, v12
    v_xor_b32 v50, v30, v12
    v_xor_b32 v51, v31, v12
    v_xor_b32 v52, v32, v12
    v_xor_b32 v53, v33, v12
    v_xor_b32 v54, v34, v12
    v_xor_b32 v55, v35, v12
    s_mov_b64 exec, vcc
    s_nop 4
    v_xor_b32_dpp v36, v16, v12 row_ror:8 row_mask:0xf bank_mask:0xf
    v_xor_b32_dpp v37, v17, v12 row_ror:8 row_mask:0xf bank_mask:0xf
    v_xor_b32_dpp v38, v18, v12 row_ror:8 row_mask:0xf bank_mask:0xf
    v_xor_b32_dpp v39, v19, v12 row_ror:8 row_mask:0xf bank_mask:0xf
    v_xor_b32_dpp v40, v20, v12 row_ror:8 row_mask:0xf bank_mask:0xf
    v_xor_b32_dpp v41, v21, v12 row_ror:8 row_mask:0xf bank_mask:0xf
    v_xor_b32_dpp v42, v22, v12 row_ror:8 row_mask:0xf bank_mask:0xf
    v_xor_b32_dpp v43, v23, v12 row_ror:8 row_mask:0xf bank_mask:0xf
    v_xor_b32_dpp v44, v24, v12 row_ror:8 row_mask:0xf bank_mask:0xf
    v_xor_b32_dpp v45, v25, v12 row_ror:8 row_mask:0xf bank_mask:0xf
    v_xor_b32_dpp v46, v26, v12 row_ror:8 row_mask:0xf bank_mask:0xf
    v_xor_b32_dpp v47, v27, v12 row_ror:8 row_mask:0xf bank_mask:0xf
    v_xor_b32_dpp v48, v28, v12 row_ror:8 row_mask:0xf bank_mask:0xf
    v_xor_b32_dpp v49, v29, v12 row_ror:8 row_mask:0xf bank_mask:0xf
    v_xor_b32_dpp v50, v30, v12 row_ror:8 row_mask:0xf bank_mask:0xf
    v_xor_b32_dpp v51, v31, v12 row_ror:8 row_mask:0xf bank_mask:0xf
    v_xor_b32_dpp v52, v32, v12 row_ror:8 row_mask:0xf bank_mask:0xf
    v_xor_b32_dpp v53, v33, v12 row_ror:8 row_mask:0xf bank_mask:0xf
    v_xor_b32_dpp v54, v34, v12 row_ror:8 row_mask:0xf bank_mask:0xf
    v_xor_b32_dpp v55, v35, v12 row_ror:8 row_mask:0xf bank_mask:0xf
    s_mov_b64 exec, -1
Lg_65:
    s_add_u32 s6, s3, 0
    s_cmp_ge_u32 s6, 5
    s_cselect_b32 s7, 5, 0
    s_cselect_b32 s62, 0, 81920
    s_cselect_b32 s65, 40960, 0
    s_sub_u32 s6, s6, s7
    s_lshl_b32 s7, s6, 10
    s_add_u32 s62, s62, s7
    v_lshrrev_b32 v11, 4, v10
    v_mul_u32_u24 v11, 5120, v11
    v_lshl_add_u32 v11, v4, 9, v11
    v_lshl_add_u32 v11, v8, 4, v11
    v_add_u32 v11, s62, v11
    v_add_u32 v13, 51200, v11
    s_lshl_b32 s6, s6, 1
    s_mul_i32 s7, s5, 10
    s_add_u32 s6, s6, s7
    v_add_u32 v7, s6, v4
    v_lshlrev_b32 v7, 9, v7
    v_lshl_add_u32 v7, v10, 4, v7
    s_add_u32 s65, s65, s44
    s_add_u32 s65, s65, 0x1460000
    s_waitcnt lgkmcnt(0)
    s_barrier
    ds_read_b128 v[56:59], v11 offset:0
    ds_read_b128 v[60:63], v11 offset:256
    ds_read_b128 v[64:67], v11 offset:10240
    ds_read_b128 v[68:71], v11 offset:10496
    ds_read_b128 v[72:75], v11 offset:20480
    ds_read_b128 v[76:79], v11 offset:20736
    ds_read_b128 v[80:83], v11 offset:30720
    ds_read_b128 v[84:87], v11 offset:30976
    ds_read_b128 v[88:91], v11 offset:40960
    ds_read_b128 v[92:95], v11 offset:41216
    ds_read_b128 v[96:99], v13 offset:0
    ds_read_b128 v[100:103], v13 offset:256
    ds_read_b128 v[104:107], v13 offset:10240
    ds_read_b128 v[108:111], v13 offset:10496
    s_waitcnt lgkmcnt(10)
    v_pk_add_f32 v[56:57], v[56:57], v[64:65]
    v_pk_add_f32 v[58:59], v[58:59], v[66:67]
    v_pk_add_f32 v[60:61], v[60:61], v[68:69]
    v_pk_add_f32 v[62:63], v[62:63], v[70:71]
    ds_read_b128 v[64:67], v13 offset:20480
    ds_read_b128 v[68:71], v13 offset:20736
    s_waitcnt lgkmcnt(10)
    v_pk_add_f32 v[56:57], v[56:57], v[72:73]
    v_pk_add_f32 v[58:59], v[58:59], v[74:75]
    v_pk_add_f32 v[60:61], v[60:61], v[76:77]
    v_pk_add_f32 v[62:63], v[62:63], v[78:79]
    s_waitcnt lgkmcnt(8)
    v_pk_add_f32 v[56:57], v[56:57], v[80:81]
    v_pk_add_f32 v[58:59], v[58:59], v[82:83]
    v_pk_add_f32 v[60:61], v[60:61], v[84:85]
    v_pk_add_f32 v[62:63], v[62:63], v[86:87]
    s_waitcnt lgkmcnt(6)
    v_pk_add_f32 v[56:57], v[56:57], v[88:89]
    v_pk_add_f32 v[58:59], v[58:59], v[90:91]
    v_pk_add_f32 v[60:61], v[60:61], v[92:93]
    v_pk_add_f32 v[62:63], v[62:63], v[94:95]
    s_waitcnt lgkmcnt(4)
    v_pk_add_f32 v[56:57], v[56:57], v[96:97]
    v_pk_add_f32 v[58:59], v[58:59], v[98:99]
    v_pk_add_f32 v[60:61], v[60:61], v[100:101]
    v_pk_add_f32 v[62:63], v[62:63], v[102:103]
    s_waitcnt lgkmcnt(2)
    v_pk_add_f32 v[56:57], v[56:57], v[104:105]
    v_pk_add_f32 v[58:59], v[58:59], v[106:107]
    v_pk_add_f32 v[60:61], v[60:61], v[108:109]
    v_pk_add_f32 v[62:63], v[62:63], v[110:111]
    s_waitcnt lgkmcnt(0)
    v_pk_add_f32 v[56:57], v[56:57], v[64:65]
    v_pk_add_f32 v[58:59], v[58:59], v[66:67]
    v_pk_add_f32 v[60:61], v[60:61], v[68:69]
    v_pk_add_f32 v[62:63], v[62:63], v[70:71]
    v_cvt_pk_bf16_f32 v56, v56, v57
    v_cvt_pk_bf16_f32 v57, v58, v59
    v_cvt_pk_bf16_f32 v58, v60, v61
    v_cvt_pk_bf16_f32 v59, v62, v63
    buffer_store_dwordx4 v[56:59], v7, s[28:31], s65 offen sc1
    s_cmp_ge_u32 s3, 2
    s_cbranch_scc1 Lnr_66
    s_add_u32 s6, s3, 8
    s_cmp_ge_u32 s6, 5
    s_cselect_b32 s7, 5, 0
    s_cselect_b32 s62, 0, 81920
    s_cselect_b32 s65, 40960, 0
    s_sub_u32 s6, s6, s7
    s_lshl_b32 s7, s6, 10
    s_add_u32 s62, s62, s7
    v_lshrrev_b32 v11, 4, v10
    v_mul_u32_u24 v11, 5120, v11
    v_lshl_add_u32 v11, v4, 9, v11
    v_lshl_add_u32 v11, v8, 4, v11
    v_add_u32 v11, s62, v11
    v_add_u32 v13, 51200, v11
    s_lshl_b32 s6, s6, 1
    s_mul_i32 s7, s5, 10
    s_add_u32 s6, s6, s7
    v_add_u32 v7, s6, v4
    v_lshlrev_b32 v7, 9, v7
    v_lshl_add_u32 v7, v10, 4, v7
    s_add_u32 s65, s65, s44
    s_add_u32 s65, s65, 0x1460000
    ds_read_b128 v[56:59], v11 offset:0
    ds_read_b128 v[60:63], v11 offset:256
    ds_read_b128 v[64:67], v11 offset:10240
    ds_read_b128 v[68:71], v11 offset:10496
    ds_read_b128 v[72:75], v11 offset:20480
    ds_read_b128 v[76:79], v11 offset:20736
    ds_read_b128 v[80:83], v11 offset:30720
    ds_read_b128 v[84:87], v11 offset:30976
    ds_read_b128 v[88:91], v11 offset:40960
    ds_read_b128 v[92:95], v11 offset:41216
    ds_read_b128 v[96:99], v13 offset:0
    ds_read_b128 v[100:103], v13 offset:256
    ds_read_b128 v[104:107], v13 offset:10240
    ds_read_b128 v[108:111], v13 offset:10496
    s_waitcnt lgkmcnt(10)
    v_pk_add_f32 v[56:57], v[56:57], v[64:65]
    v_pk_add_f32 v[58:59], v[58:59], v[66:67]
    v_pk_add_f32 v[60:61], v[60:61], v[68:69]
    v_pk_add_f32 v[62:63], v[62:63], v[70:71]
    ds_read_b128 v[64:67], v13 offset:20480
    ds_read_b128 v[68:71], v13 offset:20736
    s_waitcnt lgkmcnt(10)
    v_pk_add_f32 v[56:57], v[56:57], v[72:73]
    v_pk_add_f32 v[58:59], v[58:59], v[74:75]
    v_pk_add_f32 v[60:61], v[60:61], v[76:77]
    v_pk_add_f32 v[62:63], v[62:63], v[78:79]
    s_waitcnt lgkmcnt(8)
    v_pk_add_f32 v[56:57], v[56:57], v[80:81]
    v_pk_add_f32 v[58:59], v[58:59], v[82:83]
    v_pk_add_f32 v[60:61], v[60:61], v[84:85]
    v_pk_add_f32 v[62:63], v[62:63], v[86:87]
    s_waitcnt lgkmcnt(6)
    v_pk_add_f32 v[56:57], v[56:57], v[88:89]
    v_pk_add_f32 v[58:59], v[58:59], v[90:91]
    v_pk_add_f32 v[60:61], v[60:61], v[92:93]
    v_pk_add_f32 v[62:63], v[62:63], v[94:95]
    s_waitcnt lgkmcnt(4)
    v_pk_add_f32 v[56:57], v[56:57], v[96:97]
    v_pk_add_f32 v[58:59], v[58:59], v[98:99]
    v_pk_add_f32 v[60:61], v[60:61], v[100:101]
    v_pk_add_f32 v[62:63], v[62:63], v[102:103]
    s_waitcnt lgkmcnt(2)
    v_pk_add_f32 v[56:57], v[56:57], v[104:105]
    v_pk_add_f32 v[58:59], v[58:59], v[106:107]
    v_pk_add_f32 v[60:61], v[60:61], v[108:109]
    v_pk_add_f32 v[62:63], v[62:63], v[110:111]
    s_waitcnt lgkmcnt(0)
    v_pk_add_f32 v[56:57], v[56:57], v[64:65]
    v_pk_add_f32 v[58:59], v[58:59], v[66:67]
    v_pk_add_f32 v[60:61], v[60:61], v[68:69]
    v_pk_add_f32 v[62:63], v[62:63], v[70:71]
    v_cvt_pk_bf16_f32 v56, v56, v57
    v_cvt_pk_bf16_f32 v57, v58, v59
    v_cvt_pk_bf16_f32 v58, v60, v61
    v_cvt_pk_bf16_f32 v59, v62, v63
    buffer_store_dwordx4 v[56:59], v7, s[28:31], s65 offen sc1
Lnr_66:
    v_lshlrev_b32 v5, 4, v8
    v_lshl_add_u32 v5, v9, 9, v5
    v_add_u32 v5, 81920, v5
    v_add_u32 v6, 40960, v5
    s_cmp_lt_u32 s3, 4
    s_cbranch_scc1 Lg_67
    s_mul_i32 s6, s5, 40
    s_min_u32 s7, s3, 4
    s_lshl_b32 s7, s7, 3
    s_add_u32 s6, s6, s7
    v_and_b32 v124, 7, v1
    v_add_u32 v124, s6, v124
    v_mov_b32 v0, 320
    v_cmp_eq_u32 vcc, 0, v124
    s_nop 1
    v_cndmask_b32 v124, v124, v0, vcc
    v_lshlrev_b32 v125, 3, v9
    v_mul_u32_u24 v125, v124, v125
    v_mov_b32 v11, 160
    v_cmp_gt_u32 vcc, 8, v8
    s_nop 1
    v_cndmask_b32 v0, v0, v11, vcc
    v_add_u32 v125, v125, v0
    s_mov_b32 s7, 0x666667
    v_mul_hi_u32 v0, v125, s7
    v_mul_u32_u24 v0, 640, v0
    v_sub_u32 v125, v125, v0
    v_cvt_f32_i32 v125, v125
    v_cvt_f32_u32 v124, v124
    v_mul_f32 v125, 0x3acccccd, v125
    v_mul_f32 v124, 0x3acccccd, v124
    v_fmamk_f32 v116, v124, 0x00000000, v125
    v_fmamk_f32 v117, v124, 0x3f800000, v125
    v_fmamk_f32 v118, v124, 0x40000000, v125
    v_fmamk_f32 v119, v124, 0x40400000, v125
    v_fmamk_f32 v120, v124, 0x40800000, v125
    v_fmamk_f32 v121, v124, 0x40a00000, v125
    v_fmamk_f32 v122, v124, 0x40c00000, v125
    v_fmamk_f32 v123, v124, 0x40e00000, v125
    v_sin_f32 v116, v116
    v_sin_f32 v117, v117
    v_sin_f32 v118, v118
    v_sin_f32 v119, v119
    v_sin_f32 v120, v120
    v_sin_f32 v121, v121
    v_sin_f32 v122, v122
    v_sin_f32 v123, v123
    v_cvt_pk_bf16_f32 v16, v116, v117
    v_cvt_pk_bf16_f32 v17, v118, v119
    v_cvt_pk_bf16_f32 v18, v120, v121
    v_cvt_pk_bf16_f32 v19, v122, v123
    v_fmamk_f32 v116, v124, 0x42000000, v125
    v_fmamk_f32 v117, v124, 0x42040000, v125
    v_fmamk_f32 v118, v124, 0x42080000, v125
    v_fmamk_f32 v119, v124, 0x420c0000, v125
    v_fmamk_f32 v120, v124, 0x42100000, v125
    v_fmamk_f32 v121, v124, 0x42140000, v125
    v_fmamk_f32 v122, v124, 0x42180000, v125
    v_fmamk_f32 v123, v124, 0x421c0000, v125
    v_sin_f32 v116, v116
    v_sin_f32 v117, v117
    v_sin_f32 v118, v118
    v_sin_f32 v119, v119
    v_sin_f32 v120, v120
    v_sin_f32 v121, v121
    v_sin_f32 v122, v122
    v_sin_f32 v123, v123
    v_cvt_pk_bf16_f32 v20, v116, v117
    v_cvt_pk_bf16_f32 v21, v118, v119
    v_cvt_pk_bf16_f32 v22, v120, v121
    v_cvt_pk_bf16_f32 v23, v122, v123
    v_fmamk_f32 v116, v124, 0x42800000, v125
    v_fmamk_f32 v117, v124, 0x42820000, v125
    v_fmamk_f32 v118, v124, 0x42840000, v125
    v_fmamk_f32 v119, v124, 0x42860000, v125
    v_fmamk_f32 v120, v124, 0x42880000, v125
    v_fmamk_f32 v121, v124, 0x428a0000, v125
    v_fmamk_f32 v122, v124, 0x428c0000, v125
    v_fmamk_f32 v123, v124, 0x428e0000, v125
    v_sin_f32 v116, v116
    v_sin_f32 v117, v117
    v_sin_f32 v118, v118
    v_sin_f32 v119, v119
    v_sin_f32 v120, v120
    v_sin_f32 v121, v121
    v_sin_f32 v122, v122
    v_sin_f32 v123, v123
    v_cvt_pk_bf16_f32 v24, v116, v117
    v_cvt_pk_bf16_f32 v25, v118, v119
    v_cvt_pk_bf16_f32 v26, v120, v121
    v_cvt_pk_bf16_f32 v27, v122, v123
Lg_67:
    s_waitcnt vmcnt(0)
    s_barrier
    s_cmp_lg_u32 s3, 0
    s_cbranch_scc1 Lnf_68
    s_add_u32 s62, s41, 5
    v_mov_b32 v0, s62
    v_writelane_b32 v0, s27, 1
    v_lshlrev_b32 v12, 2, v1
    s_mov_b32 exec_hi, 0
    s_add_u32 s62, s45, 0x80000
    buffer_store_dword v0, v12, s[28:31], s62 offen
    s_cmp_eq_u32 s26, 0
    s_cbranch_scc1 Lng_69
    buffer_store_dword v0, v12, s[28:31], s45 offen sc1
Lng_69:
    s_mov_b32 exec_hi, -1
Lnf_68:
    s_sleep 0
    v_min_u32 v7, 0, v1
    v_lshlrev_b32 v7, 7, v7
    s_add_u32 s60, s50, 0x760000
    buffer_load_dword v7, v7, s[28:31], s60 offen sc1
    v_min_u32 v11, 0, v1
    v_lshlrev_b32 v11, 7, v11
    s_add_u32 s60, s53, 0x760000
    buffer_load_dword v11, v11, s[28:31], s60 offen sc1
    s_add_u32 s67, s44, s68
    s_mul_i32 s66, s52, 81920
    s_add_u32 s66, s66, s68
    s_add_u32 s59, s41, 5
    s_waitcnt vmcnt(1)
    s_mov_b32 s61, 0
Lpoll_70:
    v_subrev_u32 v7, s59, v7
    v_cmp_le_u32 vcc, 16, v7
    s_cbranch_vccz Lpd_71
    s_sleep 2
    v_min_u32 v7, 0, v1
    v_lshlrev_b32 v7, 7, v7
    s_add_u32 s60, s50, 0x760000
    buffer_load_dword v7, v7, s[28:31], s60 offen sc1
    s_waitcnt vmcnt(0)
    s_add_u32 s61, s61, 1
    s_cmp_lt_u32 s61, 200000
    s_cbranch_scc1 Lpoll_70
Lpd_71:
    s_add_u32 m0, s68, 81920
    s_add_u32 s64, s67, 0x1460000
    buffer_load_dwordx4 v2, s[28:31], s64 offen offset:0 sc1 lds
    buffer_load_dwordx4 v2, s[28:31], s64 offen offset:1024 sc1 lds
    buffer_load_dwordx4 v2, s[28:31], s64 offen offset:2048 sc1 lds
    buffer_load_dwordx4 v2, s[28:31], s64 offen offset:3072 sc1 lds
    s_add_u32 m0, s68, 86016
    s_add_u32 s64, s67, 0x1461000
    buffer_load_dwordx4 v2, s[28:31], s64 offen offset:0 sc1 lds
    s_add_u32 s59, s41, 5
    s_waitcnt vmcnt(5)
    s_mov_b32 s61, 0
Lpoll_72:
    v_subrev_u32 v11, s59, v11
    v_cmp_le_u32 vcc, 16, v11
    s_cbranch_vccz Lpd_73
    s_sleep 2
    v_min_u32 v11, 0, v1
    v_lshlrev_b32 v11, 7, v11
    s_add_u32 s60, s53, 0x760000
    buffer_load_dword v11, v11, s[28:31], s60 offen sc1
    s_waitcnt vmcnt(0)
    s_add_u32 s61, s61, 1
    s_cmp_lt_u32 s61, 200000
    s_cbranch_scc1 Lpoll_72
Lpd_73:
    s_add_u32 m0, s68, 122880
    s_add_u32 s64, s66, 0x146a000
    buffer_load_dwordx4 v2, s[28:31], s64 offen offset:0 sc1 lds
    buffer_load_dwordx4 v2, s[28:31], s64 offen offset:1024 sc1 lds
    buffer_load_dwordx4 v2, s[28:31], s64 offen offset:2048 sc1 lds
    buffer_load_dwordx4 v2, s[28:31], s64 offen offset:3072 sc1 lds
    s_add_u32 m0, s68, 126976
    s_add_u32 s64, s66, 0x146b000
    buffer_load_dwordx4 v2, s[28:31], s64 offen offset:0 sc1 lds
    s_cmp_ge_u32 s3, 4
    s_cbranch_scc1 Lh_74
    s_lshl_b32 s6, s3, 12
    v_add_u32 v75, s6, v2
    s_cmp_ge_u32 s3, 2
    s_cselect_b32 s98, 0.5, 0x3e800000
    s_lshl_b32 s99, s39, 5
    v_lshlrev_b32 v74, 3, v9
    v_cvt_f32_u32 v74, v74
    v_and_b32 v13, 1, v1
    v_mul_u32_u24 v13, 0x10001, v13
    v_lshlrev_b32 v13, 15, v13
    v_add_u32 v72, 0, v8
    v_add_u32 v72, s99, v72
    v_cvt_f32_u32 v72, v72
    v_mul_f32 v72, 0x3c800000, v72
    v_fma_f32 v73, v74, v72, s98
    v_fmamk_f32 v56, v72, 0x00000000, v73
    v_fmamk_f32 v57, v72, 0x40000000, v73
    v_fmamk_f32 v58, v72, 0x40800000, v73
    v_fmamk_f32 v59, v72, 0x40c00000, v73
    v_fmamk_f32 v60, v72, 0x3f800000, v73
    v_fmamk_f32 v61, v72, 0x40400000, v73
    v_fmamk_f32 v62, v72, 0x40a00000, v73
    v_fmamk_f32 v63, v72, 0x40e00000, v73
    v_sin_f32 v56, v56
    v_sin_f32 v57, v57
    v_sin_f32 v58, v58
    v_sin_f32 v59, v59
    v_sin_f32 v60, v60
    v_sin_f32 v61, v61
    v_sin_f32 v62, v62
    v_sin_f32 v63, v63
    v_cvt_pk_bf16_f32 v64, v56, v57
    v_cvt_pk_bf16_f32 v65, v58, v59
    v_cvt_pk_bf16_f32 v68, v60, v61
    v_cvt_pk_bf16_f32 v69, v62, v63
    v_xor_b32 v66, v64, v13
    v_xor_b32 v67, v65, v13
    v_xor_b32 v70, v68, v13
    v_xor_b32 v71, v69, v13
    ds_write_b128 v75, v[64:67] offset:20480
    ds_write_b128 v75, v[68:71] offset:21504
    v_add_u32 v72, 16, v8
    v_add_u32 v72, s99, v72
    v_cvt_f32_u32 v72, v72
    v_mul_f32 v72, 0x3c800000, v72
    v_fma_f32 v73, v74, v72, s98
    v_fmamk_f32 v56, v72, 0x00000000, v73
    v_fmamk_f32 v57, v72, 0x40000000, v73
    v_fmamk_f32 v58, v72, 0x40800000, v73
    v_fmamk_f32 v59, v72, 0x40c00000, v73
    v_fmamk_f32 v60, v72, 0x3f800000, v73
    v_fmamk_f32 v61, v72, 0x40400000, v73
    v_fmamk_f32 v62, v72, 0x40a00000, v73
    v_fmamk_f32 v63, v72, 0x40e00000, v73
    v_sin_f32 v56, v56
    v_sin_f32 v57, v57
    v_sin_f32 v58, v58
    v_sin_f32 v59, v59
    v_sin_f32 v60, v60
    v_sin_f32 v61, v61
    v_sin_f32 v62, v62
    v_sin_f32 v63, v63
    v_cvt_pk_bf16_f32 v64, v56, v57
    v_cvt_pk_bf16_f32 v65, v58, v59
    v_cvt_pk_bf16_f32 v68, v60, v61
    v_cvt_pk_bf16_f32 v69, v62, v63
    v_xor_b32 v66, v64, v13
    v_xor_b32 v67, v65, v13
    v_xor_b32 v70, v68, v13
    v_xor_b32 v71, v69, v13
    ds_write_b128 v75, v[64:67] offset:22528
    ds_write_b128 v75, v[68:71] offset:23552
    s_waitcnt vmcnt(0) lgkmcnt(0)
    s_barrier
    s_setprio 1
    ds_read_b128 v[88:91], v5 offset:0
    ds_read_b128 v[92:95], v5 offset:256
    ds_read_b128 v[96:99], v6 offset:0
    ds_read_b128 v[100:103], v6 offset:256
    ds_read_b128 v[116:119], v5 offset:2048
    ds_read_b128 v[120:123], v5 offset:2304
    ds_read_b128 v[124:127], v6 offset:2048
    ds_read_b128 v[128:131], v6 offset:2304
    s_waitcnt lgkmcnt(4)
    v_mfma_f32_16x16x32_bf16 v[56:59], v[88:91], v[16:19], 0
    ds_read_b128 v[104:107], v5 offset:4096
    v_mfma_f32_16x16x32_bf16 v[60:63], v[92:95], v[16:19], 0
    ds_read_b128 v[108:111], v5 offset:4352
    v_mfma_f32_16x16x32_bf16 v[64:67], v[96:99], v[16:19], 0
    ds_read_b128 v[112:115], v6 offset:4096
    v_mfma_f32_16x16x32_bf16 v[68:71], v[100:103], v[16:19], 0
    ds_read_b128 v[132:135], v6 offset:4352
    s_waitcnt lgkmcnt(4)
    v_mfma_f32_16x16x32_bf16 v[56:59], v[116:119], v[20:23], v[56:59]
    ds_read_b128 v[88:91], v5 offset:6144
    v_mfma_f32_16x16x32_bf16 v[60:63], v[120:123], v[20:23], v[60:63]
    ds_read_b128 v[92:95], v5 offset:6400
    v_mfma_f32_16x16x32_bf16 v[64:67], v[124:127], v[20:23], v[64:67]
    ds_read_b128 v[96:99], v6 offset:6144
    v_mfma_f32_16x16x32_bf16 v[68:71], v[128:131], v[20:23], v[68:71]
    ds_read_b128 v[100:103], v6 offset:6400
    s_waitcnt lgkmcnt(4)
    v_mfma_f32_16x16x32_bf16 v[56:59], v[104:107], v[24:27], v[56:59]
    ds_read_b128 v[116:119], v5 offset:8192
    v_mfma_f32_16x16x32_bf16 v[60:63], v[108:111], v[24:27], v[60:63]
    ds_read_b128 v[120:123], v5 offset:8448
    v_mfma_f32_16x16x32_bf16 v[64:67], v[112:115], v[24:27], v[64:67]
    ds_read_b128 v[124:127], v6 offset:8192
    v_mfma_f32_16x16x32_bf16 v[68:71], v[132:135], v[24:27], v[68:71]
    ds_read_b128 v[128:131], v6 offset:8448
    s_waitcnt lgkmcnt(4)
    v_mfma_f32_16x16x32_bf16 v[56:59], v[88:91], v[28:31], v[56:59]
    ds_read_b128 v[104:107], v5 offset:10240
    v_mfma_f32_16x16x32_bf16 v[60:63], v[92:95], v[28:31], v[60:63]
    ds_read_b128 v[108:111], v5 offset:10496
    v_mfma_f32_16x16x32_bf16 v[64:67], v[96:99], v[28:31], v[64:67]
    ds_read_b128 v[112:115], v6 offset:10240
    v_mfma_f32_16x16x32_bf16 v[68:71], v[100:103], v[28:31], v[68:71]
    ds_read_b128 v[132:135], v6 offset:10496
    s_waitcnt lgkmcnt(4)
    v_mfma_f32_16x16x32_bf16 v[56:59], v[116:119], v[32:35], v[56:59]
    ds_read_b128 v[88:91], v5 offset:12288
    v_mfma_f32_16x16x32_bf16 v[60:63], v[120:123], v[32:35], v[60:63]
    ds_read_b128 v[92:95], v5 offset:12544
    v_mfma_f32_16x16x32_bf16 v[64:67], v[124:127], v[32:35], v[64:67]
    ds_read_b128 v[96:99], v6 offset:12288
    v_mfma_f32_16x16x32_bf16 v[68:71], v[128:131], v[32:35], v[68:71]
    ds_read_b128 v[100:103], v6 offset:12544
    s_waitcnt lgkmcnt(4)
    v_mfma_f32_16x16x32_bf16 v[56:59], v[104:107], v[36:39], v[56:59]
    ds_read_b128 v[116:119], v5 offset:14336
    v_mfma_f32_16x16x32_bf16 v[60:63], v[108:111], v[36:39], v[60:63]
    ds_read_b128 v[120:123], v5 offset:14592
    v_mfma_f32_16x16x32_bf16 v[64:67], v[112:115], v[36:39], v[64:67]
    ds_read_b128 v[124:127], v6 offset:14336
    v_mfma_f32_16x16x32_bf16 v[68:71], v[132:135], v[36:39], v[68:71]
    ds_read_b128 v[128:131], v6 offset:14592
    s_waitcnt lgkmcnt(4)
    v_mfma_f32_16x16x32_bf16 v[56:59], v[88:91], v[40:43], v[56:59]
    ds_read_b128 v[104:107], v5 offset:16384
    v_mfma_f32_16x16x32_bf16 v[60:63], v[92:95], v[40:43], v[60:63]
    ds_read_b128 v[108:111], v5 offset:16640
    v_mfma_f32_16x16x32_bf16 v[64:67], v[96:99], v[40:43], v[64:67]
    ds_read_b128 v[112:115], v6 offset:16384
    v_mfma_f32_16x16x32_bf16 v[68:71], v[100:103], v[40:43], v[68:71]
    ds_read_b128 v[132:135], v6 offset:16640
    s_waitcnt lgkmcnt(4)
    v_mfma_f32_16x16x32_bf16 v[56:59], v[116:119], v[44:47], v[56:59]
    ds_read_b128 v[88:91], v5 offset:18432
    v_mfma_f32_16x16x32_bf16 v[60:63], v[120:123], v[44:47], v[60:63]
    ds_read_b128 v[92:95], v5 offset:18688
    v_mfma_f32_16x16x32_bf16 v[64:67], v[124:127], v[44:47], v[64:67]
    ds_read_b128 v[96:99], v6 offset:18432
    v_mfma_f32_16x16x32_bf16 v[68:71], v[128:131], v[44:47], v[68:71]
    ds_read_b128 v[100:103], v6 offset:18688
    s_waitcnt lgkmcnt(4)
    v_mfma_f32_16x16x32_bf16 v[56:59], v[104:107], v[48:51], v[56:59]
    ds_read_b128 v[116:119], v5 offset:20480
    v_mfma_f32_16x16x32_bf16 v[60:63], v[108:111], v[48:51], v[60:63]
    ds_read_b128 v[120:123], v5 offset:20736
    v_mfma_f32_16x16x32_bf16 v[64:67], v[112:115], v[48:51], v[64:67]
    ds_read_b128 v[124:127], v6 offset:20480
    v_mfma_f32_16x16x32_bf16 v[68:71], v[132:135], v[48:51], v[68:71]
    ds_read_b128 v[128:131], v6 offset:20736
    s_waitcnt lgkmcnt(4)
    v_mfma_f32_16x16x32_bf16 v[56:59], v[88:91], v[52:55], v[56:59]
    ds_read_b128 v[104:107], v5 offset:22528
    v_mfma_f32_16x16x32_bf16 v[60:63], v[92:95], v[52:55], v[60:63]
    ds_read_b128 v[108:111], v5 offset:22784
    v_mfma_f32_16x16x32_bf16 v[64:67], v[96:99], v[52:55], v[64:67]
    ds_read_b128 v[112:115], v6 offset:22528
    v_mfma_f32_16x16x32_bf16 v[68:71], v[100:103], v[52:55], v[68:71]
    ds_read_b128 v[132:135], v6 offset:22784
    s_waitcnt lgkmcnt(4)
    v_mfma_f32_16x16x32_bf16 v[72:75], v[116:119], v[16:19], 0
    ds_read_b128 v[88:91], v5 offset:24576
    v_mfma_f32_16x16x32_bf16 v[76:79], v[120:123], v[16:19], 0
    ds_read_b128 v[92:95], v5 offset:24832
    v_mfma_f32_16x16x32_bf16 v[80:83], v[124:127], v[16:19], 0
    ds_read_b128 v[96:99], v6 offset:24576
    v_mfma_f32_16x16x32_bf16 v[84:87], v[128:131], v[16:19], 0
    ds_read_b128 v[100:103], v6 offset:24832
    s_waitcnt lgkmcnt(4)
    v_mfma_f32_16x16x32_bf16 v[72:75], v[104:107], v[20:23], v[72:75]
    ds_read_b128 v[116:119], v5 offset:26624
    v_mfma_f32_16x16x32_bf16 v[76:79], v[108:111], v[20:23], v[76:79]
    ds_read_b128 v[120:123], v5 offset:26880
    v_mfma_f32_16x16x32_bf16 v[80:83], v[112:115], v[20:23], v[80:83]
    ds_read_b128 v[124:127], v6 offset:26624
    v_mfma_f32_16x16x32_bf16 v[84:87], v[132:135], v[20:23], v[84:87]
    ds_read_b128 v[128:131], v6 offset:26880
    s_waitcnt lgkmcnt(4)
    v_mfma_f32_16x16x32_bf16 v[72:75], v[88:91], v[24:27], v[72:75]
    ds_read_b128 v[104:107], v5 offset:28672
    v_mfma_f32_16x16x32_bf16 v[76:79], v[92:95], v[24:27], v[76:79]
    ds_read_b128 v[108:111], v5 offset:28928
    v_mfma_f32_16x16x32_bf16 v[80:83], v[96:99], v[24:27], v[80:83]
    ds_read_b128 v[112:115], v6 offset:28672
    v_mfma_f32_16x16x32_bf16 v[84:87], v[100:103], v[24:27], v[84:87]
    ds_read_b128 v[132:135], v6 offset:28928
    s_waitcnt lgkmcnt(4)
    v_mfma_f32_16x16x32_bf16 v[72:75], v[116:119], v[28:31], v[72:75]
    ds_read_b128 v[88:91], v5 offset:30720
    v_mfma_f32_16x16x32_bf16 v[76:79], v[120:123], v[28:31], v[76:79]
    ds_read_b128 v[92:95], v5 offset:30976
    v_mfma_f32_16x16x32_bf16 v[80:83], v[124:127], v[28:31], v[80:83]
    ds_read_b128 v[96:99], v6 offset:30720
    v_mfma_f32_16x16x32_bf16 v[84:87], v[128:131], v[28:31], v[84:87]
    ds_read_b128 v[100:103], v6 offset:30976
    s_waitcnt lgkmcnt(4)
    v_mfma_f32_16x16x32_bf16 v[72:75], v[104:107], v[32:35], v[72:75]
    ds_read_b128 v[116:119], v5 offset:32768
    v_mfma_f32_16x16x32_bf16 v[76:79], v[108:111], v[32:35], v[76:79]
    ds_read_b128 v[120:123], v5 offset:33024
    v_mfma_f32_16x16x32_bf16 v[80:83], v[112:115], v[32:35], v[80:83]
    ds_read_b128 v[124:127], v6 offset:32768
    v_mfma_f32_16x16x32_bf16 v[84:87], v[132:135], v[32:35], v[84:87]
    ds_read_b128 v[128:131], v6 offset:33024
    s_waitcnt lgkmcnt(4)
    v_mfma_f32_16x16x32_bf16 v[72:75], v[88:91], v[36:39], v[72:75]
    ds_read_b128 v[104:107], v5 offset:34816
    v_mfma_f32_16x16x32_bf16 v[76:79], v[92:95], v[36:39], v[76:79]
    ds_read_b128 v[108:111], v5 offset:35072
    v_mfma_f32_16x16x32_bf16 v[80:83], v[96:99], v[36:39], v[80:83]
    ds_read_b128 v[112:115], v6 offset:34816
    v_mfma_f32_16x16x32_bf16 v[84:87], v[100:103], v[36:39], v[84:87]
    ds_read_b128 v[132:135], v6 offset:35072
    s_waitcnt lgkmcnt(4)
    v_mfma_f32_16x16x32_bf16 v[72:75], v[116:119], v[40:43], v[72:75]
    ds_read_b128 v[88:91], v5 offset:36864
    v_mfma_f32_16x16x32_bf16 v[76:79], v[120:123], v[40:43], v[76:79]
    ds_read_b128 v[92:95], v5 offset:37120
    v_mfma_f32_16x16x32_bf16 v[80:83], v[124:127], v[40:43], v[80:83]
    ds_read_b128 v[96:99], v6 offset:36864
    v_mfma_f32_16x16x32_bf16 v[84:87], v[128:131], v[40:43], v[84:87]
    ds_read_b128 v[100:103], v6 offset:37120
    s_waitcnt lgkmcnt(4)
    v_mfma_f32_16x16x32_bf16 v[72:75], v[104:107], v[44:47], v[72:75]
    ds_read_b128 v[116:119], v5 offset:38912
    v_mfma_f32_16x16x32_bf16 v[76:79], v[108:111], v[44:47], v[76:79]
    ds_read_b128 v[120:123], v5 offset:39168
    v_mfma_f32_16x16x32_bf16 v[80:83], v[112:115], v[44:47], v[80:83]
    ds_read_b128 v[124:127], v6 offset:38912
    v_mfma_f32_16x16x32_bf16 v[84:87], v[132:135], v[44:47], v[84:87]
    ds_read_b128 v[128:131], v6 offset:39168
    s_waitcnt lgkmcnt(4)
    v_mfma_f32_16x16x32_bf16 v[72:75], v[88:91], v[48:51], v[72:75]
    v_mfma_f32_16x16x32_bf16 v[76:79], v[92:95], v[48:51], v[76:79]
    v_mfma_f32_16x16x32_bf16 v[80:83], v[96:99], v[48:51], v[80:83]
    v_mfma_f32_16x16x32_bf16 v[84:87], v[100:103], v[48:51], v[84:87]
    s_waitcnt lgkmcnt(0)
    v_mfma_f32_16x16x32_bf16 v[72:75], v[116:119], v[52:55], v[72:75]
    v_mfma_f32_16x16x32_bf16 v[76:79], v[120:123], v[52:55], v[76:79]
    v_mfma_f32_16x16x32_bf16 v[80:83], v[124:127], v[52:55], v[80:83]
    v_mfma_f32_16x16x32_bf16 v[84:87], v[128:131], v[52:55], v[84:87]
    s_setprio 3
    v_and_b32 v0, 1, v1
    v_lshlrev_b32 v0, 31, v0
    v_or_b32 v0, 1.0, v0
    s_nop 0
    v_fma_f32 v56, v72, v0, v56
    v_fma_f32 v57, v73, v0, v57
    v_fma_f32 v58, v74, v0, v58
    v_fma_f32 v59, v75, v0, v59
    v_fma_f32 v60, v76, v0, v60
    v_fma_f32 v61, v77, v0, v61
    v_fma_f32 v62, v78, v0, v62
    v_fma_f32 v63, v79, v0, v63
    v_fma_f32 v64, v80, v0, v64
    v_fma_f32 v65, v81, v0, v65
    v_fma_f32 v66, v82, v0, v66
    v_fma_f32 v67, v83, v0, v67
    v_fma_f32 v68, v84, v0, v68
    v_fma_f32 v69, v85, v0, v69
    v_fma_f32 v70, v86, v0, v70
    v_fma_f32 v71, v87, v0, v71
    ds_read_b128 v[16:19], v2 offset:20480
    ds_read_b128 v[48:51], v2 offset:28672
    ds_read_b128 v[20:23], v2 offset:21504
    ds_read_b128 v[52:55], v2 offset:29696
    ds_read_b128 v[24:27], v2 offset:22528
    ds_read_b128 v[72:75], v2 offset:30720
    ds_read_b128 v[28:31], v2 offset:23552
    ds_read_b128 v[76:79], v2 offset:31744
    ds_read_b128 v[32:35], v2 offset:24576
    ds_read_b128 v[80:83], v2 offset:32768
    ds_read_b128 v[36:39], v2 offset:25600
    ds_read_b128 v[84:87], v2 offset:33792
    ds_read_b128 v[40:43], v2 offset:26624
    ds_read_b128 v[104:107], v2 offset:34816
    ds_read_b128 v[44:47], v2 offset:27648
    ds_read_b128 v[108:111], v2 offset:35840
    s_barrier
    v_lshlrev_b32 v12, 4, v9
    ds_read_b128 v[116:119], v12 offset:36864
    ds_read_b128 v[88:91], v12 offset:37120
    ds_read_b128 v[120:123], v12 offset:36928
    ds_read_b128 v[92:95], v12 offset:37184
    ds_read_b128 v[124:127], v12 offset:36992
    ds_read_b128 v[96:99], v12 offset:37248
    ds_read_b128 v[128:131], v12 offset:37056
    ds_read_b128 v[100:103], v12 offset:37312
L4_76:
    v_cmp_gt_u32 vcc, 8, v8
    v_mov_b32 v13, 0x80008000
    s_nop 0
    v_cndmask_b32 v13, 0, v13, vcc
    v_and_b32 v12, 1, v9
    v_lshl_add_u32 v12, v12, 4, v8
    v_mul_u32_u24 v12, 192, v12
    v_lshrrev_b32 v11, 1, v9
    v_mul_u32_u24 v11, 80, v11
    s_lshl_b32 s6, s3, 4
    s_add_u32 s6, s6, 81920
    v_add3_u32 v12, v12, v11, s6
    s_waitcnt lgkmcnt(0)
    v_mul_f32 v88, v88, v14
    v_mul_f32 v89, v89, v14
    v_mul_f32 v90, v90, v14
    v_mul_f32 v91, v91, v14
    v_mul_f32 v92, v92, v14
    v_mul_f32 v93, v93, v14
    v_mul_f32 v94, v94, v14
    v_mul_f32 v95, v95, v14
    v_mul_f32 v96, v96, v14
    v_mul_f32 v97, v97, v14
    v_mul_f32 v98, v98, v14
    v_mul_f32 v99, v99, v14
    v_mul_f32 v100, v100, v14
    v_mul_f32 v101, v101, v14
    v_mul_f32 v102, v102, v14
    v_mul_f32 v103, v103, v14
    v_fma_f32 v56, v56, v116, -v88
    v_fma_f32 v57, v57, v117, -v89
    v_fma_f32 v58, v58, v118, -v90
    v_fma_f32 v59, v59, v119, -v91
    v_fma_f32 v60, v60, v120, -v92
    v_fma_f32 v61, v61, v121, -v93
    v_fma_f32 v62, v62, v122, -v94
    v_fma_f32 v63, v63, v123, -v95
    v_fma_f32 v64, v64, v124, -v96
    v_fma_f32 v65, v65, v125, -v97
    v_fma_f32 v66, v66, v126, -v98
    v_fma_f32 v67, v67, v127, -v99
    v_fma_f32 v68, v68, v128, -v100
    v_fma_f32 v69, v69, v129, -v101
    v_fma_f32 v70, v70, v130, -v102
    v_fma_f32 v71, v71, v131, -v103
    v_cvt_pk_bf16_f32 v56, v56, v57
    v_cvt_pk_bf16_f32 v57, v58, v59
    v_cvt_pk_bf16_f32 v58, v60, v61
    v_cvt_pk_bf16_f32 v59, v62, v63
    v_cvt_pk_bf16_f32 v60, v64, v65
    v_cvt_pk_bf16_f32 v61, v66, v67
    v_cvt_pk_bf16_f32 v62, v68, v69
    v_cvt_pk_bf16_f32 v63, v70, v71
    v_xor_b32_dpp v64, v56, v13 row_ror:8 row_mask:0xf bank_mask:0xf
    v_xor_b32_dpp v65, v57, v13 row_ror:8 row_mask:0xf bank_mask:0xf
    v_xor_b32_dpp v66, v58, v13 row_ror:8 row_mask:0xf bank_mask:0xf
    v_xor_b32_dpp v67, v59, v13 row_ror:8 row_mask:0xf bank_mask:0xf
    v_xor_b32_dpp v68, v60, v13 row_ror:8 row_mask:0xf bank_mask:0xf
    v_xor_b32_dpp v69, v61, v13 row_ror:8 row_mask:0xf bank_mask:0xf
    v_xor_b32_dpp v70, v62, v13 row_ror:8 row_mask:0xf bank_mask:0xf
    v_xor_b32_dpp v71, v63, v13 row_ror:8 row_mask:0xf bank_mask:0xf
    v_mfma_f32_16x16x32_bf16 v[116:119], v[56:59], v[16:19], 0
    v_mfma_f32_16x16x32_bf16 v[116:119], v[64:67], v[48:51], v[116:119]
    v_mfma_f32_16x16x32_bf16 v[116:119], v[60:63], v[20:23], v[116:119]
    v_mfma_f32_16x16x32_bf16 v[116:119], v[68:71], v[52:55], v[116:119]
    v_mfma_f32_16x16x32_bf16 v[120:123], v[56:59], v[24:27], 0
    v_mfma_f32_16x16x32_bf16 v[120:123], v[64:67], v[72:75], v[120:123]
    v_mfma_f32_16x16x32_bf16 v[120:123], v[60:63], v[28:31], v[120:123]
    v_mfma_f32_16x16x32_bf16 v[120:123], v[68:71], v[76:79], v[120:123]
    v_mfma_f32_16x16x32_bf16 v[124:127], v[56:59], v[32:35], 0
    v_mfma_f32_16x16x32_bf16 v[124:127], v[64:67], v[80:83], v[124:127]
    v_mfma_f32_16x16x32_bf16 v[124:127], v[60:63], v[36:39], v[124:127]
    v_mfma_f32_16x16x32_bf16 v[124:127], v[68:71], v[84:87], v[124:127]
    v_mfma_f32_16x16x32_bf16 v[128:131], v[56:59], v[40:43], 0
    v_mfma_f32_16x16x32_bf16 v[128:131], v[64:67], v[104:107], v[128:131]
    v_mfma_f32_16x16x32_bf16 v[128:131], v[60:63], v[44:47], v[128:131]
    v_mfma_f32_16x16x32_bf16 v[128:131], v[68:71], v[108:111], v[128:131]
    v_cvt_pk_bf16_f32 v116, v116, v117
    v_cvt_pk_bf16_f32 v117, v118, v119
    v_cvt_pk_bf16_f32 v118, v120, v121
    v_cvt_pk_bf16_f32 v119, v122, v123
    s_nop 0
    v_permlane16_swap_b32 v116, v118
    v_permlane16_swap_b32 v117, v119
    ds_write_b128 v12, v[116:119] offset:0
    v_cvt_pk_bf16_f32 v124, v124, v125
    v_cvt_pk_bf16_f32 v125, v126, v127
    v_cvt_pk_bf16_f32 v126, v128, v129
    v_cvt_pk_bf16_f32 v127, v130, v131
    s_nop 0
    v_permlane16_swap_b32 v124, v126
    v_permlane16_swap_b32 v125, v127
    ds_write_b128 v12, v[124:127] offset:6144
    s_branch Lj_75
Lh_74:
    v_fmamk_f32 v116, v124, 0x42c00000, v125
    v_fmamk_f32 v117, v124, 0x42c20000, v125
    v_fmamk_f32 v118, v124, 0x42c40000, v125
    v_fmamk_f32 v119, v124, 0x42c60000, v125
    v_fmamk_f32 v120, v124, 0x42c80000, v125
    v_fmamk_f32 v121, v124, 0x42ca0000, v125
    v_fmamk_f32 v122, v124, 0x42cc0000, v125
    v_fmamk_f32 v123, v124, 0x42ce0000, v125
    v_sin_f32 v116, v116
    v_sin_f32 v117, v117
    v_sin_f32 v118, v118
    v_sin_f32 v119, v119
    v_sin_f32 v120, v120
    v_sin_f32 v121, v121
    v_sin_f32 v122, v122
    v_sin_f32 v123, v123
    v_cvt_pk_bf16_f32 v28, v116, v117
    v_cvt_pk_bf16_f32 v29, v118, v119
    v_cvt_pk_bf16_f32 v30, v120, v121
    v_cvt_pk_bf16_f32 v31, v122, v123
    v_fmamk_f32 v116, v124, 0x43000000, v125
    v_fmamk_f32 v117, v124, 0x43010000, v125
    v_fmamk_f32 v118, v124, 0x43020000, v125
    v_fmamk_f32 v119, v124, 0x43030000, v125
    v_fmamk_f32 v120, v124, 0x43040000, v125
    v_fmamk_f32 v121, v124, 0x43050000, v125
    v_fmamk_f32 v122, v124, 0x43060000, v125
    v_fmamk_f32 v123, v124, 0x43070000, v125
    v_sin_f32 v116, v116
    v_sin_f32 v117, v117
    v_sin_f32 v118, v118
    v_sin_f32 v119, v119
    v_sin_f32 v120, v120
    v_sin_f32 v121, v121
    v_sin_f32 v122, v122
    v_sin_f32 v123, v123
    v_cvt_pk_bf16_f32 v32, v116, v117
    v_cvt_pk_bf16_f32 v33, v118, v119
    v_cvt_pk_bf16_f32 v34, v120, v121
    v_cvt_pk_bf16_f32 v35, v122, v123
    v_mov_b32 v13, 0x80008000
    v_lshrrev_b32 v0, 1, v1
    v_lshrrev_b32 v12, 3, v1
    v_and_b32 v12, v12, v1
    v_xor_b32 v0, v0, v12
    v_and_b32 v0, 1, v0
    v_cmp_eq_u32 vcc, 1, v0
    s_nop 1
    v_cndmask_b32 v12, 0, v13, vcc
    v_and_b32 v0, 1, v1
    v_cmp_eq_u32 vcc, 1, v0
    s_nop 1
    v_cndmask_b32 v124, 0, v13, vcc
    v_xor_b32 v36, v16, v12
    v_xor_b32 v37, v17, v12
    v_xor_b32 v38, v18, v12
    v_xor_b32 v39, v19, v12
    v_xor_b32 v40, v20, v12
    v_xor_b32 v41, v21, v12
    v_xor_b32 v42, v22, v12
    v_xor_b32 v43, v23, v12
    v_xor_b32 v44, v24, v12
    v_xor_b32 v45, v25, v12
    v_xor_b32 v46, v26, v12
    v_xor_b32 v47, v27, v12
    v_xor_b32 v48, v28, v12
    v_xor_b32 v49, v29, v12
    v_xor_b32 v50, v30, v12
    v_xor_b32 v51, v31, v12
    v_xor_b32 v52, v32, v12
    v_xor_b32 v53, v33, v12
    v_xor_b32 v54, v34, v12
    v_xor_b32 v55, v35, v12
    s_mov_b64 exec, vcc
    s_nop 4
    v_xor_b32_dpp v36, v16, v12 row_ror:8 row_mask:0xf bank_mask:0xf
    v_xor_b32_dpp v37, v17, v12 row_ror:8 row_mask:0xf bank_mask:0xf
    v_xor_b32_dpp v38, v18, v12 row_ror:8 row_mask:0xf bank_mask:0xf
    v_xor_b32_dpp v39, v19, v12 row_ror:8 row_mask:0xf bank_mask:0xf
    v_xor_b32_dpp v40, v20, v12 row_ror:8 row_mask:0xf bank_mask:0xf
    v_xor_b32_dpp v41, v21, v12 row_ror:8 row_mask:0xf bank_mask:0xf
    v_xor_b32_dpp v42, v22, v12 row_ror:8 row_mask:0xf bank_mask:0xf
    v_xor_b32_dpp v43, v23, v12 row_ror:8 row_mask:0xf bank_mask:0xf
    v_xor_b32_dpp v44, v24, v12 row_ror:8 row_mask:0xf bank_mask:0xf
    v_xor_b32_dpp v45, v25, v12 row_ror:8 row_mask:0xf bank_mask:0xf
    v_xor_b32_dpp v46, v26, v12 row_ror:8 row_mask:0xf bank_mask:0xf
    v_xor_b32_dpp v47, v27, v12 row_ror:8 row_mask:0xf bank_mask:0xf
    v_xor_b32_dpp v48, v28, v12 row_ror:8 row_mask:0xf bank_mask:0xf
    v_xor_b32_dpp v49, v29, v12 row_ror:8 row_mask:0xf bank_mask:0xf
    v_xor_b32_dpp v50, v30, v12 row_ror:8 row_mask:0xf bank_mask:0xf
    v_xor_b32_dpp v51, v31, v12 row_ror:8 row_mask:0xf bank_mask:0xf
    v_xor_b32_dpp v52, v32, v12 row_ror:8 row_mask:0xf bank_mask:0xf
    v_xor_b32_dpp v53, v33, v12 row_ror:8 row_mask:0xf bank_mask:0xf
    v_xor_b32_dpp v54, v34, v12 row_ror:8 row_mask:0xf bank_mask:0xf
    v_xor_b32_dpp v55, v35, v12 row_ror:8 row_mask:0xf bank_mask:0xf
    s_mov_b64 exec, -1
    v_mov_b32 v72, 0x3f803f80
    v_mov_b32 v73, 0x3f803f80
    v_mov_b32 v74, 0x3f803f80
    v_mov_b32 v75, 0x3f803f80
    s_mul_i32 s6, s38, 40960
    s_lshl_b32 s7, s39, 8
    s_add_u32 s6, s6, s7
    v_add_u32 v5, s6, v5
    s_waitcnt vmcnt(0) lgkmcnt(0)
    s_barrier
    s_setprio 3
    ds_read_b128 v[76:79], v5 offset:0
    ds_read_b128 v[80:83], v5 offset:2048
    ds_read_b128 v[84:87], v5 offset:4096
    ds_read_b128 v[88:91], v5 offset:6144
    ds_read_b128 v[92:95], v5 offset:8192
    ds_read_b128 v[96:99], v5 offset:10240
    s_waitcnt lgkmcnt(5)
    v_mfma_f32_16x16x32_bf16 v[64:67], v[76:79], v[76:79], 0
    ds_read_b128 v[100:103], v5 offset:12288
    v_mfma_f32_16x16x32_bf16 v[68:71], v[76:79], v[72:75], 0
    v_mfma_f32_16x16x32_bf16 v[56:59], v[76:79], v[16:19], 0
    s_waitcnt lgkmcnt(5)
    v_mfma_f32_16x16x32_bf16 v[64:67], v[80:83], v[80:83], v[64:67]
    ds_read_b128 v[104:107], v5 offset:14336
    v_mfma_f32_16x16x32_bf16 v[68:71], v[80:83], v[72:75], v[68:71]
    v_mfma_f32_16x16x32_bf16 v[56:59], v[80:83], v[20:23], v[56:59]
    s_waitcnt lgkmcnt(5)
    v_mfma_f32_16x16x32_bf16 v[64:67], v[84:87], v[84:87], v[64:67]
    ds_read_b128 v[108:111], v5 offset:16384
    v_mfma_f32_16x16x32_bf16 v[68:71], v[84:87], v[72:75], v[68:71]
    v_mfma_f32_16x16x32_bf16 v[56:59], v[84:87], v[24:27], v[56:59]
    s_waitcnt lgkmcnt(5)
    v_mfma_f32_16x16x32_bf16 v[64:67], v[88:91], v[88:91], v[64:67]
    ds_read_b128 v[112:115], v5 offset:18432
    v_mfma_f32_16x16x32_bf16 v[68:71], v[88:91], v[72:75], v[68:71]
    v_mfma_f32_16x16x32_bf16 v[56:59], v[88:91], v[28:31], v[56:59]
    s_waitcnt lgkmcnt(5)
    v_mfma_f32_16x16x32_bf16 v[64:67], v[92:95], v[92:95], v[64:67]
    ds_read_b128 v[76:79], v5 offset:20480
    v_mfma_f32_16x16x32_bf16 v[68:71], v[92:95], v[72:75], v[68:71]
    v_mfma_f32_16x16x32_bf16 v[56:59], v[92:95], v[32:35], v[56:59]
    s_waitcnt lgkmcnt(5)
    v_mfma_f32_16x16x32_bf16 v[64:67], v[96:99], v[96:99], v[64:67]
    ds_read_b128 v[80:83], v5 offset:22528
    v_mfma_f32_16x16x32_bf16 v[68:71], v[96:99], v[72:75], v[68:71]
    v_mfma_f32_16x16x32_bf16 v[56:59], v[96:99], v[36:39], v[56:59]
    s_waitcnt lgkmcnt(5)
    v_mfma_f32_16x16x32_bf16 v[64:67], v[100:103], v[100:103], v[64:67]
    ds_read_b128 v[84:87], v5 offset:24576
    v_mfma_f32_16x16x32_bf16 v[68:71], v[100:103], v[72:75], v[68:71]
    v_mfma_f32_16x16x32_bf16 v[56:59], v[100:103], v[40:43], v[56:59]
    s_waitcnt lgkmcnt(5)
    v_mfma_f32_16x16x32_bf16 v[64:67], v[104:107], v[104:107], v[64:67]
    ds_read_b128 v[88:91], v5 offset:26624
    v_mfma_f32_16x16x32_bf16 v[68:71], v[104:107], v[72:75], v[68:71]
    v_mfma_f32_16x16x32_bf16 v[56:59], v[104:107], v[44:47], v[56:59]
    s_waitcnt lgkmcnt(5)
    v_mfma_f32_16x16x32_bf16 v[64:67], v[108:111], v[108:111], v[64:67]
    ds_read_b128 v[92:95], v5 offset:28672
    v_mfma_f32_16x16x32_bf16 v[68:71], v[108:111], v[72:75], v[68:71]
    v_mfma_f32_16x16x32_bf16 v[56:59], v[108:111], v[48:51], v[56:59]
    s_waitcnt lgkmcnt(5)
    v_mfma_f32_16x16x32_bf16 v[64:67], v[112:115], v[112:115], v[64:67]
    ds_read_b128 v[96:99], v5 offset:30720
    v_mfma_f32_16x16x32_bf16 v[68:71], v[112:115], v[72:75], v[68:71]
    v_mfma_f32_16x16x32_bf16 v[56:59], v[112:115], v[52:55], v[56:59]
    s_waitcnt lgkmcnt(5)
    v_mfma_f32_16x16x32_bf16 v[64:67], v[76:79], v[76:79], v[64:67]
    ds_read_b128 v[100:103], v5 offset:32768
    v_mfma_f32_16x16x32_bf16 v[68:71], v[76:79], v[72:75], v[68:71]
    v_mfma_f32_16x16x32_bf16 v[60:63], v[76:79], v[16:19], 0
    s_waitcnt lgkmcnt(5)
    v_mfma_f32_16x16x32_bf16 v[64:67], v[80:83], v[80:83], v[64:67]
    ds_read_b128 v[104:107], v5 offset:34816
    v_mfma_f32_16x16x32_bf16 v[68:71], v[80:83], v[72:75], v[68:71]
    v_mfma_f32_16x16x32_bf16 v[60:63], v[80:83], v[20:23], v[60:63]
    s_waitcnt lgkmcnt(5)
    v_mfma_f32_16x16x32_bf16 v[64:67], v[84:87], v[84:87], v[64:67]
    ds_read_b128 v[108:111], v5 offset:36864
    v_mfma_f32_16x16x32_bf16 v[68:71], v[84:87], v[72:75], v[68:71]
    v_mfma_f32_16x16x32_bf16 v[60:63], v[84:87], v[24:27], v[60:63]
    s_waitcnt lgkmcnt(5)
    v_mfma_f32_16x16x32_bf16 v[64:67], v[88:91], v[88:91], v[64:67]
    ds_read_b128 v[112:115], v5 offset:38912
    v_mfma_f32_16x16x32_bf16 v[68:71], v[88:91], v[72:75], v[68:71]
    v_mfma_f32_16x16x32_bf16 v[60:63], v[88:91], v[28:31], v[60:63]
    s_waitcnt lgkmcnt(5)
    v_mfma_f32_16x16x32_bf16 v[64:67], v[92:95], v[92:95], v[64:67]
    v_mfma_f32_16x16x32_bf16 v[68:71], v[92:95], v[72:75], v[68:71]
    v_mfma_f32_16x16x32_bf16 v[60:63], v[92:95], v[32:35], v[60:63]
    s_waitcnt lgkmcnt(4)
    v_mfma_f32_16x16x32_bf16 v[64:67], v[96:99], v[96:99], v[64:67]
    v_mfma_f32_16x16x32_bf16 v[68:71], v[96:99], v[72:75], v[68:71]
    v_mfma_f32_16x16x32_bf16 v[60:63], v[96:99], v[36:39], v[60:63]
    s_waitcnt lgkmcnt(3)
    v_mfma_f32_16x16x32_bf16 v[64:67], v[100:103], v[100:103], v[64:67]
    v_mfma_f32_16x16x32_bf16 v[68:71], v[100:103], v[72:75], v[68:71]
    v_mfma_f32_16x16x32_bf16 v[60:63], v[100:103], v[40:43], v[60:63]
    s_waitcnt lgkmcnt(2)
    v_mfma_f32_16x16x32_bf16 v[64:67], v[104:107], v[104:107], v[64:67]
    v_mfma_f32_16x16x32_bf16 v[68:71], v[104:107], v[72:75], v[68:71]
    v_mfma_f32_16x16x32_bf16 v[60:63], v[104:107], v[44:47], v[60:63]
    s_waitcnt lgkmcnt(1)
    v_mfma_f32_16x16x32_bf16 v[64:67], v[108:111], v[108:111], v[64:67]
    v_mfma_f32_16x16x32_bf16 v[68:71], v[108:111], v[72:75], v[68:71]
    v_mfma_f32_16x16x32_bf16 v[60:63], v[108:111], v[48:51], v[60:63]
    s_waitcnt lgkmcnt(0)
    v_mfma_f32_16x16x32_bf16 v[64:67], v[112:115], v[112:115], v[64:67]
    v_mfma_f32_16x16x32_bf16 v[68:71], v[112:115], v[72:75], v[68:71]
    v_mfma_f32_16x16x32_bf16 v[60:63], v[112:115], v[52:55], v[60:63]
    s_and_b32 s66, s3, 3
    s_lshl_b32 s6, s66, 6
    s_add_u32 s6, s6, 36864
    v_lshlrev_b32 v11, 2, v9
    v_sub_u32 v11, v8, v11
    v_lshl_add_u32 v12, v8, 2, s6
    v_cmp_eq_u32 s[70:71], 1, v11
    v_cmp_eq_u32 s[72:73], 2, v11
    v_cmp_eq_u32 s[74:75], 3, v11
    v_cmp_gt_u32 s[76:77], 4, v11
    s_mov_b32 s7, 0x3acccccd
    v_cndmask_b32 v64, v64, v65, s[70:71]
    v_cndmask_b32 v64, v64, v66, s[72:73]
    v_cndmask_b32 v64, v64, v67, s[74:75]
    v_cndmask_b32 v68, v68, v69, s[70:71]
    v_cndmask_b32 v68, v68, v70, s[72:73]
    v_cndmask_b32 v68, v68, v71, s[74:75]
    v_mul_f32 v68, s7, v68
    v_mul_f32 v64, s7, v64
    v_fma_f32 v64, -v68, v68, v64
    v_max_f32 v64, 0, v64
    v_add_f32 v64, 0x3727c5ac, v64
    v_rsq_f32 v64, v64
    s_nop 0
    v_mul_f32 v68, v68, v64
    s_mov_b64 exec, s[76:77]
    ds_write_b32 v12, v64 offset:0
    ds_write_b32 v12, v68 offset:256
    s_mov_b64 exec, -1
    v_and_b32 v0, 1, v1
    v_lshlrev_b32 v0, 31, v0
    v_or_b32 v0, 1.0, v0
    v_fma_f32 v56, v60, v0, v56
    v_fma_f32 v57, v61, v0, v57
    v_fma_f32 v58, v62, v0, v58
    v_fma_f32 v59, v63, v0, v59
    s_lshl_b32 s6, s66, 10
    v_add_u32 v7, s6, v2
    ds_write_b128 v7, v[56:59] offset:37888
    s_setprio 3
    s_cmp_lg_u32 s3, 4
    s_cbranch_scc1 Ln4_77
    ds_read_b128 v[16:19], v2 offset:20480
    ds_read_b128 v[48:51], v2 offset:28672
    ds_read_b128 v[20:23], v2 offset:21504
    ds_read_b128 v[52:55], v2 offset:29696
    ds_read_b128 v[24:27], v2 offset:22528
    ds_read_b128 v[72:75], v2 offset:30720
    ds_read_b128 v[28:31], v2 offset:23552
    ds_read_b128 v[76:79], v2 offset:31744
    ds_read_b128 v[32:35], v2 offset:24576
    ds_read_b128 v[80:83], v2 offset:32768
    ds_read_b128 v[36:39], v2 offset:25600
    ds_read_b128 v[84:87], v2 offset:33792
    ds_read_b128 v[40:43], v2 offset:26624
    ds_read_b128 v[104:107], v2 offset:34816
    ds_read_b128 v[44:47], v2 offset:27648
    ds_read_b128 v[108:111], v2 offset:35840
    s_waitcnt lgkmcnt(15)
    s_barrier
    ds_read_b128 v[56:59], v2 offset:37888
    ds_read_b128 v[60:63], v2 offset:38912
    ds_read_b128 v[64:67], v2 offset:39936
    ds_read_b128 v[68:71], v2 offset:40960
    v_lshlrev_b32 v12, 4, v9
    ds_read_b128 v[116:119], v12 offset:36864
    ds_read_b128 v[88:91], v12 offset:37120
    ds_read_b128 v[120:123], v12 offset:36928
    ds_read_b128 v[92:95], v12 offset:37184
    ds_read_b128 v[124:127], v12 offset:36992
    ds_read_b128 v[96:99], v12 offset:37248
    ds_read_b128 v[128:131], v12 offset:37056
    ds_read_b128 v[100:103], v12 offset:37312
    s_branch L4_76
Ln4_77:
    s_cmp_lg_u32 s3, 7
    s_cbranch_scc1 L7_78
    v_min_u32 v0, 23, v10
    v_lshlrev_b32 v0, 7, v0
    s_movk_i32 s7, 20480
    v_mad_u32_u24 v0, v4, s7, v0
    s_and_b32 s6, s101, 3
    s_mul_i32 s6, s6, 3072
    s_mul_i32 s7, s100, 40960
    s_add_u32 s6, s6, s7
    s_add_u32 s7, s6, 8192
    buffer_load_dword v60, v0, s[28:31], s7 offen sc1
    s_add_u32 s7, s6, 49152
    buffer_load_dword v60, v0, s[28:31], s7 offen sc1
    s_add_u32 s7, s6, 90112
    buffer_load_dword v60, v0, s[28:31], s7 offen sc1
    s_add_u32 s7, s6, 131072
    buffer_load_dword v60, v0, s[28:31], s7 offen sc1
L7_78:
    s_waitcnt lgkmcnt(0)
    s_barrier
    s_cmp_eq_u32 s3, 7
    s_cbranch_scc1 L7_79
    s_cmp_eq_u32 s3, 6
    s_cselect_b32 s99, s51, s4
    s_cselect_b32 s6, 4096, 0
    s_add_u32 s6, s6, 106496
    v_add_u32 v31, s6, v2
    v_lshl_add_u32 v28, v10, 6, s99
    v_cvt_f32_u32 v28, v28
    v_mul_f32 v28, 0x3a000000, v28
    v_lshlrev_b32 v29, 3, v4
    v_cvt_f32_u32 v29, v29
    v_mul_f32 v29, v29, v28
    v_fmamk_f32 v16, v28, 0x00000000, v29
    v_fmamk_f32 v17, v28, 0x3f800000, v29
    v_fmamk_f32 v18, v28, 0x40000000, v29
    v_fmamk_f32 v19, v28, 0x40400000, v29
    v_fmamk_f32 v20, v28, 0x40800000, v29
    v_fmamk_f32 v21, v28, 0x40a00000, v29
    v_fmamk_f32 v22, v28, 0x40c00000, v29
    v_fmamk_f32 v23, v28, 0x40e00000, v29
    v_sin_f32 v16, v16
    v_sin_f32 v17, v17
    v_sin_f32 v18, v18
    v_sin_f32 v19, v19
    v_sin_f32 v20, v20
    v_sin_f32 v21, v21
    v_sin_f32 v22, v22
    v_sin_f32 v23, v23
    v_cvt_pk_bf16_f32 v24, v16, v17
    v_cvt_pk_bf16_f32 v25, v18, v19
    v_cvt_pk_bf16_f32 v26, v20, v21
    v_cvt_pk_bf16_f32 v27, v22, v23
    ds_write_b128 v31, v[24:27] offset:2048
    v_fmamk_f32 v16, v28, 0x41800000, v29
    v_fmamk_f32 v17, v28, 0x41880000, v29
    v_fmamk_f32 v18, v28, 0x41900000, v29
    v_fmamk_f32 v19, v28, 0x41980000, v29
    v_fmamk_f32 v20, v28, 0x41a00000, v29
    v_fmamk_f32 v21, v28, 0x41a80000, v29
    v_fmamk_f32 v22, v28, 0x41b00000, v29
    v_fmamk_f32 v23, v28, 0x41b80000, v29
    v_sin_f32 v16, v16
    v_sin_f32 v17, v17
    v_sin_f32 v18, v18
    v_sin_f32 v19, v19
    v_sin_f32 v20, v20
    v_sin_f32 v21, v21
    v_sin_f32 v22, v22
    v_sin_f32 v23, v23
    v_cvt_pk_bf16_f32 v24, v16, v17
    v_cvt_pk_bf16_f32 v25, v18, v19
    v_cvt_pk_bf16_f32 v26, v20, v21
    v_cvt_pk_bf16_f32 v27, v22, v23
    ds_write_b128 v31, v[24:27] offset:3072
    v_add_f32 v29, 0x3e800000, v29
    v_fmamk_f32 v16, v28, 0x00000000, v29
    v_fmamk_f32 v17, v28, 0x3f800000, v29
    v_fmamk_f32 v18, v28, 0x40000000, v29
    v_fmamk_f32 v19, v28, 0x40400000, v29
    v_fmamk_f32 v20, v28, 0x40800000, v29
    v_fmamk_f32 v21, v28, 0x40a00000, v29
    v_fmamk_f32 v22, v28, 0x40c00000, v29
    v_fmamk_f32 v23, v28, 0x40e00000, v29
    v_sin_f32 v16, v16
    v_sin_f32 v17, v17
    v_sin_f32 v18, v18
    v_sin_f32 v19, v19
    v_sin_f32 v20, v20
    v_sin_f32 v21, v21
    v_sin_f32 v22, v22
    v_sin_f32 v23, v23
    v_cvt_pk_bf16_f32 v24, v16, v17
    v_cvt_pk_bf16_f32 v25, v18, v19
    v_cvt_pk_bf16_f32 v26, v20, v21
    v_cvt_pk_bf16_f32 v27, v22, v23
    ds_write_b128 v31, v[24:27] offset:0
    v_fmamk_f32 v16, v28, 0x41800000, v29
    v_fmamk_f32 v17, v28, 0x41880000, v29
    v_fmamk_f32 v18, v28, 0x41900000, v29
    v_fmamk_f32 v19, v28, 0x41980000, v29
    v_fmamk_f32 v20, v28, 0x41a00000, v29
    v_fmamk_f32 v21, v28, 0x41a80000, v29
    v_fmamk_f32 v22, v28, 0x41b00000, v29
    v_fmamk_f32 v23, v28, 0x41b80000, v29
    v_sin_f32 v16, v16
    v_sin_f32 v17, v17
    v_sin_f32 v18, v18
    v_sin_f32 v19, v19
    v_sin_f32 v20, v20
    v_sin_f32 v21, v21
    v_sin_f32 v22, v22
    v_sin_f32 v23, v23
    v_cvt_pk_bf16_f32 v24, v16, v17
    v_cvt_pk_bf16_f32 v25, v18, v19
    v_cvt_pk_bf16_f32 v26, v20, v21
    v_cvt_pk_bf16_f32 v27, v22, v23
    ds_write_b128 v31, v[24:27] offset:1024
    s_branch Lj_75
L7_79:
    v_mul_u32_u24 v0, 40960, v4
    v_lshl_add_u32 v0, v10, 4, v0
    s_mul_i32 s6, s5, 2560
    s_add_u32 s62, s44, 0x1460000
    s_add_u32 s64, s6, 0
    s_add_u32 s64, s64, s62
    s_mov_b32 m0, 94208
    s_nop 0
    buffer_load_dwordx4 v0, s[28:31], s64 offen sc1 lds
    s_add_u32 s64, s6, 512
    s_add_u32 s64, s64, s62
    s_mov_b32 m0, 95232
    s_nop 0
    buffer_load_dwordx4 v0, s[28:31], s64 offen sc1 lds
    s_add_u32 s64, s6, 1024
    s_add_u32 s64, s64, s62
    s_mov_b32 m0, 96256
    s_nop 0
    buffer_load_dwordx4 v0, s[28:31], s64 offen sc1 lds
    s_add_u32 s64, s6, 1536
    s_add_u32 s64, s64, s62
    s_mov_b32 m0, 97280
    s_nop 0
    buffer_load_dwordx4 v0, s[28:31], s64 offen sc1 lds
    s_add_u32 s64, s6, 2048
    s_add_u32 s64, s64, s62
    s_mov_b32 m0, 98304
    s_nop 0
    buffer_load_dwordx4 v0, s[28:31], s64 offen sc1 lds
    s_sub_u32 s64, 38400, s6
    s_add_u32 s64, s64, s62
    s_mov_b32 m0, 99328
    s_nop 0
    buffer_load_dwordx4 v0, s[28:31], s64 offen sc1 lds
    s_sub_u32 s64, 38912, s6
    s_add_u32 s64, s64, s62
    s_mov_b32 m0, 100352
    s_nop 0
    buffer_load_dwordx4 v0, s[28:31], s64 offen sc1 lds
    s_sub_u32 s64, 39424, s6
    s_add_u32 s64, s64, s62
    s_mov_b32 m0, 101376
    s_nop 0
    buffer_load_dwordx4 v0, s[28:31], s64 offen sc1 lds
    s_sub_u32 s64, 39936, s6
    s_add_u32 s64, s64, s62
    s_mov_b32 m0, 102400
    s_nop 0
    buffer_load_dwordx4 v0, s[28:31], s64 offen sc1 lds
    s_sub_u32 s64, 40448, s6
    s_add_u32 s64, s64, s62
    s_mov_b32 m0, 103424
    s_nop 0
    buffer_load_dwordx4 v0, s[28:31], s64 offen sc1 lds
    s_sub_u32 s64, 40960, s6
    s_cmp_eq_u32 s5, 0
    s_cselect_b32 s64, 0, s64
    s_add_u32 s64, s64, s62
    s_mov_b32 m0, 104448
    s_nop 0
    buffer_load_dwordx4 v0, s[28:31], s64 offen sc1 lds
    s_movk_i32 s64, 20480
    s_add_u32 s64, s64, s62
    s_mov_b32 m0, 105472
    s_nop 0
    buffer_load_dwordx4 v0, s[28:31], s64 offen sc1 lds
Lj_75:
    s_nop 1
    s_lshl_b32 s6, s3, 6
    s_add_u32 s6, s6, 0
    v_add_u32 v0, s6, v1
    v_mul_u32_u24 v7, 5462, v0
    v_lshrrev_b32 v7, 16, v7
    v_lshlrev_b32 v0, 4, v0
    s_mov_b32 s7, 48960
    v_mad_u32_u24 v5, v7, s7, v0
    s_lshl_b32 s6, s3, 6
    s_add_u32 s6, s6, 512
    v_add_u32 v0, s6, v1
    v_mul_u32_u24 v7, 5462, v0
    v_lshrrev_b32 v7, 16, v7
    v_lshlrev_b32 v0, 4, v0
    s_mov_b32 s7, 48960
    v_mad_u32_u24 v6, v7, s7, v0
    s_waitcnt lgkmcnt(0)
    s_barrier
    s_lshl_b32 s6, s3, 10
    s_add_u32 s6, s6, 81920
    v_add_u32 v0, s6, v2
    ds_read_b128 v[64:67], v0
    ds_read_b128 v[68:71], v0 offset:8192
    s_lshl_b32 s6, s5, 5
    s_add_u32 s6, s6, s4
    s_mulk_i32 s6, 192
    s_add_u32 s6, s6, 0xc60000
    s_cmp_lt_u32 s3, 4
    s_cselect_b32 s7, s6, 0x7f000000
    s_waitcnt lgkmcnt(1)
    buffer_store_dwordx4 v[64:67], v5, s[28:31], s6 offen sc1
    s_waitcnt lgkmcnt(0)
    buffer_store_dwordx4 v[68:71], v6, s[28:31], s7 offen sc1
    v_lshlrev_b32 v7, 3, v1
    v_mov_b32 v76, 0
    v_mov_b32 v77, 0
    ds_write_b64 v7, v[76:77] offset:9472
    s_cmp_lt_u32 s3, 4
    s_cbranch_scc1 Lpa_81
    s_lshl_b32 s6, s38, 5
    v_add_u32 v5, s6, v10
    v_sub_u32 v11, 63, v5
    v_sub_u32 v12, 32, v10
    v_and_b32 v12, 31, v12
    v_sub_u32 v13, 63, v10
    s_cmp_eq_u32 s38, 0
    s_cselect_b64 vcc, -1, 0
    v_cndmask_b32 v12, v13, v12, vcc
    s_cmp_eq_u32 s4, 0
    s_cselect_b64 vcc, -1, 0
    v_cndmask_b32 v11, v11, v12, vcc
    s_cmp_eq_u32 s39, 1
    s_cselect_b64 vcc, -1, 0
    v_cndmask_b32 v5, v5, v11, vcc
    v_bfe_u32 v11, v1, 2, 1
    v_and_b32 v12, 1, v1
    v_lshlrev_b32 v12, 4, v12
    v_mov_b32 v13, 0x3f80
    v_lshlrev_b32 v12, v12, v13
    v_cmp_eq_u32 vcc, v11, v4
    s_nop 1
    v_cndmask_b32 v12, 0, v12, vcc
    v_bfe_u32 v13, v1, 1, 1
    v_bfe_u32 v11, v1, 3, 2
    v_lshl_add_u32 v13, v11, 1, v13
    v_cmp_eq_u32 vcc, 0, v13
    s_nop 1
    v_cndmask_b32 v84, 0, v12, vcc
    v_cmp_eq_u32 vcc, 1, v13
    s_nop 1
    v_cndmask_b32 v85, 0, v12, vcc
    v_cmp_eq_u32 vcc, 2, v13
    s_nop 1
    v_cndmask_b32 v86, 0, v12, vcc
    v_cmp_eq_u32 vcc, 3, v13
    s_nop 1
    v_cndmask_b32 v87, 0, v12, vcc
    v_cmp_eq_u32 vcc, 4, v13
    s_nop 1
    v_cndmask_b32 v88, 0, v12, vcc
    v_cmp_eq_u32 vcc, 5, v13
    s_nop 1
    v_cndmask_b32 v89, 0, v12, vcc
    v_cmp_eq_u32 vcc, 6, v13
    s_nop 1
    v_cndmask_b32 v90, 0, v12, vcc
    v_cmp_eq_u32 vcc, 7, v13
    s_nop 1
    v_cndmask_b32 v91, 0, v12, vcc
Lpa_81:
    s_waitcnt vmcnt(0) lgkmcnt(0)
    s_barrier
    s_cmp_lg_u32 s3, 0
    s_cbranch_scc1 Lnf_82
    s_add_u32 s62, s41, 6
    v_mov_b32 v0, s62
    v_writelane_b32 v0, s27, 1
    v_lshlrev_b32 v7, 2, v1
    s_mov_b32 exec_hi, 0
    buffer_store_dword v0, v7, s[28:31], s45 offen sc1
    s_mov_b32 exec_hi, -1
Lnf_82:
    s_cmp_ge_u32 s3, 4
    s_cbranch_scc1 Lctl_87
    s_setprio 0
    s_add_u32 s6, s3, 4
    s_add_u32 s66, s46, 163840
    s_cmp_ge_u32 s6, s43
    s_cselect_b32 s66, 0x7f000000, s66
    s_add_u32 s64, s46, 0
    buffer_load_dwordx4 v[88:91], v2, s[28:31], s64 offen sc1
    s_add_u32 m0, s69, 0
    s_add_u32 s64, s46, 20480
    buffer_load_dwordx4 v2, s[28:31], s64 offen sc1 lds
    s_add_u32 s64, s46, 1024
    buffer_load_dwordx4 v[92:95], v2, s[28:31], s64 offen sc1
    s_add_u32 m0, s69, 1024
    s_add_u32 s64, s46, 21504
    buffer_load_dwordx4 v2, s[28:31], s64 offen sc1 lds
    s_add_u32 s64, s46, 2048
    buffer_load_dwordx4 v[96:99], v2, s[28:31], s64 offen sc1
    s_add_u32 m0, s69, 2048
    s_add_u32 s64, s46, 22528
    buffer_load_dwordx4 v2, s[28:31], s64 offen sc1 lds
    s_add_u32 s64, s46, 3072
    buffer_load_dwordx4 v[100:103], v2, s[28:31], s64 offen sc1
    s_add_u32 m0, s69, 3072
    s_add_u32 s64, s46, 23552
    buffer_load_dwordx4 v2, s[28:31], s64 offen sc1 lds
    s_add_u32 s64, s46, 4096
    buffer_load_dwordx4 v[104:107], v2, s[28:31], s64 offen sc1
    s_waitcnt vmcnt(8)
    s_add_u32 m0, s69, 4096
    s_add_u32 s64, s46, 24576
    buffer_load_dwordx4 v2, s[28:31], s64 offen sc1 lds
    s_waitcnt vmcnt(8)
    s_add_u32 s64, s46, 5120
    buffer_load_dwordx4 v[108:111], v2, s[28:31], s64 offen sc1
    s_waitcnt vmcnt(8)
    s_add_u32 m0, s69, 5120
    s_add_u32 s64, s46, 25600
    buffer_load_dwordx4 v2, s[28:31], s64 offen sc1 lds
    s_waitcnt vmcnt(8)
    s_add_u32 s64, s46, 6144
    buffer_load_dwordx4 v[112:115], v2, s[28:31], s64 offen sc1
    s_waitcnt vmcnt(8)
    s_add_u32 m0, s69, 6144
    s_add_u32 s64, s46, 26624
    buffer_load_dwordx4 v2, s[28:31], s64 offen sc1 lds
    s_waitcnt vmcnt(8)
    s_add_u32 s64, s46, 7168
    buffer_load_dwordx4 v[116:119], v2, s[28:31], s64 offen sc1
    s_waitcnt vmcnt(8)
    s_add_u32 m0, s69, 7168
    s_add_u32 s64, s46, 27648
    buffer_load_dwordx4 v2, s[28:31], s64 offen sc1 lds
    s_waitcnt vmcnt(8)
    s_add_u32 s64, s46, 8192
    buffer_load_dwordx4 v[120:123], v2, s[28:31], s64 offen sc1
    s_waitcnt vmcnt(8)
    s_add_u32 m0, s69, 8192
    s_add_u32 s64, s46, 28672
    buffer_load_dwordx4 v2, s[28:31], s64 offen sc1 lds
    s_waitcnt vmcnt(8)
    s_add_u32 s64, s46, 9216
    buffer_load_dwordx4 v[124:127], v2, s[28:31], s64 offen sc1
    s_waitcnt vmcnt(8)
    s_add_u32 s64, s46, 10240
    buffer_load_dwordx4 v[128:131], v2, s[28:31], s64 offen sc1
    s_waitcnt vmcnt(8)
    s_add_u32 s64, s46, 11264
    buffer_load_dwordx4 v[132:135], v2, s[28:31], s64 offen sc1
    s_waitcnt vmcnt(8)
    s_add_u32 m0, s69, 40960
    s_add_u32 s64, s66, 20480
    buffer_load_dwordx4 v2, s[28:31], s64 offen sc1 lds
    s_waitcnt vmcnt(8)
    s_add_u32 m0, s69, 41984
    s_add_u32 s64, s66, 21504
    buffer_load_dwordx4 v2, s[28:31], s64 offen sc1 lds
    s_waitcnt vmcnt(8)
    s_add_u32 m0, s69, 43008
    s_add_u32 s64, s66, 22528
    buffer_load_dwordx4 v2, s[28:31], s64 offen sc1 lds
    s_waitcnt vmcnt(8)
    s_add_u32 m0, s69, 44032
    s_add_u32 s64, s66, 23552
    buffer_load_dwordx4 v2, s[28:31], s64 offen sc1 lds
    s_waitcnt vmcnt(8)
    s_add_u32 m0, s69, 45056
    s_add_u32 s64, s66, 24576
    buffer_load_dwordx4 v2, s[28:31], s64 offen sc1 lds
    s_waitcnt vmcnt(8)
    s_add_u32 m0, s69, 46080
    s_add_u32 s64, s66, 25600
    buffer_load_dwordx4 v2, s[28:31], s64 offen sc1 lds
    s_waitcnt vmcnt(8)
    s_add_u32 m0, s69, 47104
    s_add_u32 s64, s66, 26624
    buffer_load_dwordx4 v2, s[28:31], s64 offen sc1 lds
    s_waitcnt vmcnt(8)
    s_add_u32 m0, s69, 48128
    s_add_u32 s64, s66, 27648
    buffer_load_dwordx4 v2, s[28:31], s64 offen sc1 lds
    s_waitcnt vmcnt(8)
    s_add_u32 m0, s69, 49152
    s_add_u32 s64, s66, 28672
    buffer_load_dwordx4 v2, s[28:31], s64 offen sc1 lds
    s_waitcnt vmcnt(8)
    s_lshl_b32 s6, s3, 7
    v_lshl_add_u32 v7, v10, 2, s6
    ds_write_b32 v7, v15 offset:19456
    v_add_u32 v5, 81920, v3
    v_add_u32 v6, 122880, v3
    s_waitcnt vmcnt(0) lgkmcnt(0)
    s_barrier
    s_setprio 3
    v_add_u32 v13, s69, v2
    ds_read_b128 v[48:51], v5 offset:0
    ds_read_b128 v[52:55], v5 offset:256
    ds_read_b128 v[56:59], v5 offset:512
    ds_read_b128 v[60:63], v5 offset:768
    ds_read_b128 v[80:83], v13 offset:0
    s_add_u32 s56, s46, 12288
    s_add_u32 s57, s46, 16384
    s_waitcnt lgkmcnt(0)
    v_mfma_f32_16x16x32_bf16 v[16:19], v[88:91], v[48:51], 0
    ds_read_b128 v[64:67], v5 offset:4096
    v_mfma_f32_16x16x32_bf16 v[20:23], v[88:91], v[52:55], 0
    ds_read_b128 v[68:71], v5 offset:4352
    v_mfma_f32_16x16x32_bf16 v[24:27], v[88:91], v[56:59], 0
    ds_read_b128 v[72:75], v5 offset:4608
    v_mfma_f32_16x16x32_bf16 v[28:31], v[88:91], v[60:63], 0
    ds_read_b128 v[76:79], v5 offset:4864
    v_mfma_f32_16x16x32_bf16 v[32:35], v[80:83], v[48:51], 0
    ds_read_b128 v[84:87], v13 offset:1024
    v_mfma_f32_16x16x32_bf16 v[36:39], v[80:83], v[52:55], 0
    s_add_u32 m0, s69, 0
    s_add_u32 s66, s46, 29696
    buffer_load_dwordx4 v2, s[28:31], s66 offen offset:0 sc1 lds
    v_mfma_f32_16x16x32_bf16 v[40:43], v[80:83], v[56:59], 0
    buffer_load_dwordx4 v[88:91], v2, s[28:31], s56 offen offset:0 sc1
    v_mfma_f32_16x16x32_bf16 v[44:47], v[80:83], v[60:63], 0
    s_waitcnt lgkmcnt(0)
    v_mfma_f32_16x16x32_bf16 v[16:19], v[92:95], v[64:67], v[16:19]
    ds_read_b128 v[48:51], v5 offset:8192
    v_mfma_f32_16x16x32_bf16 v[20:23], v[92:95], v[68:71], v[20:23]
    ds_read_b128 v[52:55], v5 offset:8448
    v_mfma_f32_16x16x32_bf16 v[24:27], v[92:95], v[72:75], v[24:27]
    ds_read_b128 v[56:59], v5 offset:8704
    v_mfma_f32_16x16x32_bf16 v[28:31], v[92:95], v[76:79], v[28:31]
    ds_read_b128 v[60:63], v5 offset:8960
    v_mfma_f32_16x16x32_bf16 v[32:35], v[84:87], v[64:67], v[32:35]
    ds_read_b128 v[80:83], v13 offset:2048
    v_mfma_f32_16x16x32_bf16 v[36:39], v[84:87], v[68:71], v[36:39]
    buffer_load_dwordx4 v2, s[28:31], s66 offen offset:1024 sc1 lds
    v_mfma_f32_16x16x32_bf16 v[40:43], v[84:87], v[72:75], v[40:43]
    buffer_load_dwordx4 v[92:95], v2, s[28:31], s56 offen offset:1024 sc1
    v_mfma_f32_16x16x32_bf16 v[44:47], v[84:87], v[76:79], v[44:47]
    s_waitcnt lgkmcnt(0)
    v_mfma_f32_16x16x32_bf16 v[16:19], v[96:99], v[48:51], v[16:19]
    ds_read_b128 v[64:67], v5 offset:12288
    v_mfma_f32_16x16x32_bf16 v[20:23], v[96:99], v[52:55], v[20:23]
    ds_read_b128 v[68:71], v5 offset:12544
    v_mfma_f32_16x16x32_bf16 v[24:27], v[96:99], v[56:59], v[24:27]
    ds_read_b128 v[72:75], v5 offset:12800
    v_mfma_f32_16x16x32_bf16 v[28:31], v[96:99], v[60:63], v[28:31]
    ds_read_b128 v[76:79], v5 offset:13056
    v_mfma_f32_16x16x32_bf16 v[32:35], v[80:83], v[48:51], v[32:35]
    ds_read_b128 v[84:87], v13 offset:3072
    v_mfma_f32_16x16x32_bf16 v[36:39], v[80:83], v[52:55], v[36:39]
    buffer_load_dwordx4 v2, s[28:31], s66 offen offset:2048 sc1 lds
    v_mfma_f32_16x16x32_bf16 v[40:43], v[80:83], v[56:59], v[40:43]
    buffer_load_dwordx4 v[96:99], v2, s[28:31], s56 offen offset:2048 sc1
    v_mfma_f32_16x16x32_bf16 v[44:47], v[80:83], v[60:63], v[44:47]
    s_waitcnt lgkmcnt(0)
    v_mfma_f32_16x16x32_bf16 v[16:19], v[100:103], v[64:67], v[16:19]
    ds_read_b128 v[48:51], v5 offset:16384
    v_mfma_f32_16x16x32_bf16 v[20:23], v[100:103], v[68:71], v[20:23]
    ds_read_b128 v[52:55], v5 offset:16640
    v_mfma_f32_16x16x32_bf16 v[24:27], v[100:103], v[72:75], v[24:27]
    ds_read_b128 v[56:59], v5 offset:16896
    v_mfma_f32_16x16x32_bf16 v[28:31], v[100:103], v[76:79], v[28:31]
    ds_read_b128 v[60:63], v5 offset:17152
    v_mfma_f32_16x16x32_bf16 v[32:35], v[84:87], v[64:67], v[32:35]
    ds_read_b128 v[80:83], v13 offset:4096
    v_mfma_f32_16x16x32_bf16 v[36:39], v[84:87], v[68:71], v[36:39]
    buffer_load_dwordx4 v2, s[28:31], s66 offen offset:3072 sc1 lds
    v_mfma_f32_16x16x32_bf16 v[40:43], v[84:87], v[72:75], v[40:43]
    buffer_load_dwordx4 v[100:103], v2, s[28:31], s56 offen offset:3072 sc1
    v_mfma_f32_16x16x32_bf16 v[44:47], v[84:87], v[76:79], v[44:47]
    s_waitcnt lgkmcnt(0)
    v_mfma_f32_16x16x32_bf16 v[16:19], v[104:107], v[48:51], v[16:19]
    ds_read_b128 v[64:67], v5 offset:20480
    v_mfma_f32_16x16x32_bf16 v[20:23], v[104:107], v[52:55], v[20:23]
    ds_read_b128 v[68:71], v5 offset:20736
    v_mfma_f32_16x16x32_bf16 v[24:27], v[104:107], v[56:59], v[24:27]
    ds_read_b128 v[72:75], v5 offset:20992
    v_mfma_f32_16x16x32_bf16 v[28:31], v[104:107], v[60:63], v[28:31]
    ds_read_b128 v[76:79], v5 offset:21248
    v_mfma_f32_16x16x32_bf16 v[32:35], v[80:83], v[48:51], v[32:35]
    ds_read_b128 v[84:87], v13 offset:5120
    v_mfma_f32_16x16x32_bf16 v[36:39], v[80:83], v[52:55], v[36:39]
    s_add_u32 m0, s69, 4096
    s_add_u32 s66, s46, 33792
    buffer_load_dwordx4 v2, s[28:31], s66 offen offset:0 sc1 lds
    v_mfma_f32_16x16x32_bf16 v[40:43], v[80:83], v[56:59], v[40:43]
    buffer_load_dwordx4 v[104:107], v2, s[28:31], s57 offen offset:0 sc1
    v_mfma_f32_16x16x32_bf16 v[44:47], v[80:83], v[60:63], v[44:47]
    s_waitcnt lgkmcnt(0)
    v_mfma_f32_16x16x32_bf16 v[16:19], v[108:111], v[64:67], v[16:19]
    ds_read_b128 v[48:51], v5 offset:24576
    v_mfma_f32_16x16x32_bf16 v[20:23], v[108:111], v[68:71], v[20:23]
    ds_read_b128 v[52:55], v5 offset:24832
    v_mfma_f32_16x16x32_bf16 v[24:27], v[108:111], v[72:75], v[24:27]
    ds_read_b128 v[56:59], v5 offset:25088
    v_mfma_f32_16x16x32_bf16 v[28:31], v[108:111], v[76:79], v[28:31]
    ds_read_b128 v[60:63], v5 offset:25344
    v_mfma_f32_16x16x32_bf16 v[32:35], v[84:87], v[64:67], v[32:35]
    ds_read_b128 v[80:83], v13 offset:6144
    v_mfma_f32_16x16x32_bf16 v[36:39], v[84:87], v[68:71], v[36:39]
    buffer_load_dwordx4 v2, s[28:31], s66 offen offset:1024 sc1 lds
    v_mfma_f32_16x16x32_bf16 v[40:43], v[84:87], v[72:75], v[40:43]
    buffer_load_dwordx4 v[108:111], v2, s[28:31], s57 offen offset:1024 sc1
    v_mfma_f32_16x16x32_bf16 v[44:47], v[84:87], v[76:79], v[44:47]
    v_mov_b32 v7, 9728
    ds_read_b32 v7, v7
    s_waitcnt lgkmcnt(1)
    v_mfma_f32_16x16x32_bf16 v[16:19], v[112:115], v[48:51], v[16:19]
    ds_read_b128 v[64:67], v5 offset:28672
    v_mfma_f32_16x16x32_bf16 v[20:23], v[112:115], v[52:55], v[20:23]
    ds_read_b128 v[68:71], v5 offset:28928
    v_mfma_f32_16x16x32_bf16 v[24:27], v[112:115], v[56:59], v[24:27]
    ds_read_b128 v[72:75], v5 offset:29184
    v_mfma_f32_16x16x32_bf16 v[28:31], v[112:115], v[60:63], v[28:31]
    ds_read_b128 v[76:79], v5 offset:29440
    v_mfma_f32_16x16x32_bf16 v[32:35], v[80:83], v[48:51], v[32:35]
    ds_read_b128 v[84:87], v13 offset:7168
    v_mfma_f32_16x16x32_bf16 v[36:39], v[80:83], v[52:55], v[36:39]
    buffer_load_dwordx4 v2, s[28:31], s66 offen offset:2048 sc1 lds
    v_mfma_f32_16x16x32_bf16 v[40:43], v[80:83], v[56:59], v[40:43]
    buffer_load_dwordx4 v[112:115], v2, s[28:31], s57 offen offset:2048 sc1
    v_mfma_f32_16x16x32_bf16 v[44:47], v[80:83], v[60:63], v[44:47]
    s_waitcnt lgkmcnt(5)
    v_cmp_gt_u32 vcc, 4, v7
    s_cbranch_vccz Lcd_90
    s_mov_b32 s61, 0
Lcw_89:
    v_mov_b32 v7, 9728
    ds_read_b32 v7, v7
    s_waitcnt lgkmcnt(0)
    v_cmp_gt_u32 vcc, 4, v7
    s_cbranch_vccz Lcd_90
    s_sleep 1
    s_add_u32 s61, s61, 1
    s_cmp_lt_u32 s61, 200000
    s_cbranch_scc1 Lcw_89
Lcd_90:
    s_waitcnt lgkmcnt(0)
    v_mfma_f32_16x16x32_bf16 v[16:19], v[116:119], v[64:67], v[16:19]
    ds_read_b128 v[48:51], v5 offset:32768
    v_mfma_f32_16x16x32_bf16 v[20:23], v[116:119], v[68:71], v[20:23]
    ds_read_b128 v[52:55], v5 offset:33024
    v_mfma_f32_16x16x32_bf16 v[24:27], v[116:119], v[72:75], v[24:27]
    ds_read_b128 v[56:59], v5 offset:33280
    v_mfma_f32_16x16x32_bf16 v[28:31], v[116:119], v[76:79], v[28:31]
    ds_read_b128 v[60:63], v5 offset:33536
    v_mfma_f32_16x16x32_bf16 v[32:35], v[84:87], v[64:67], v[32:35]
    ds_read_b128 v[80:83], v13 offset:8192
    v_mfma_f32_16x16x32_bf16 v[36:39], v[84:87], v[68:71], v[36:39]
    buffer_load_dwordx4 v2, s[28:31], s66 offen offset:3072 sc1 lds
    v_mfma_f32_16x16x32_bf16 v[40:43], v[84:87], v[72:75], v[40:43]
    buffer_load_dwordx4 v[116:119], v2, s[28:31], s57 offen offset:3072 sc1
    v_mfma_f32_16x16x32_bf16 v[44:47], v[84:87], v[76:79], v[44:47]
    s_waitcnt vmcnt(15) lgkmcnt(0)
    v_mfma_f32_16x16x32_bf16 v[16:19], v[120:123], v[48:51], v[16:19]
    ds_read_b128 v[64:67], v5 offset:36864
    v_mfma_f32_16x16x32_bf16 v[20:23], v[120:123], v[52:55], v[20:23]
    ds_read_b128 v[68:71], v5 offset:37120
    v_mfma_f32_16x16x32_bf16 v[24:27], v[120:123], v[56:59], v[24:27]
    ds_read_b128 v[72:75], v5 offset:37376
    v_mfma_f32_16x16x32_bf16 v[28:31], v[120:123], v[60:63], v[28:31]
    ds_read_b128 v[76:79], v5 offset:37632
    v_mfma_f32_16x16x32_bf16 v[32:35], v[80:83], v[48:51], v[32:35]
    ds_read_b128 v[84:87], v13 offset:0
    v_mfma_f32_16x16x32_bf16 v[36:39], v[80:83], v[52:55], v[36:39]
    s_add_u32 m0, s69, 8192
    s_add_u32 s66, s46, 37888
    buffer_load_dwordx4 v2, s[28:31], s66 offen offset:0 sc1 lds
    v_mfma_f32_16x16x32_bf16 v[40:43], v[80:83], v[56:59], v[40:43]
    v_mfma_f32_16x16x32_bf16 v[44:47], v[80:83], v[60:63], v[44:47]
    s_waitcnt vmcnt(14) lgkmcnt(0)
    v_mfma_f32_16x16x32_bf16 v[16:19], v[124:127], v[64:67], v[16:19]
    ds_read_b128 v[48:51], v6 offset:0
    v_mfma_f32_16x16x32_bf16 v[20:23], v[124:127], v[68:71], v[20:23]
    ds_read_b128 v[52:55], v6 offset:256
    v_mfma_f32_16x16x32_bf16 v[24:27], v[124:127], v[72:75], v[24:27]
    ds_read_b128 v[56:59], v6 offset:512
    v_mfma_f32_16x16x32_bf16 v[28:31], v[124:127], v[76:79], v[28:31]
    ds_read_b128 v[60:63], v6 offset:768
    v_mfma_f32_16x16x32_bf16 v[32:35], v[84:87], v[64:67], v[32:35]
    ds_read_b128 v[80:83], v13 offset:1024
    v_mfma_f32_16x16x32_bf16 v[36:39], v[84:87], v[68:71], v[36:39]
    s_add_u32 m0, s69, 0
    s_add_u32 s66, s46, 38912
    buffer_load_dwordx4 v2, s[28:31], s66 offen offset:0 sc1 lds
    v_mfma_f32_16x16x32_bf16 v[40:43], v[84:87], v[72:75], v[40:43]
    v_mfma_f32_16x16x32_bf16 v[44:47], v[84:87], v[76:79], v[44:47]
    s_waitcnt vmcnt(13) lgkmcnt(0)
    v_mfma_f32_16x16x32_bf16 v[16:19], v[128:131], v[48:51], v[16:19]
    ds_read_b128 v[64:67], v6 offset:4096
    v_mfma_f32_16x16x32_bf16 v[20:23], v[128:131], v[52:55], v[20:23]
    ds_read_b128 v[68:71], v6 offset:4352
    v_mfma_f32_16x16x32_bf16 v[24:27], v[128:131], v[56:59], v[24:27]
    ds_read_b128 v[72:75], v6 offset:4608
    v_mfma_f32_16x16x32_bf16 v[28:31], v[128:131], v[60:63], v[28:31]
    ds_read_b128 v[76:79], v6 offset:4864
    v_mfma_f32_16x16x32_bf16 v[32:35], v[80:83], v[48:51], v[32:35]
    ds_read_b128 v[84:87], v13 offset:2048
    v_mfma_f32_16x16x32_bf16 v[36:39], v[80:83], v[52:55], v[36:39]
    buffer_load_dwordx4 v2, s[28:31], s66 offen offset:1024 sc1 lds
    v_mfma_f32_16x16x32_bf16 v[40:43], v[80:83], v[56:59], v[40:43]
    v_mfma_f32_16x16x32_bf16 v[44:47], v[80:83], v[60:63], v[44:47]
    s_waitcnt vmcnt(12) lgkmcnt(0)
    v_mfma_f32_16x16x32_bf16 v[16:19], v[132:135], v[64:67], v[16:19]
    ds_read_b128 v[48:51], v6 offset:8192
    v_mfma_f32_16x16x32_bf16 v[20:23], v[132:135], v[68:71], v[20:23]
    ds_read_b128 v[52:55], v6 offset:8448
    v_mfma_f32_16x16x32_bf16 v[24:27], v[132:135], v[72:75], v[24:27]
    ds_read_b128 v[56:59], v6 offset:8704
    v_mfma_f32_16x16x32_bf16 v[28:31], v[132:135], v[76:79], v[28:31]
    ds_read_b128 v[60:63], v6 offset:8960
    v_mfma_f32_16x16x32_bf16 v[32:35], v[84:87], v[64:67], v[32:35]
    ds_read_b128 v[80:83], v13 offset:3072
    v_mfma_f32_16x16x32_bf16 v[36:39], v[84:87], v[68:71], v[36:39]
    v_mfma_f32_16x16x32_bf16 v[40:43], v[84:87], v[72:75], v[40:43]
    v_mfma_f32_16x16x32_bf16 v[44:47], v[84:87], v[76:79], v[44:47]
    s_waitcnt vmcnt(10) lgkmcnt(0)
    v_mfma_f32_16x16x32_bf16 v[16:19], v[88:91], v[48:51], v[16:19]
    ds_read_b128 v[64:67], v6 offset:12288
    v_mfma_f32_16x16x32_bf16 v[20:23], v[88:91], v[52:55], v[20:23]
    ds_read_b128 v[68:71], v6 offset:12544
    v_mfma_f32_16x16x32_bf16 v[24:27], v[88:91], v[56:59], v[24:27]
    ds_read_b128 v[72:75], v6 offset:12800
    v_mfma_f32_16x16x32_bf16 v[28:31], v[88:91], v[60:63], v[28:31]
    ds_read_b128 v[76:79], v6 offset:13056
    v_mfma_f32_16x16x32_bf16 v[32:35], v[80:83], v[48:51], v[32:35]
    ds_read_b128 v[84:87], v13 offset:4096
    v_mfma_f32_16x16x32_bf16 v[36:39], v[80:83], v[52:55], v[36:39]
    buffer_load_dwordx4 v[120:123], v2, s[28:31], s23 offen offset:1024 sc1
    v_mfma_f32_16x16x32_bf16 v[40:43], v[80:83], v[56:59], v[40:43]
    buffer_load_dwordx4 v[124:127], v2, s[28:31], s23 offen offset:2048 sc1
    v_mfma_f32_16x16x32_bf16 v[44:47], v[80:83], v[60:63], v[44:47]
    s_waitcnt vmcnt(10) lgkmcnt(0)
    v_mfma_f32_16x16x32_bf16 v[16:19], v[92:95], v[64:67], v[16:19]
    ds_read_b128 v[48:51], v6 offset:16384
    v_mfma_f32_16x16x32_bf16 v[20:23], v[92:95], v[68:71], v[20:23]
    ds_read_b128 v[52:55], v6 offset:16640
    v_mfma_f32_16x16x32_bf16 v[24:27], v[92:95], v[72:75], v[24:27]
    ds_read_b128 v[56:59], v6 offset:16896
    v_mfma_f32_16x16x32_bf16 v[28:31], v[92:95], v[76:79], v[28:31]
    ds_read_b128 v[60:63], v6 offset:17152
    v_mfma_f32_16x16x32_bf16 v[32:35], v[84:87], v[64:67], v[32:35]
    ds_read_b128 v[80:83], v13 offset:5120
    v_mfma_f32_16x16x32_bf16 v[36:39], v[84:87], v[68:71], v[36:39]
    buffer_load_dwordx4 v[128:131], v2, s[28:31], s23 offen offset:3072 sc1
    v_mfma_f32_16x16x32_bf16 v[40:43], v[84:87], v[72:75], v[40:43]
    s_add_u32 s64, s23, 4096
    buffer_load_dwordx4 v[132:135], v2, s[28:31], s64 offen sc1
    v_mfma_f32_16x16x32_bf16 v[44:47], v[84:87], v[76:79], v[44:47]
    s_waitcnt vmcnt(10) lgkmcnt(0)
    v_mfma_f32_16x16x32_bf16 v[16:19], v[96:99], v[48:51], v[16:19]
    ds_read_b128 v[64:67], v6 offset:20480
    v_mfma_f32_16x16x32_bf16 v[20:23], v[96:99], v[52:55], v[20:23]
    ds_read_b128 v[68:71], v6 offset:20736
    v_mfma_f32_16x16x32_bf16 v[24:27], v[96:99], v[56:59], v[24:27]
    ds_read_b128 v[72:75], v6 offset:20992
    v_mfma_f32_16x16x32_bf16 v[28:31], v[96:99], v[60:63], v[28:31]
    ds_read_b128 v[76:79], v6 offset:21248
    v_mfma_f32_16x16x32_bf16 v[32:35], v[80:83], v[48:51], v[32:35]
    ds_read_b128 v[84:87], v13 offset:6144
    v_mfma_f32_16x16x32_bf16 v[36:39], v[80:83], v[52:55], v[36:39]
    v_mfma_f32_16x16x32_bf16 v[40:43], v[80:83], v[56:59], v[40:43]
    v_mfma_f32_16x16x32_bf16 v[44:47], v[80:83], v[60:63], v[44:47]
    s_waitcnt vmcnt(8) lgkmcnt(0)
    v_mfma_f32_16x16x32_bf16 v[16:19], v[100:103], v[64:67], v[16:19]
    ds_read_b128 v[48:51], v6 offset:24576
    v_mfma_f32_16x16x32_bf16 v[20:23], v[100:103], v[68:71], v[20:23]
    ds_read_b128 v[52:55], v6 offset:24832
    v_mfma_f32_16x16x32_bf16 v[24:27], v[100:103], v[72:75], v[24:27]
    ds_read_b128 v[56:59], v6 offset:25088
    v_mfma_f32_16x16x32_bf16 v[28:31], v[100:103], v[76:79], v[28:31]
    ds_read_b128 v[60:63], v6 offset:25344
    v_mfma_f32_16x16x32_bf16 v[32:35], v[84:87], v[64:67], v[32:35]
    ds_read_b128 v[80:83], v13 offset:7168
    v_mfma_f32_16x16x32_bf16 v[36:39], v[84:87], v[68:71], v[36:39]
    buffer_load_dwordx4 v[96:99], v2, s[28:31], s22 offen offset:0 sc1
    v_mfma_f32_16x16x32_bf16 v[40:43], v[84:87], v[72:75], v[40:43]
    v_mfma_f32_16x16x32_bf16 v[44:47], v[84:87], v[76:79], v[44:47]
    s_waitcnt vmcnt(7) lgkmcnt(0)
    v_mfma_f32_16x16x32_bf16 v[16:19], v[104:107], v[48:51], v[16:19]
    ds_read_b128 v[64:67], v6 offset:28672
    v_mfma_f32_16x16x32_bf16 v[20:23], v[104:107], v[52:55], v[20:23]
    ds_read_b128 v[68:71], v6 offset:28928
    v_mfma_f32_16x16x32_bf16 v[24:27], v[104:107], v[56:59], v[24:27]
    ds_read_b128 v[72:75], v6 offset:29184
    v_mfma_f32_16x16x32_bf16 v[28:31], v[104:107], v[60:63], v[28:31]
    ds_read_b128 v[76:79], v6 offset:29440
    v_mfma_f32_16x16x32_bf16 v[32:35], v[80:83], v[48:51], v[32:35]
    ds_read_b128 v[84:87], v13 offset:8192
    v_mfma_f32_16x16x32_bf16 v[36:39], v[80:83], v[52:55], v[36:39]
    buffer_load_dwordx4 v[100:103], v2, s[28:31], s22 offen offset:1024 sc1
    v_mfma_f32_16x16x32_bf16 v[40:43], v[80:83], v[56:59], v[40:43]
    v_mfma_f32_16x16x32_bf16 v[44:47], v[80:83], v[60:63], v[44:47]
    s_waitcnt vmcnt(7) lgkmcnt(0)
    v_mfma_f32_16x16x32_bf16 v[16:19], v[108:111], v[64:67], v[16:19]
    ds_read_b128 v[48:51], v6 offset:32768
    v_mfma_f32_16x16x32_bf16 v[20:23], v[108:111], v[68:71], v[20:23]
    ds_read_b128 v[52:55], v6 offset:33024
    v_mfma_f32_16x16x32_bf16 v[24:27], v[108:111], v[72:75], v[24:27]
    ds_read_b128 v[56:59], v6 offset:33280
    v_mfma_f32_16x16x32_bf16 v[28:31], v[108:111], v[76:79], v[28:31]
    ds_read_b128 v[60:63], v6 offset:33536
    v_mfma_f32_16x16x32_bf16 v[32:35], v[84:87], v[64:67], v[32:35]
    ds_read_b128 v[80:83], v13 offset:0
    v_mfma_f32_16x16x32_bf16 v[36:39], v[84:87], v[68:71], v[36:39]
    buffer_load_dwordx4 v[104:107], v2, s[28:31], s22 offen offset:2048 sc1
    v_mfma_f32_16x16x32_bf16 v[40:43], v[84:87], v[72:75], v[40:43]
    v_mfma_f32_16x16x32_bf16 v[44:47], v[84:87], v[76:79], v[44:47]
    s_waitcnt vmcnt(7) lgkmcnt(0)
    v_mfma_f32_16x16x32_bf16 v[16:19], v[112:115], v[48:51], v[16:19]
    ds_read_b128 v[64:67], v6 offset:36864
    v_mfma_f32_16x16x32_bf16 v[20:23], v[112:115], v[52:55], v[20:23]
    ds_read_b128 v[68:71], v6 offset:37120
    v_mfma_f32_16x16x32_bf16 v[24:27], v[112:115], v[56:59], v[24:27]
    ds_read_b128 v[72:75], v6 offset:37376
    v_mfma_f32_16x16x32_bf16 v[28:31], v[112:115], v[60:63], v[28:31]
    ds_read_b128 v[76:79], v6 offset:37632
    v_mfma_f32_16x16x32_bf16 v[32:35], v[80:83], v[48:51], v[32:35]
    ds_read_b128 v[84:87], v13 offset:1024
    v_mfma_f32_16x16x32_bf16 v[36:39], v[80:83], v[52:55], v[36:39]
    buffer_load_dwordx4 v[108:111], v2, s[28:31], s22 offen offset:3072 sc1
    v_mfma_f32_16x16x32_bf16 v[40:43], v[80:83], v[56:59], v[40:43]
    v_mfma_f32_16x16x32_bf16 v[44:47], v[80:83], v[60:63], v[44:47]
    s_waitcnt lgkmcnt(0)
    v_mfma_f32_16x16x32_bf16 v[16:19], v[116:119], v[64:67], v[16:19]
    s_lshl_b32 s6, s3, 7
    v_lshl_add_u32 v7, v9, 4, s6
    ds_read_b128 v[48:51], v7 offset:19456
    ds_read_b128 v[52:55], v7 offset:19520
    v_mfma_f32_16x16x32_bf16 v[20:23], v[116:119], v[68:71], v[20:23]
    v_lshlrev_b32 v7, 2, v8
    ds_read_b32 v60, v7 offset:9472
    ds_read_b32 v61, v7 offset:9536
    ds_read_b32 v62, v7 offset:9600
    ds_read_b32 v63, v7 offset:9664
    ds_read_b32 v56, v7 offset:9216
    ds_read_b32 v57, v7 offset:9280
    ds_read_b32 v58, v7 offset:9344
    ds_read_b32 v59, v7 offset:9408
    v_mfma_f32_16x16x32_bf16 v[24:27], v[116:119], v[72:75], v[24:27]
    v_mfma_f32_16x16x32_bf16 v[28:31], v[116:119], v[76:79], v[28:31]
    v_mfma_f32_16x16x32_bf16 v[32:35], v[84:87], v[64:67], v[32:35]
    v_mfma_f32_16x16x32_bf16 v[36:39], v[84:87], v[68:71], v[36:39]
    v_mfma_f32_16x16x32_bf16 v[40:43], v[84:87], v[72:75], v[40:43]
    v_mfma_f32_16x16x32_bf16 v[44:47], v[84:87], v[76:79], v[44:47]
    s_setprio 3
    s_lshl_b32 s65, s42, 11
    s_add_u32 s65, s65, s49
    s_add_u32 s65, s65, 0x16e0000
    s_mov_b32 s61, 0
Lsw_91:
    s_waitcnt lgkmcnt(0)
    v_min_u32 v7, v60, v61
    v_min3_u32 v7, v7, v62, v63
    v_cmp_eq_u32 vcc, 0, v7
    s_cbranch_vccz Lsd_92
    s_sleep 1
    v_lshlrev_b32 v7, 2, v8
    ds_read_b32 v60, v7 offset:9472
    ds_read_b32 v61, v7 offset:9536
    ds_read_b32 v62, v7 offset:9600
    ds_read_b32 v63, v7 offset:9664
    ds_read_b32 v56, v7 offset:9216
    ds_read_b32 v57, v7 offset:9280
    ds_read_b32 v58, v7 offset:9344
    ds_read_b32 v59, v7 offset:9408
    s_add_u32 s61, s61, 1
    s_cmp_lt_u32 s61, 200000
    s_cbranch_scc1 Lsw_91
    s_waitcnt lgkmcnt(0)
Lsd_92:
    v_lshlrev_b32 v7, 10, v4
    v_lshl_add_u32 v7, v10, 4, v7
    v_fma_f32 v16, -v56, v48, v16
    v_fma_f32 v17, -v56, v49, v17
    v_fma_f32 v18, -v56, v50, v18
    v_fma_f32 v19, -v56, v51, v19
    v_fma_f32 v20, -v57, v48, v20
    v_fma_f32 v21, -v57, v49, v21
    v_fma_f32 v22, -v57, v50, v22
    v_fma_f32 v23, -v57, v51, v23
    v_mul_f32 v16, v16, v60
    v_mul_f32 v17, v17, v60
    v_mul_f32 v18, v18, v60
    v_mul_f32 v19, v19, v60
    v_mul_f32 v20, v20, v61
    v_mul_f32 v21, v21, v61
    v_mul_f32 v22, v22, v61
    v_mul_f32 v23, v23, v61
    v_cvt_pk_bf16_f32 v16, v16, v17
    v_cvt_pk_bf16_f32 v17, v18, v19
    v_cvt_pk_bf16_f32 v18, v20, v21
    v_cvt_pk_bf16_f32 v19, v22, v23
    v_pk_max_i16 v16, v16, 0
    v_pk_max_i16 v17, v17, 0
    v_pk_max_i16 v18, v18, 0
    v_pk_max_i16 v19, v19, 0
    s_nop 0
    v_permlane16_swap_b32 v16, v18
    v_permlane16_swap_b32 v17, v19
    buffer_store_dwordx4 v[16:19], v7, s[28:31], s65 offen offset:0 sc1
    v_fma_f32 v24, -v58, v48, v24
    v_fma_f32 v25, -v58, v49, v25
    v_fma_f32 v26, -v58, v50, v26
    v_fma_f32 v27, -v58, v51, v27
    v_fma_f32 v28, -v59, v48, v28
    v_fma_f32 v29, -v59, v49, v29
    v_fma_f32 v30, -v59, v50, v30
    v_fma_f32 v31, -v59, v51, v31
    v_mul_f32 v24, v24, v62
    v_mul_f32 v25, v25, v62
    v_mul_f32 v26, v26, v62
    v_mul_f32 v27, v27, v62
    v_mul_f32 v28, v28, v63
    v_mul_f32 v29, v29, v63
    v_mul_f32 v30, v30, v63
    v_mul_f32 v31, v31, v63
    v_cvt_pk_bf16_f32 v24, v24, v25
    v_cvt_pk_bf16_f32 v25, v26, v27
    v_cvt_pk_bf16_f32 v26, v28, v29
    v_cvt_pk_bf16_f32 v27, v30, v31
    v_pk_max_i16 v24, v24, 0
    v_pk_max_i16 v25, v25, 0
    v_pk_max_i16 v26, v26, 0
    v_pk_max_i16 v27, v27, 0
    s_nop 0
    v_permlane16_swap_b32 v24, v26
    v_permlane16_swap_b32 v25, v27
    buffer_store_dwordx4 v[24:27], v7, s[28:31], s65 offen offset:512 sc1
    v_fma_f32 v32, -v56, v52, v32
    v_fma_f32 v33, -v56, v53, v33
    v_fma_f32 v34, -v56, v54, v34
    v_fma_f32 v35, -v56, v55, v35
    v_fma_f32 v36, -v57, v52, v36
    v_fma_f32 v37, -v57, v53, v37
    v_fma_f32 v38, -v57, v54, v38
    v_fma_f32 v39, -v57, v55, v39
    v_mul_f32 v32, v32, v60
    v_mul_f32 v33, v33, v60
    v_mul_f32 v34, v34, v60
    v_mul_f32 v35, v35, v60
    v_mul_f32 v36, v36, v61
    v_mul_f32 v37, v37, v61
    v_mul_f32 v38, v38, v61
    v_mul_f32 v39, v39, v61
    v_cvt_pk_bf16_f32 v32, v32, v33
    v_cvt_pk_bf16_f32 v33, v34, v35
    v_cvt_pk_bf16_f32 v34, v36, v37
    v_cvt_pk_bf16_f32 v35, v38, v39
    v_pk_max_i16 v32, v32, 0
    v_pk_max_i16 v33, v33, 0
    v_pk_max_i16 v34, v34, 0
    v_pk_max_i16 v35, v35, 0
    s_nop 0
    v_permlane16_swap_b32 v32, v34
    v_permlane16_swap_b32 v33, v35
    buffer_store_dwordx4 v[32:35], v7, s[28:31], s65 offen offset:2048 sc1
    v_fma_f32 v40, -v58, v52, v40
    v_fma_f32 v41, -v58, v53, v41
    v_fma_f32 v42, -v58, v54, v42
    v_fma_f32 v43, -v58, v55, v43
    v_fma_f32 v44, -v59, v52, v44
    v_fma_f32 v45, -v59, v53, v45
    v_fma_f32 v46, -v59, v54, v46
    v_fma_f32 v47, -v59, v55, v47
    v_mul_f32 v40, v40, v62
    v_mul_f32 v41, v41, v62
    v_mul_f32 v42, v42, v62
    v_mul_f32 v43, v43, v62
    v_mul_f32 v44, v44, v63
    v_mul_f32 v45, v45, v63
    v_mul_f32 v46, v46, v63
    v_mul_f32 v47, v47, v63
    v_cvt_pk_bf16_f32 v40, v40, v41
    v_cvt_pk_bf16_f32 v41, v42, v43
    v_cvt_pk_bf16_f32 v42, v44, v45
    v_cvt_pk_bf16_f32 v43, v46, v47
    v_pk_max_i16 v40, v40, 0
    v_pk_max_i16 v41, v41, 0
    v_pk_max_i16 v42, v42, 0
    v_pk_max_i16 v43, v43, 0
    s_nop 0
    v_permlane16_swap_b32 v40, v42
    v_permlane16_swap_b32 v41, v43
    buffer_store_dwordx4 v[40:43], v7, s[28:31], s65 offen offset:2560 sc1
    v_mov_b32 v7, 9732
    v_mov_b32 v0, 1
    s_mov_b64 exec, 1
    ds_add_u32 v7, v0
    s_mov_b64 exec, -1
    s_add_u32 s64, s22, 4096
    buffer_load_dwordx4 v[112:115], v2, s[28:31], s64 offen sc1
    buffer_load_dwordx4 v[116:119], v2, s[28:31], s23 offen offset:0 sc1
    s_waitcnt vmcnt(2)
    s_add_u32 s62, s41, 9
    v_mov_b32 v0, s62
    v_writelane_b32 v0, s27, 1
    v_lshlrev_b32 v12, 2, v1
    s_mov_b32 exec_hi, 0
    s_add_u32 s62, s45, 0x80000
    buffer_store_dword v0, v12, s[28:31], s62 offen
    s_cmp_eq_u32 s26, 0
    s_cbranch_scc1 Lng_93
    buffer_store_dword v0, v12, s[28:31], s45 offen sc1
Lng_93:
    s_mov_b32 exec_hi, -1
    s_setprio 1
    s_lshl_b32 s7, s3, 7
    s_lshl_b32 s67, s4, 13
    s_cmp_eq_u32 s26, 0
    s_cselect_b32 s6, 0x80000, 0
    s_add_u32 s67, s67, s6
    s_add_u32 s67, s67, s7
    v_min_u32 v11, 7, v1
    v_lshlrev_b32 v11, 10, v11
    s_add_u32 s60, s67, 0x760000
    buffer_load_dword v11, v11, s[28:31], s60 offen sc1
    s_add_u32 s59, s41, 9
    s_waitcnt vmcnt(0)
    s_mov_b32 s61, 0
Lpoll_94:
    v_subrev_u32 v11, s59, v11
    v_cmp_le_u32 vcc, 16, v11
    s_cbranch_vccz Lpd_95
    s_sleep 2
    v_min_u32 v11, 7, v1
    v_lshlrev_b32 v11, 10, v11
    s_add_u32 s60, s67, 0x760000
    buffer_load_dword v11, v11, s[28:31], s60 offen sc1
    s_waitcnt vmcnt(0)
    s_add_u32 s61, s61, 1
    s_cmp_lt_u32 s61, 200000
    s_cbranch_scc1 Lpoll_94
Lpd_95:
    v_add_u32 v12, 0x16e0000, v3
    v_add_u32 v13, s69, v2
    v_add_u32 v11, 81920, v13
    buffer_load_dwordx4 v[56:59], v12, s[28:31], s8 offen offset:0 sc1
    buffer_load_dwordx4 v[60:63], v12, s[28:31], s9 offen offset:0 sc1
    buffer_load_dwordx4 v[64:67], v12, s[28:31], s10 offen offset:0 sc1
    buffer_load_dwordx4 v[68:71], v12, s[28:31], s11 offen offset:0 sc1
    buffer_load_dwordx4 v[72:75], v12, s[28:31], s12 offen offset:0 sc1
    buffer_load_dwordx4 v[76:79], v12, s[28:31], s13 offen offset:0 sc1
    buffer_load_dwordx4 v[80:83], v12, s[28:31], s14 offen offset:0 sc1
    buffer_load_dwordx4 v[84:87], v12, s[28:31], s15 offen offset:0 sc1
    buffer_load_dwordx4 v[88:91], v12, s[28:31], s8 offen offset:256 sc1
    buffer_load_dwordx4 v[92:95], v12, s[28:31], s9 offen offset:256 sc1
    s_setprio 1
    s_waitcnt vmcnt(9)
    v_mfma_f32_16x16x32_bf16 v[16:19], v[136:139], v[56:59], 0
    s_add_u32 m0, s69, 0
    s_add_u32 s64, s10, 256
    buffer_load_dwordx4 v12, s[28:31], s64 offen sc1 lds
    v_mfma_f32_16x16x32_bf16 v[20:23], v[140:143], v[56:59], 0
    s_add_u32 m0, s69, 1024
    s_add_u32 s64, s11, 256
    buffer_load_dwordx4 v12, s[28:31], s64 offen sc1 lds
    v_mfma_f32_16x16x32_bf16 v[24:27], v[144:147], v[56:59], 0
    v_mfma_f32_16x16x32_bf16 v[28:31], v[148:151], v[56:59], 0
    v_mfma_f32_16x16x32_bf16 v[32:35], v[152:155], v[56:59], 0
    s_waitcnt vmcnt(10)
    v_mfma_f32_16x16x32_bf16 v[16:19], v[156:159], v[60:63], v[16:19]
    s_add_u32 m0, s69, 2048
    s_add_u32 s64, s12, 256
    buffer_load_dwordx4 v12, s[28:31], s64 offen sc1 lds
    v_mfma_f32_16x16x32_bf16 v[20:23], v[160:163], v[60:63], v[20:23]
    s_add_u32 m0, s69, 3072
    s_add_u32 s64, s13, 256
    buffer_load_dwordx4 v12, s[28:31], s64 offen sc1 lds
    v_mfma_f32_16x16x32_bf16 v[24:27], v[164:167], v[60:63], v[24:27]
    buffer_load_dwordx4 v[56:59], v12, s[28:31], s11 offen offset:512 sc1
    v_mfma_f32_16x16x32_bf16 v[28:31], v[168:171], v[60:63], v[28:31]
    v_mfma_f32_16x16x32_bf16 v[32:35], v[172:175], v[60:63], v[32:35]
    s_waitcnt vmcnt(12)
    v_mfma_f32_16x16x32_bf16 v[16:19], v[176:179], v[64:67], v[16:19]
    s_add_u32 m0, s69, 4096
    s_add_u32 s64, s14, 256
    buffer_load_dwordx4 v12, s[28:31], s64 offen sc1 lds
    v_mfma_f32_16x16x32_bf16 v[20:23], v[180:183], v[64:67], v[20:23]
    s_add_u32 m0, s69, 5120
    s_add_u32 s64, s15, 256
    buffer_load_dwordx4 v12, s[28:31], s64 offen sc1 lds
    v_mfma_f32_16x16x32_bf16 v[24:27], v[184:187], v[64:67], v[24:27]
    buffer_load_dwordx4 v[60:63], v12, s[28:31], s12 offen offset:512 sc1
    v_mfma_f32_16x16x32_bf16 v[28:31], v[188:191], v[64:67], v[28:31]
    v_mfma_f32_16x16x32_bf16 v[32:35], v[192:195], v[64:67], v[32:35]
    s_waitcnt vmcnt(14)
    v_mfma_f32_16x16x32_bf16 v[16:19], v[196:199], v[68:71], v[16:19]
    s_add_u32 m0, s69, 6144
    s_add_u32 s64, s8, 512
    buffer_load_dwordx4 v12, s[28:31], s64 offen sc1 lds
    v_mfma_f32_16x16x32_bf16 v[20:23], v[200:203], v[68:71], v[20:23]
    s_add_u32 m0, s69, 7168
    s_add_u32 s64, s9, 512
    buffer_load_dwordx4 v12, s[28:31], s64 offen sc1 lds
    v_mfma_f32_16x16x32_bf16 v[24:27], v[204:207], v[68:71], v[24:27]
    buffer_load_dwordx4 v[64:67], v12, s[28:31], s13 offen offset:512 sc1
    v_mfma_f32_16x16x32_bf16 v[28:31], v[208:211], v[68:71], v[28:31]
    v_mfma_f32_16x16x32_bf16 v[32:35], v[212:215], v[68:71], v[32:35]
    s_waitcnt vmcnt(16)
    v_mfma_f32_16x16x32_bf16 v[16:19], v[216:219], v[72:75], v[16:19]
    s_add_u32 m0, s69, 8192
    s_add_u32 s64, s10, 512
    buffer_load_dwordx4 v12, s[28:31], s64 offen sc1 lds
    v_mfma_f32_16x16x32_bf16 v[20:23], v[220:223], v[72:75], v[20:23]
    buffer_load_dwordx4 v[68:71], v12, s[28:31], s14 offen offset:512 sc1
    v_mfma_f32_16x16x32_bf16 v[24:27], v[224:227], v[72:75], v[24:27]
    v_mfma_f32_16x16x32_bf16 v[28:31], v[228:231], v[72:75], v[28:31]
    v_mfma_f32_16x16x32_bf16 v[32:35], v[232:235], v[72:75], v[32:35]
    s_waitcnt vmcnt(17)
    v_mfma_f32_16x16x32_bf16 v[16:19], v[236:239], v[76:79], v[16:19]
    buffer_load_dwordx4 v[72:75], v12, s[28:31], s15 offen offset:512 sc1
    v_mfma_f32_16x16x32_bf16 v[20:23], v[240:243], v[76:79], v[20:23]
    v_mfma_f32_16x16x32_bf16 v[24:27], v[244:247], v[76:79], v[24:27]
    v_mfma_f32_16x16x32_bf16 v[28:31], v[248:251], v[76:79], v[28:31]
    v_mfma_f32_16x16x32_bf16 v[32:35], v[252:255], v[76:79], v[32:35]
    s_waitcnt vmcnt(17)
    v_mfma_f32_16x16x32_bf16 v[16:19], v[96:99], v[80:83], v[16:19]
    buffer_load_dwordx4 v[76:79], v12, s[28:31], s8 offen offset:768 sc1
    v_mfma_f32_16x16x32_bf16 v[20:23], v[100:103], v[80:83], v[20:23]
    v_mfma_f32_16x16x32_bf16 v[24:27], v[104:107], v[80:83], v[24:27]
    v_mfma_f32_16x16x32_bf16 v[28:31], v[108:111], v[80:83], v[28:31]
    v_mfma_f32_16x16x32_bf16 v[32:35], v[112:115], v[80:83], v[32:35]
    s_waitcnt vmcnt(14)
    v_mfma_f32_16x16x32_bf16 v[16:19], v[116:119], v[84:87], v[16:19]
    ds_read_b128 v[80:83], v13 offset:0
    v_mfma_f32_16x16x32_bf16 v[20:23], v[120:123], v[84:87], v[20:23]
    v_mfma_f32_16x16x32_bf16 v[24:27], v[124:127], v[84:87], v[24:27]
    v_mfma_f32_16x16x32_bf16 v[28:31], v[128:131], v[84:87], v[28:31]
    v_mfma_f32_16x16x32_bf16 v[32:35], v[132:135], v[84:87], v[32:35]
    s_waitcnt vmcnt(13)
    v_mfma_f32_16x16x32_bf16 v[36:39], v[136:139], v[88:91], 0
    ds_read_b128 v[84:87], v13 offset:1024
    v_mfma_f32_16x16x32_bf16 v[40:43], v[140:143], v[88:91], 0
    v_mov_b32 v7, 9732
    ds_read_b32 v7, v7
    v_mfma_f32_16x16x32_bf16 v[44:47], v[144:147], v[88:91], 0
    v_mfma_f32_16x16x32_bf16 v[48:51], v[148:151], v[88:91], 0
    v_mfma_f32_16x16x32_bf16 v[52:55], v[152:155], v[88:91], 0
    s_waitcnt lgkmcnt(0)
    v_cmp_gt_u32 vcc, 8, v7
    s_cbranch_vccz Lcd_97
    s_mov_b32 s61, 0
Lcw_96:
    v_mov_b32 v7, 9732
    ds_read_b32 v7, v7
    s_waitcnt lgkmcnt(0)
    v_cmp_gt_u32 vcc, 8, v7
    s_cbranch_vccz Lcd_97
    s_sleep 1
    s_add_u32 s61, s61, 1
    s_cmp_lt_u32 s61, 200000
    s_cbranch_scc1 Lcw_96
Lcd_97:
    v_mov_b32 v7, 9732
    v_mov_b32 v0, 1
    s_mov_b64 exec, 1
    ds_add_u32 v7, v0
    s_mov_b64 exec, -1
    s_waitcnt vmcnt(12)
    v_mfma_f32_16x16x32_bf16 v[36:39], v[156:159], v[92:95], v[36:39]
    ds_read_b128 v[88:91], v13 offset:2048
    v_mfma_f32_16x16x32_bf16 v[40:43], v[160:163], v[92:95], v[40:43]
    ds_write_b128 v11, v[16:19] offset:0
    v_mfma_f32_16x16x32_bf16 v[44:47], v[164:167], v[92:95], v[44:47]
    ds_write_b128 v11, v[20:23] offset:1024
    v_mfma_f32_16x16x32_bf16 v[48:51], v[168:171], v[92:95], v[48:51]
    v_mfma_f32_16x16x32_bf16 v[52:55], v[172:175], v[92:95], v[52:55]
    s_waitcnt vmcnt(11)
    v_mfma_f32_16x16x32_bf16 v[36:39], v[176:179], v[80:83], v[36:39]
    ds_read_b128 v[92:95], v13 offset:3072
    v_mfma_f32_16x16x32_bf16 v[40:43], v[180:183], v[80:83], v[40:43]
    ds_write_b128 v11, v[24:27] offset:2048
    v_mfma_f32_16x16x32_bf16 v[44:47], v[184:187], v[80:83], v[44:47]
    ds_write_b128 v11, v[28:31] offset:3072
    v_mfma_f32_16x16x32_bf16 v[48:51], v[188:191], v[80:83], v[48:51]
    v_mfma_f32_16x16x32_bf16 v[52:55], v[192:195], v[80:83], v[52:55]
    s_waitcnt vmcnt(9)
    v_mfma_f32_16x16x32_bf16 v[36:39], v[196:199], v[84:87], v[36:39]
    ds_read_b128 v[80:83], v13 offset:4096
    v_mfma_f32_16x16x32_bf16 v[40:43], v[200:203], v[84:87], v[40:43]
    ds_write_b128 v11, v[32:35] offset:4096
    v_mfma_f32_16x16x32_bf16 v[44:47], v[204:207], v[84:87], v[44:47]
    v_mfma_f32_16x16x32_bf16 v[48:51], v[208:211], v[84:87], v[48:51]
    v_mfma_f32_16x16x32_bf16 v[52:55], v[212:215], v[84:87], v[52:55]
    s_waitcnt vmcnt(8) lgkmcnt(7)
    v_mfma_f32_16x16x32_bf16 v[36:39], v[216:219], v[88:91], v[36:39]
    ds_read_b128 v[84:87], v13 offset:5120
    v_mfma_f32_16x16x32_bf16 v[40:43], v[220:223], v[88:91], v[40:43]
    v_mfma_f32_16x16x32_bf16 v[44:47], v[224:227], v[88:91], v[44:47]
    v_mfma_f32_16x16x32_bf16 v[48:51], v[228:231], v[88:91], v[48:51]
    v_mfma_f32_16x16x32_bf16 v[52:55], v[232:235], v[88:91], v[52:55]
    s_waitcnt vmcnt(6) lgkmcnt(5)
    v_mfma_f32_16x16x32_bf16 v[36:39], v[236:239], v[92:95], v[36:39]
    ds_read_b128 v[88:91], v13 offset:6144
    v_mfma_f32_16x16x32_bf16 v[40:43], v[240:243], v[92:95], v[40:43]
    v_mfma_f32_16x16x32_bf16 v[44:47], v[244:247], v[92:95], v[44:47]
    v_mfma_f32_16x16x32_bf16 v[48:51], v[248:251], v[92:95], v[48:51]
    v_mfma_f32_16x16x32_bf16 v[52:55], v[252:255], v[92:95], v[52:55]
    s_waitcnt vmcnt(5) lgkmcnt(3)
    v_mfma_f32_16x16x32_bf16 v[36:39], v[96:99], v[80:83], v[36:39]
    ds_read_b128 v[92:95], v13 offset:7168
    v_mfma_f32_16x16x32_bf16 v[40:43], v[100:103], v[80:83], v[40:43]
    v_mfma_f32_16x16x32_bf16 v[44:47], v[104:107], v[80:83], v[44:47]
    v_mfma_f32_16x16x32_bf16 v[48:51], v[108:111], v[80:83], v[48:51]
    v_mfma_f32_16x16x32_bf16 v[52:55], v[112:115], v[80:83], v[52:55]
    s_waitcnt vmcnt(3) lgkmcnt(2)
    v_mfma_f32_16x16x32_bf16 v[36:39], v[116:119], v[84:87], v[36:39]
    ds_read_b128 v[80:83], v13 offset:8192
    v_mfma_f32_16x16x32_bf16 v[40:43], v[120:123], v[84:87], v[40:43]
    v_mfma_f32_16x16x32_bf16 v[44:47], v[124:127], v[84:87], v[44:47]
    v_mfma_f32_16x16x32_bf16 v[48:51], v[128:131], v[84:87], v[48:51]
    v_mfma_f32_16x16x32_bf16 v[52:55], v[132:135], v[84:87], v[52:55]
    s_waitcnt lgkmcnt(2)
    v_mfma_f32_16x16x32_bf16 v[16:19], v[136:139], v[88:91], 0
    buffer_load_dwordx4 v[84:87], v12, s[28:31], s9 offen offset:768 sc1
    v_mfma_f32_16x16x32_bf16 v[20:23], v[140:143], v[88:91], 0
    v_mfma_f32_16x16x32_bf16 v[24:27], v[144:147], v[88:91], 0
    v_mfma_f32_16x16x32_bf16 v[28:31], v[148:151], v[88:91], 0
    v_mfma_f32_16x16x32_bf16 v[32:35], v[152:155], v[88:91], 0
    s_waitcnt lgkmcnt(1)
    v_mfma_f32_16x16x32_bf16 v[16:19], v[156:159], v[92:95], v[16:19]
    buffer_load_dwordx4 v[88:91], v12, s[28:31], s10 offen offset:768 sc1
    v_mfma_f32_16x16x32_bf16 v[20:23], v[160:163], v[92:95], v[20:23]
    ds_write_b128 v11, v[36:39] offset:5120
    v_mfma_f32_16x16x32_bf16 v[24:27], v[164:167], v[92:95], v[24:27]
    ds_write_b128 v11, v[40:43] offset:6144
    v_mfma_f32_16x16x32_bf16 v[28:31], v[168:171], v[92:95], v[28:31]
    v_mfma_f32_16x16x32_bf16 v[32:35], v[172:175], v[92:95], v[32:35]
    s_waitcnt lgkmcnt(2)
    v_mfma_f32_16x16x32_bf16 v[16:19], v[176:179], v[80:83], v[16:19]
    buffer_load_dwordx4 v[92:95], v12, s[28:31], s11 offen offset:768 sc1
    v_mfma_f32_16x16x32_bf16 v[20:23], v[180:183], v[80:83], v[20:23]
    ds_write_b128 v11, v[44:47] offset:7168
    v_mfma_f32_16x16x32_bf16 v[24:27], v[184:187], v[80:83], v[24:27]
    ds_write_b128 v11, v[48:51] offset:8192
    v_mfma_f32_16x16x32_bf16 v[28:31], v[188:191], v[80:83], v[28:31]
    v_mfma_f32_16x16x32_bf16 v[32:35], v[192:195], v[80:83], v[32:35]
    v_mfma_f32_16x16x32_bf16 v[16:19], v[196:199], v[56:59], v[16:19]
    buffer_load_dwordx4 v[80:83], v12, s[28:31], s12 offen offset:768 sc1
    v_mfma_f32_16x16x32_bf16 v[20:23], v[200:203], v[56:59], v[20:23]
    ds_write_b128 v11, v[52:55] offset:9216
    v_mfma_f32_16x16x32_bf16 v[24:27], v[204:207], v[56:59], v[24:27]
    v_mfma_f32_16x16x32_bf16 v[28:31], v[208:211], v[56:59], v[28:31]
    v_mfma_f32_16x16x32_bf16 v[32:35], v[212:215], v[56:59], v[32:35]
    v_mfma_f32_16x16x32_bf16 v[16:19], v[216:219], v[60:63], v[16:19]
    buffer_load_dwordx4 v[56:59], v12, s[28:31], s13 offen offset:768 sc1
    v_mfma_f32_16x16x32_bf16 v[20:23], v[220:223], v[60:63], v[20:23]
    v_mfma_f32_16x16x32_bf16 v[24:27], v[224:227], v[60:63], v[24:27]
    v_mfma_f32_16x16x32_bf16 v[28:31], v[228:231], v[60:63], v[28:31]
    v_mfma_f32_16x16x32_bf16 v[32:35], v[232:235], v[60:63], v[32:35]
    v_mfma_f32_16x16x32_bf16 v[16:19], v[236:239], v[64:67], v[16:19]
    buffer_load_dwordx4 v[60:63], v12, s[28:31], s14 offen offset:768 sc1
    v_mfma_f32_16x16x32_bf16 v[20:23], v[240:243], v[64:67], v[20:23]
    v_mfma_f32_16x16x32_bf16 v[24:27], v[244:247], v[64:67], v[24:27]
    v_mfma_f32_16x16x32_bf16 v[28:31], v[248:251], v[64:67], v[28:31]
    v_mfma_f32_16x16x32_bf16 v[32:35], v[252:255], v[64:67], v[32:35]
    s_waitcnt vmcnt(8)
    v_mfma_f32_16x16x32_bf16 v[16:19], v[96:99], v[68:71], v[16:19]
    buffer_load_dwordx4 v[64:67], v12, s[28:31], s15 offen offset:768 sc1
    v_mfma_f32_16x16x32_bf16 v[20:23], v[100:103], v[68:71], v[20:23]
    v_mfma_f32_16x16x32_bf16 v[24:27], v[104:107], v[68:71], v[24:27]
    v_mfma_f32_16x16x32_bf16 v[28:31], v[108:111], v[68:71], v[28:31]
    v_mfma_f32_16x16x32_bf16 v[32:35], v[112:115], v[68:71], v[32:35]
    s_waitcnt vmcnt(8)
    v_mfma_f32_16x16x32_bf16 v[16:19], v[116:119], v[72:75], v[16:19]
    v_mfma_f32_16x16x32_bf16 v[20:23], v[120:123], v[72:75], v[20:23]
    v_mfma_f32_16x16x32_bf16 v[24:27], v[124:127], v[72:75], v[24:27]
    v_mfma_f32_16x16x32_bf16 v[28:31], v[128:131], v[72:75], v[28:31]
    v_mfma_f32_16x16x32_bf16 v[32:35], v[132:135], v[72:75], v[32:35]
    s_waitcnt vmcnt(7) lgkmcnt(0)
    v_mfma_f32_16x16x32_bf16 v[36:39], v[136:139], v[76:79], 0
    v_mfma_f32_16x16x32_bf16 v[40:43], v[140:143], v[76:79], 0
    v_mfma_f32_16x16x32_bf16 v[44:47], v[144:147], v[76:79], 0
    v_mfma_f32_16x16x32_bf16 v[48:51], v[148:151], v[76:79], 0
    v_mfma_f32_16x16x32_bf16 v[52:55], v[152:155], v[76:79], 0
    s_waitcnt vmcnt(6)
    v_mfma_f32_16x16x32_bf16 v[36:39], v[156:159], v[84:87], v[36:39]
    ds_write_b128 v13, v[16:19] offset:0
    v_mfma_f32_16x16x32_bf16 v[40:43], v[160:163], v[84:87], v[40:43]
    ds_write_b128 v13, v[20:23] offset:1024
    v_mfma_f32_16x16x32_bf16 v[44:47], v[164:167], v[84:87], v[44:47]
    v_mfma_f32_16x16x32_bf16 v[48:51], v[168:171], v[84:87], v[48:51]
    v_mfma_f32_16x16x32_bf16 v[52:55], v[172:175], v[84:87], v[52:55]
    s_waitcnt vmcnt(5)
    v_mfma_f32_16x16x32_bf16 v[36:39], v[176:179], v[88:91], v[36:39]
    ds_write_b128 v13, v[24:27] offset:2048
    v_mfma_f32_16x16x32_bf16 v[40:43], v[180:183], v[88:91], v[40:43]
    ds_write_b128 v13, v[28:31] offset:3072
    v_mfma_f32_16x16x32_bf16 v[44:47], v[184:187], v[88:91], v[44:47]
    v_mfma_f32_16x16x32_bf16 v[48:51], v[188:191], v[88:91], v[48:51]
    v_mfma_f32_16x16x32_bf16 v[52:55], v[192:195], v[88:91], v[52:55]
    s_waitcnt vmcnt(4)
    v_mfma_f32_16x16x32_bf16 v[36:39], v[196:199], v[92:95], v[36:39]
    ds_write_b128 v13, v[32:35] offset:4096
    v_mfma_f32_16x16x32_bf16 v[40:43], v[200:203], v[92:95], v[40:43]
    v_mfma_f32_16x16x32_bf16 v[44:47], v[204:207], v[92:95], v[44:47]
    v_mfma_f32_16x16x32_bf16 v[48:51], v[208:211], v[92:95], v[48:51]
    v_mfma_f32_16x16x32_bf16 v[52:55], v[212:215], v[92:95], v[52:55]
    s_waitcnt vmcnt(3)
    v_mfma_f32_16x16x32_bf16 v[36:39], v[216:219], v[80:83], v[36:39]
    v_mfma_f32_16x16x32_bf16 v[40:43], v[220:223], v[80:83], v[40:43]
    v_mfma_f32_16x16x32_bf16 v[44:47], v[224:227], v[80:83], v[44:47]
    v_mfma_f32_16x16x32_bf16 v[48:51], v[228:231], v[80:83], v[48:51]
    v_mfma_f32_16x16x32_bf16 v[52:55], v[232:235], v[80:83], v[52:55]
    s_waitcnt vmcnt(2)
    v_mfma_f32_16x16x32_bf16 v[36:39], v[236:239], v[56:59], v[36:39]
    v_mfma_f32_16x16x32_bf16 v[40:43], v[240:243], v[56:59], v[40:43]
    v_mfma_f32_16x16x32_bf16 v[44:47], v[244:247], v[56:59], v[44:47]
    v_mfma_f32_16x16x32_bf16 v[48:51], v[248:251], v[56:59], v[48:51]
    v_mfma_f32_16x16x32_bf16 v[52:55], v[252:255], v[56:59], v[52:55]
    s_waitcnt vmcnt(1)
    v_mfma_f32_16x16x32_bf16 v[36:39], v[96:99], v[60:63], v[36:39]
    v_mfma_f32_16x16x32_bf16 v[40:43], v[100:103], v[60:63], v[40:43]
    v_mfma_f32_16x16x32_bf16 v[44:47], v[104:107], v[60:63], v[44:47]
    v_mfma_f32_16x16x32_bf16 v[48:51], v[108:111], v[60:63], v[48:51]
    v_mfma_f32_16x16x32_bf16 v[52:55], v[112:115], v[60:63], v[52:55]
    s_waitcnt vmcnt(0)
    v_mfma_f32_16x16x32_bf16 v[36:39], v[116:119], v[64:67], v[36:39]
    v_mfma_f32_16x16x32_bf16 v[40:43], v[120:123], v[64:67], v[40:43]
    v_mfma_f32_16x16x32_bf16 v[44:47], v[124:127], v[64:67], v[44:47]
    v_mfma_f32_16x16x32_bf16 v[48:51], v[128:131], v[64:67], v[48:51]
    v_mfma_f32_16x16x32_bf16 v[52:55], v[132:135], v[64:67], v[52:55]
    s_setprio 3
    s_nop 2
    ds_write_b128 v13, v[36:39] offset:5120
    ds_write_b128 v13, v[40:43] offset:6144
    ds_write_b128 v13, v[44:47] offset:7168
    ds_write_b128 v13, v[48:51] offset:8192
    s_cmp_lg_u32 s3, 0
    s_cbranch_scc1 L0_98
    s_mov_b32 s61, 0
Lcw_99:
    v_mov_b32 v7, 9732
    ds_read_b32 v7, v7
    s_waitcnt lgkmcnt(0)
    v_cmp_gt_u32 vcc, 16, v7
    s_cbranch_vccz Lcd_100
    s_sleep 1
    s_add_u32 s61, s61, 1
    s_cmp_lt_u32 s61, 200000
    s_cbranch_scc1 Lcw_99
Lcd_100:
L0_98:
    ds_write_b128 v13, v[52:55] offset:9216
    s_branch Ljoin_86
Lctl_87:
    s_setprio 3
    s_and_b32 s63, s3, 3
    s_lshl_b32 s67, s63, 16
    s_lshl_b32 s6, s5, 10
    s_add_u32 s67, s67, s6
    v_mul_u32_u24 v6, 16, v5
    v_add_u32 v6, 94208, v6
    s_cmp_eq_u32 s39, 1
    s_cselect_b64 s[76:77], -1, 0
    s_cmp_eq_u32 s5, 0
    s_cselect_b32 s7, 11, 0
    v_add_u32 v11, 0, v4
    v_sub_u32 v12, 9, v11
    v_cndmask_b32 v12, v11, v12, s[76:77]
    v_lshl_add_u32 v12, v12, 10, v6
    ds_read_b128 v[96:99], v12
    v_mov_b32 v13, s7
    v_cmp_eq_u32 vcc, 0, v11
    s_nop 1
    v_cndmask_b32 v13, v11, v13, vcc
    v_sub_u32 v12, 10, v11
    v_cndmask_b32 v12, v13, v12, s[76:77]
    v_lshl_add_u32 v12, v12, 10, v6
    ds_read_u16 v108, v12
    v_add_u32 v11, 2, v4
    v_sub_u32 v12, 9, v11
    v_cndmask_b32 v12, v11, v12, s[76:77]
    v_lshl_add_u32 v12, v12, 10, v6
    ds_read_b128 v[100:103], v12
    v_sub_u32 v12, 10, v11
    v_cndmask_b32 v12, v11, v12, s[76:77]
    v_lshl_add_u32 v12, v12, 10, v6
    ds_read_u16 v109, v12
    v_mov_b32 v11, 4
    v_sub_u32 v12, 9, v11
    v_cndmask_b32 v12, v11, v12, s[76:77]
    v_lshl_add_u32 v12, v12, 10, v6
    ds_read_b128 v[104:107], v12
    v_sub_u32 v12, 10, v11
    v_cndmask_b32 v12, v11, v12, s[76:77]
    v_lshl_add_u32 v12, v12, 10, v6
    ds_read_u16 v110, v12
    s_lshl_b32 s6, s38, 12
    s_add_u32 s6, s6, 106496
    v_add_u32 v11, s6, v2
    ds_read_b128 v[16:19], v11 offset:0
    ds_read_b128 v[20:23], v11 offset:1024
    ds_read_b128 v[24:27], v11 offset:2048
    ds_read_b128 v[28:31], v11 offset:3072
    s_lshl_b32 s6, s5, 2
    s_lshl_b32 s7, s39, 5
    s_add_u32 s6, s6, s7
    s_lshl_b32 s7, s5, 1
    s_add_u32 s7, s7, s39
    s_add_u32 s7, s7, 64
    s_sub_u32 s70, s7, s6
    s_lshl_b32 s70, s70, 10
    s_lshl_b32 s6, s6, 10
    v_lshlrev_b32 v5, 4, v5
    v_lshl_add_u32 v5, v4, 10, v5
    v_add_u32 v5, s6, v5
    s_cmp_eq_u32 s6, 32768
    s_cselect_b32 s6, 0xffff, 0
    v_mov_b32 v12, s6
    v_cmp_eq_u32 vcc, 0, v4
    s_nop 1
    v_cndmask_b32 v12, 0, v12, vcc
    s_waitcnt lgkmcnt(4)
    v_mov_b32 v11, 0xffff
    s_cmp_eq_u32 s39, 1
    s_cbranch_scc1 Lxr_101
    v_bfi_b32 v72, v11, v108, v96
    v_mov_b32 v73, v97
    v_mov_b32 v74, v98
    v_mov_b32 v75, v99
    v_bfi_b32 v76, v11, v109, v100
    v_mov_b32 v77, v101
    v_mov_b32 v78, v102
    v_mov_b32 v79, v103
    v_bfi_b32 v80, v11, v110, v104
    v_mov_b32 v81, v105
    v_mov_b32 v82, v106
    v_mov_b32 v83, v107
    s_branch Lxj_102
Lxr_101:
    v_bfi_b32 v72, v11, v108, v99
    v_bfi_b32 v73, v11, v99, v98
    v_bfi_b32 v74, v11, v98, v97
    v_bfi_b32 v75, v11, v97, v96
    v_bfi_b32 v76, v11, v109, v103
    v_bfi_b32 v77, v11, v103, v102
    v_bfi_b32 v78, v11, v102, v101
    v_bfi_b32 v79, v11, v101, v100
    v_bfi_b32 v80, v11, v110, v107
    v_bfi_b32 v81, v11, v107, v106
    v_bfi_b32 v82, v11, v106, v105
    v_bfi_b32 v83, v11, v105, v104
Lxj_102:
    v_min_u32 v7, 7, v1
    v_lshlrev_b32 v7, 13, v7
    s_add_u32 s60, s67, 0x760000
    buffer_load_dword v7, v7, s[28:31], s60 offen sc1
    v_mfma_f32_32x32x16_bf16 v[32:47], v[84:87], v[72:75], 0
    v_mfma_f32_32x32x16_bf16 v[48:63], v[84:87], v[80:83], 0
    v_mfma_f32_32x32x16_bf16 v[32:47], v[88:91], v[76:79], v[32:47]
    v_bfe_u32 v13, v1, 2, 2
    v_mul_u32_u24 v13, 192, v13
    s_movk_i32 s7, 3072
    v_mad_u32_u24 v13, v4, s7, v13
    v_bfe_u32 v11, v1, 1, 1
    v_lshl_add_u32 v13, v11, 3, v13
    s_mul_i32 s6, s38, 1536
    s_add_u32 s6, s6, s58
    v_add_u32 v111, s6, v13
    v_bfe_u32 v11, v1, 4, 1
    v_lshlrev_b32 v11, 1, v11
    v_and_b32 v0, 1, v1
    v_add_u32 v11, v11, v0
    v_lshl_add_u32 v13, v11, 4, v111
    v_mov_b32 v11, v72
    s_sub_u32 s6, s51, s4
    s_mul_i32 s6, s6, 49152
    s_sub_u32 s71, s6, 1536
    v_mul_lo_u32 v112, v4, s71
    v_add_u32 v112, v112, v2
    s_waitcnt lgkmcnt(0)
    s_lshl_b32 s6, s4, 3
    s_add_u32 s6, s6, s5
    s_mulk_i32 s6, 6144
    s_mul_i32 s7, s63, 1536
    s_add_u32 s66, s6, s7
    s_add_u32 s66, s66, 0xc60000
    s_add_u32 s65, s66, s71
    s_mul_i32 s7, s63, 3072
    s_add_u32 m0, s7, s58
    s_add_u32 s59, s41, 6
    s_waitcnt vmcnt(0)
    s_mov_b32 s61, 0
Lpoll_103:
    v_subrev_u32 v7, s59, v7
    v_cmp_le_u32 vcc, 16, v7
    s_cbranch_vccz Lpd_104
    s_sleep 2
    v_min_u32 v7, 7, v1
    v_lshlrev_b32 v7, 13, v7
    s_add_u32 s60, s67, 0x760000
    buffer_load_dword v7, v7, s[28:31], s60 offen sc1
    s_waitcnt vmcnt(0)
    s_add_u32 s61, s61, 1
    s_cmp_lt_u32 s61, 200000
    s_cbranch_scc1 Lpoll_103
Lpd_104:
    buffer_load_dwordx4 v2, s[28:31], s66 offen sc1 lds
    buffer_load_dwordx4 v112, s[28:31], s66 offen offset:1024 sc1 lds
    buffer_load_dwordx4 v2, s[28:31], s65 offen offset:2048 sc1 lds
    s_waitcnt vmcnt(0)
    v_mov_b32 v7, 9736
    v_mov_b32 v0, 1
    s_mov_b64 exec, 1
    ds_add_u32 v7, v0
    s_mov_b64 exec, -1
    s_mov_b32 s61, 0
Lcw_105:
    v_mov_b32 v7, 9736
    ds_read_b32 v7, v7
    s_waitcnt lgkmcnt(0)
    v_cmp_gt_u32 vcc, 4, v7
    s_cbranch_vccz Lcd_106
    s_sleep 1
    s_add_u32 s61, s61, 1
    s_cmp_lt_u32 s61, 200000
    s_cbranch_scc1 Lcw_105
Lcd_106:
    ds_read_b64_tr_b16 v[64:65], v13 offset:0
    ds_read_b64_tr_b16 v[66:67], v13 offset:768
    ds_read_b64_tr_b16 v[80:81], v111 offset:64
    ds_read_b64_tr_b16 v[82:83], v111 offset:832
    ds_read_b64_tr_b16 v[68:69], v13 offset:6144
    ds_read_b64_tr_b16 v[70:71], v13 offset:6912
    ds_read_b64_tr_b16 v[84:85], v111 offset:6208
    ds_read_b64_tr_b16 v[86:87], v111 offset:6976
    ds_read_b64_tr_b16 v[72:73], v13 offset:80
    ds_read_b64_tr_b16 v[74:75], v13 offset:848
    ds_read_b64_tr_b16 v[88:89], v111 offset:144
    ds_read_b64_tr_b16 v[90:91], v111 offset:912
    ds_read_b64_tr_b16 v[76:77], v13 offset:6224
    ds_read_b64_tr_b16 v[78:79], v13 offset:6992
    ds_read_b64_tr_b16 v[92:93], v111 offset:6288
    ds_read_b64_tr_b16 v[94:95], v111 offset:7056
    s_add_u32 s63, s44, 0xf60000
    s_add_u32 s71, s63, s70
    s_waitcnt lgkmcnt(14)
    v_mfma_f32_32x32x16_bf16 v[32:47], v[64:67], v[16:19], v[32:47]
    s_waitcnt lgkmcnt(12)
    v_mfma_f32_32x32x16_bf16 v[48:63], v[80:83], v[16:19], v[48:63]
    s_waitcnt lgkmcnt(10)
    v_mfma_f32_32x32x16_bf16 v[32:47], v[68:71], v[20:23], v[32:47]
    s_waitcnt lgkmcnt(8)
    v_mfma_f32_32x32x16_bf16 v[48:63], v[84:87], v[20:23], v[48:63]
    s_waitcnt lgkmcnt(6)
    v_mfma_f32_32x32x16_bf16 v[32:47], v[72:75], v[24:27], v[32:47]
    s_waitcnt lgkmcnt(4)
    v_mfma_f32_32x32x16_bf16 v[48:63], v[88:91], v[24:27], v[48:63]
    s_waitcnt lgkmcnt(2)
    v_mfma_f32_32x32x16_bf16 v[32:47], v[76:79], v[28:31], v[32:47]
    s_waitcnt lgkmcnt(0)
    v_mfma_f32_32x32x16_bf16 v[48:63], v[92:95], v[28:31], v[48:63]
    s_nop 9
    v_cvt_pk_bf16_f32 v96, v32, v33
    v_cvt_pk_bf16_f32 v97, v34, v35
    v_cvt_pk_bf16_f32 v98, v36, v37
    v_cvt_pk_bf16_f32 v99, v38, v39
    v_cvt_pk_bf16_f32 v100, v40, v41
    v_cvt_pk_bf16_f32 v101, v42, v43
    v_cvt_pk_bf16_f32 v102, v44, v45
    v_cvt_pk_bf16_f32 v103, v46, v47
    v_bfi_b32 v96, v12, v11, v96
    buffer_store_dwordx4 v[100:103], v5, s[28:31], s63 offen offset:2048 sc1
    buffer_store_dwordx4 v[96:99], v5, s[28:31], s63 offen sc1
    v_cvt_pk_bf16_f32 v104, v48, v49
    v_cvt_pk_bf16_f32 v105, v50, v51
    v_cvt_pk_bf16_f32 v106, v52, v53
    v_cvt_pk_bf16_f32 v107, v54, v55
    s_mov_b32 exec_hi, 0
    buffer_store_dwordx4 v[104:107], v5, s[28:31], s71 offen sc1
    s_mov_b32 exec_hi, -1
    s_mov_b32 s7, 0x3f803f80
    v_mov_b32 v16, 0
    v_mov_b32 v17, 0
    v_mov_b32 v18, 0
    v_mov_b32 v19, 0
    v_dot2_f32_bf16 v16, v96, s7, v16
    v_dot2_f32_bf16 v17, v96, v96, v17
    v_dot2_f32_bf16 v16, v97, s7, v16
    v_dot2_f32_bf16 v17, v97, v97, v17
    v_dot2_f32_bf16 v16, v98, s7, v16
    v_dot2_f32_bf16 v17, v98, v98, v17
    v_dot2_f32_bf16 v16, v99, s7, v16
    v_dot2_f32_bf16 v17, v99, v99, v17
    v_dot2_f32_bf16 v16, v100, s7, v16
    v_dot2_f32_bf16 v17, v100, v100, v17
    v_dot2_f32_bf16 v16, v101, s7, v16
    v_dot2_f32_bf16 v17, v101, v101, v17
    v_dot2_f32_bf16 v16, v102, s7, v16
    v_dot2_f32_bf16 v17, v102, v102, v17
    v_dot2_f32_bf16 v16, v103, s7, v16
    v_dot2_f32_bf16 v17, v103, v103, v17
    s_mov_b32 exec_hi, 0
    v_dot2_f32_bf16 v16, v104, s7, v16
    v_dot2_f32_bf16 v17, v104, v104, v17
    v_dot2_f32_bf16 v16, v105, s7, v16
    v_dot2_f32_bf16 v17, v105, v105, v17
    v_dot2_f32_bf16 v16, v106, s7, v16
    v_dot2_f32_bf16 v17, v106, v106, v17
    v_dot2_f32_bf16 v16, v107, s7, v16
    v_dot2_f32_bf16 v17, v107, v107, v17
    s_mov_b32 exec_hi, -1
    v_bfe_u32 v7, v5, 4, 6
    v_lshlrev_b32 v7, 3, v7
    s_lshl_b32 s6, s39, 9
    v_add_u32 v7, s6, v7
    v_mov_b32 v18, v16
    v_mov_b32 v19, v17
    s_nop 0
    v_permlane32_swap_b32 v16, v18
    v_permlane32_swap_b32 v17, v19
    v_add_f32 v16, v16, v18
    v_add_f32 v17, v17, v19
    ds_write_b64 v7, v[16:17] offset:60416
    s_waitcnt vmcnt(0)
    v_mov_b32 v7, 9740
    v_mov_b32 v0, 1
    s_mov_b64 exec, 1
    ds_add_u32 v7, v0
    s_mov_b64 exec, -1
    s_mov_b32 s61, 0
Lcw_107:
    v_mov_b32 v7, 9740
    ds_read_b32 v7, v7
    s_waitcnt lgkmcnt(0)
    v_cmp_gt_u32 vcc, 4, v7
    s_cbranch_vccz Lcd_108
    s_sleep 1
    s_add_u32 s61, s61, 1
    s_cmp_lt_u32 s61, 200000
    s_cbranch_scc1 Lcw_107
Lcd_108:
    s_cmp_lg_u32 s3, 4
    s_cbranch_scc1 Lnf_109
    s_add_u32 s62, s41, 7
    v_mov_b32 v0, s62
    v_writelane_b32 v0, s27, 1
    v_lshlrev_b32 v7, 2, v1
    s_mov_b32 exec_hi, 0
    s_add_u32 s62, s45, 0x80000
    buffer_store_dword v0, v7, s[28:31], s62 offen
    s_cmp_eq_u32 s26, 0
    s_cbranch_scc1 Lng_110
    buffer_store_dword v0, v7, s[28:31], s45 offen sc1
Lng_110:
    s_mov_b32 exec_hi, -1
Lnf_109:
    s_lshl_b32 s65, s4, 12
    s_add_u32 s65, s65, 0x580000
    s_cmp_lg_u32 s3, 7
    s_cbranch_scc1 Ls1_111
    v_lshlrev_b32 v7, 3, v1
    ds_read_b64 v[16:17], v7 offset:60416
    ds_read_b64 v[18:19], v7 offset:60928
    s_lshl_b32 s6, s5, 9
    s_add_u32 s6, s6, s65
    s_waitcnt lgkmcnt(0)
    v_add_f32 v16, v16, v18
    v_add_f32 v17, v17, v19
    buffer_store_dwordx2 v[16:17], v7, s[28:31], s6 offen sc1
Ls1_111:
    s_lshl_b32 s7, s3, 11
    s_lshl_b32 s67, s4, 13
    s_cmp_eq_u32 s26, 0
    s_cselect_b32 s6, 0x80000, 0
    s_add_u32 s67, s67, s6
    s_add_u32 s67, s67, s7
    s_sub_u32 s67, s67, 7680
    v_min_u32 v7, 1, v1
    v_lshlrev_b32 v7, 10, v7
    s_add_u32 s60, s67, 0x760000
    buffer_load_dword v7, v7, s[28:31], s60 offen sc1
    s_and_b32 s6, s3, 3
    s_lshl_b32 s56, s6, 13
    s_lshl_b32 s57, s6, 12
    s_add_u32 s66, s63, s56
    s_add_u32 s70, s63, s57
    s_add_u32 s59, s41, 7
    s_waitcnt vmcnt(0)
    s_mov_b32 s61, 0
Lpoll_112:
    v_subrev_u32 v7, s59, v7
    v_cmp_le_u32 vcc, 16, v7
    s_cbranch_vccz Lpd_113
    s_sleep 2
    v_min_u32 v7, 1, v1
    v_lshlrev_b32 v7, 10, v7
    s_add_u32 s60, s67, 0x760000
    buffer_load_dword v7, v7, s[28:31], s60 offen sc1
    s_waitcnt vmcnt(0)
    s_add_u32 s61, s61, 1
    s_cmp_lt_u32 s61, 200000
    s_cbranch_scc1 Lpoll_112
Lpd_113:
    s_add_u32 m0, s56, 81920
    s_add_u32 s64, s66, 0x0
    buffer_load_dwordx4 v2, s[28:31], s64 offen offset:0 sc1 lds
    buffer_load_dwordx4 v2, s[28:31], s64 offen offset:1024 sc1 lds
    buffer_load_dwordx4 v2, s[28:31], s64 offen offset:2048 sc1 lds
    buffer_load_dwordx4 v2, s[28:31], s64 offen offset:3072 sc1 lds
    s_add_u32 m0, s56, 86016
    s_add_u32 s64, s66, 0x1000
    buffer_load_dwordx4 v2, s[28:31], s64 offen offset:0 sc1 lds
    buffer_load_dwordx4 v2, s[28:31], s64 offen offset:1024 sc1 lds
    buffer_load_dwordx4 v2, s[28:31], s64 offen offset:2048 sc1 lds
    buffer_load_dwordx4 v2, s[28:31], s64 offen offset:3072 sc1 lds
    s_add_u32 m0, s56, 114688
    s_add_u32 s64, s66, 0x8000
    buffer_load_dwordx4 v2, s[28:31], s64 offen offset:0 sc1 lds
    buffer_load_dwordx4 v2, s[28:31], s64 offen offset:1024 sc1 lds
    buffer_load_dwordx4 v2, s[28:31], s64 offen offset:2048 sc1 lds
    buffer_load_dwordx4 v2, s[28:31], s64 offen offset:3072 sc1 lds
    s_add_u32 m0, s56, 118784
    s_add_u32 s64, s66, 0x9000
    buffer_load_dwordx4 v2, s[28:31], s64 offen offset:0 sc1 lds
    buffer_load_dwordx4 v2, s[28:31], s64 offen offset:1024 sc1 lds
    buffer_load_dwordx4 v2, s[28:31], s64 offen offset:2048 sc1 lds
    buffer_load_dwordx4 v2, s[28:31], s64 offen offset:3072 sc1 lds
    s_add_u32 m0, s57, 147456
    s_add_u32 s64, s70, 0x10000
    buffer_load_dwordx4 v2, s[28:31], s64 offen offset:0 sc1 lds
    buffer_load_dwordx4 v2, s[28:31], s64 offen offset:1024 sc1 lds
    buffer_load_dwordx4 v2, s[28:31], s64 offen offset:2048 sc1 lds
    buffer_load_dwordx4 v2, s[28:31], s64 offen offset:3072 sc1 lds
    v_add_u32 v5, 81920, v3
    v_add_u32 v6, 122880, v3
    s_waitcnt vmcnt(12)
    s_waitcnt lgkmcnt(0)
    s_barrier
    s_cmp_eq_u32 s3, 7
    s_cbranch_scc1 LS_83
    s_cmp_lt_u32 s3, s43
    s_cbranch_scc1 Llate_88
    s_waitcnt vmcnt(0)
    v_mov_b32 v7, 9728
    v_mov_b32 v0, 1
    s_mov_b64 exec, 1
    ds_add_u32 v7, v0
    s_mov_b64 exec, -1
    v_mov_b32 v7, 9732
    v_mov_b32 v0, 1
    s_mov_b64 exec, 1
    ds_add_u32 v7, v0
    s_mov_b64 exec, -1
    s_branch Lg2_85
Llate_88:
    s_setprio 2
    s_add_u32 s64, s46, 0
    buffer_load_dwordx4 v[88:91], v2, s[28:31], s64 offen sc1
    s_add_u32 s64, s46, 1024
    buffer_load_dwordx4 v[92:95], v2, s[28:31], s64 offen sc1
    s_add_u32 s64, s46, 2048
    buffer_load_dwordx4 v[96:99], v2, s[28:31], s64 offen sc1
    s_add_u32 s64, s46, 3072
    buffer_load_dwordx4 v[100:103], v2, s[28:31], s64 offen sc1
    s_waitcnt vmcnt(4)
    v_mov_b32 v7, 9728
    v_mov_b32 v0, 1
    s_mov_b64 exec, 1
    ds_add_u32 v7, v0
    s_mov_b64 exec, -1
    s_add_u32 s64, s46, 4096
    buffer_load_dwordx4 v[104:107], v2, s[28:31], s64 offen sc1
    s_add_u32 s64, s46, 5120
    buffer_load_dwordx4 v[108:111], v2, s[28:31], s64 offen sc1
    s_add_u32 s64, s46, 6144
    buffer_load_dwordx4 v[112:115], v2, s[28:31], s64 offen sc1
    s_add_u32 s64, s46, 7168
    buffer_load_dwordx4 v[116:119], v2, s[28:31], s64 offen sc1
    s_add_u32 s64, s46, 8192
    buffer_load_dwordx4 v[120:123], v2, s[28:31], s64 offen sc1
    s_add_u32 s64, s46, 9216
    buffer_load_dwordx4 v[124:127], v2, s[28:31], s64 offen sc1
    s_add_u32 s64, s46, 10240
    buffer_load_dwordx4 v[128:131], v2, s[28:31], s64 offen sc1
    s_add_u32 s64, s46, 11264
    buffer_load_dwordx4 v[132:135], v2, s[28:31], s64 offen sc1
    s_lshl_b32 s6, s3, 7
    v_lshl_add_u32 v7, v10, 2, s6
    ds_write_b32 v7, v15 offset:19456
    v_add_u32 v13, s69, v2
    ds_read_b128 v[48:51], v5 offset:0
    ds_read_b128 v[52:55], v5 offset:256
    ds_read_b128 v[56:59], v5 offset:512
    ds_read_b128 v[60:63], v5 offset:768
    ds_read_b128 v[80:83], v13 offset:0
    s_add_u32 s56, s46, 12288
    s_add_u32 s57, s46, 16384
    s_waitcnt vmcnt(11) lgkmcnt(0)
    v_mfma_f32_16x16x32_bf16 v[16:19], v[88:91], v[48:51], 0
    ds_read_b128 v[64:67], v5 offset:4096
    v_mfma_f32_16x16x32_bf16 v[20:23], v[88:91], v[52:55], 0
    ds_read_b128 v[68:71], v5 offset:4352
    v_mfma_f32_16x16x32_bf16 v[24:27], v[88:91], v[56:59], 0
    ds_read_b128 v[72:75], v5 offset:4608
    v_mfma_f32_16x16x32_bf16 v[28:31], v[88:91], v[60:63], 0
    ds_read_b128 v[76:79], v5 offset:4864
    v_mfma_f32_16x16x32_bf16 v[32:35], v[80:83], v[48:51], 0
    ds_read_b128 v[84:87], v13 offset:1024
    v_mfma_f32_16x16x32_bf16 v[36:39], v[80:83], v[52:55], 0
    s_add_u32 m0, s69, 0
    s_add_u32 s66, s46, 29696
    buffer_load_dwordx4 v2, s[28:31], s66 offen offset:0 sc1 lds
    v_mfma_f32_16x16x32_bf16 v[40:43], v[80:83], v[56:59], 0
    buffer_load_dwordx4 v[88:91], v2, s[28:31], s56 offen offset:0 sc1
    v_mfma_f32_16x16x32_bf16 v[44:47], v[80:83], v[60:63], 0
    s_waitcnt vmcnt(12) lgkmcnt(0)
    v_mfma_f32_16x16x32_bf16 v[16:19], v[92:95], v[64:67], v[16:19]
    ds_read_b128 v[48:51], v5 offset:8192
    v_mfma_f32_16x16x32_bf16 v[20:23], v[92:95], v[68:71], v[20:23]
    ds_read_b128 v[52:55], v5 offset:8448
    v_mfma_f32_16x16x32_bf16 v[24:27], v[92:95], v[72:75], v[24:27]
    ds_read_b128 v[56:59], v5 offset:8704
    v_mfma_f32_16x16x32_bf16 v[28:31], v[92:95], v[76:79], v[28:31]
    ds_read_b128 v[60:63], v5 offset:8960
    v_mfma_f32_16x16x32_bf16 v[32:35], v[84:87], v[64:67], v[32:35]
    ds_read_b128 v[80:83], v13 offset:2048
    v_mfma_f32_16x16x32_bf16 v[36:39], v[84:87], v[68:71], v[36:39]
    buffer_load_dwordx4 v2, s[28:31], s66 offen offset:1024 sc1 lds
    v_mfma_f32_16x16x32_bf16 v[40:43], v[84:87], v[72:75], v[40:43]
    buffer_load_dwordx4 v[92:95], v2, s[28:31], s56 offen offset:1024 sc1
    v_mfma_f32_16x16x32_bf16 v[44:47], v[84:87], v[76:79], v[44:47]
    s_waitcnt vmcnt(13) lgkmcnt(0)
    v_mfma_f32_16x16x32_bf16 v[16:19], v[96:99], v[48:51], v[16:19]
    ds_read_b128 v[64:67], v5 offset:12288
    v_mfma_f32_16x16x32_bf16 v[20:23], v[96:99], v[52:55], v[20:23]
    ds_read_b128 v[68:71], v5 offset:12544
    v_mfma_f32_16x16x32_bf16 v[24:27], v[96:99], v[56:59], v[24:27]
    ds_read_b128 v[72:75], v5 offset:12800
    v_mfma_f32_16x16x32_bf16 v[28:31], v[96:99], v[60:63], v[28:31]
    ds_read_b128 v[76:79], v5 offset:13056
    v_mfma_f32_16x16x32_bf16 v[32:35], v[80:83], v[48:51], v[32:35]
    ds_read_b128 v[84:87], v13 offset:3072
    v_mfma_f32_16x16x32_bf16 v[36:39], v[80:83], v[52:55], v[36:39]
    buffer_load_dwordx4 v2, s[28:31], s66 offen offset:2048 sc1 lds
    v_mfma_f32_16x16x32_bf16 v[40:43], v[80:83], v[56:59], v[40:43]
    buffer_load_dwordx4 v[96:99], v2, s[28:31], s56 offen offset:2048 sc1
    v_mfma_f32_16x16x32_bf16 v[44:47], v[80:83], v[60:63], v[44:47]
    s_waitcnt vmcnt(14) lgkmcnt(0)
    v_mfma_f32_16x16x32_bf16 v[16:19], v[100:103], v[64:67], v[16:19]
    ds_read_b128 v[48:51], v5 offset:16384
    v_mfma_f32_16x16x32_bf16 v[20:23], v[100:103], v[68:71], v[20:23]
    ds_read_b128 v[52:55], v5 offset:16640
    v_mfma_f32_16x16x32_bf16 v[24:27], v[100:103], v[72:75], v[24:27]
    ds_read_b128 v[56:59], v5 offset:16896
    v_mfma_f32_16x16x32_bf16 v[28:31], v[100:103], v[76:79], v[28:31]
    ds_read_b128 v[60:63], v5 offset:17152
    v_mfma_f32_16x16x32_bf16 v[32:35], v[84:87], v[64:67], v[32:35]
    ds_read_b128 v[80:83], v13 offset:4096
    v_mfma_f32_16x16x32_bf16 v[36:39], v[84:87], v[68:71], v[36:39]
    buffer_load_dwordx4 v2, s[28:31], s66 offen offset:3072 sc1 lds
    v_mfma_f32_16x16x32_bf16 v[40:43], v[84:87], v[72:75], v[40:43]
    buffer_load_dwordx4 v[100:103], v2, s[28:31], s56 offen offset:3072 sc1
    v_mfma_f32_16x16x32_bf16 v[44:47], v[84:87], v[76:79], v[44:47]
    s_waitcnt vmcnt(15) lgkmcnt(0)
    v_mfma_f32_16x16x32_bf16 v[16:19], v[104:107], v[48:51], v[16:19]
    ds_read_b128 v[64:67], v5 offset:20480
    v_mfma_f32_16x16x32_bf16 v[20:23], v[104:107], v[52:55], v[20:23]
    ds_read_b128 v[68:71], v5 offset:20736
    v_mfma_f32_16x16x32_bf16 v[24:27], v[104:107], v[56:59], v[24:27]
    ds_read_b128 v[72:75], v5 offset:20992
    v_mfma_f32_16x16x32_bf16 v[28:31], v[104:107], v[60:63], v[28:31]
    ds_read_b128 v[76:79], v5 offset:21248
    v_mfma_f32_16x16x32_bf16 v[32:35], v[80:83], v[48:51], v[32:35]
    ds_read_b128 v[84:87], v13 offset:5120
    v_mfma_f32_16x16x32_bf16 v[36:39], v[80:83], v[52:55], v[36:39]
    s_add_u32 m0, s69, 4096
    s_add_u32 s66, s46, 33792
    buffer_load_dwordx4 v2, s[28:31], s66 offen offset:0 sc1 lds
    v_mfma_f32_16x16x32_bf16 v[40:43], v[80:83], v[56:59], v[40:43]
    buffer_load_dwordx4 v[104:107], v2, s[28:31], s57 offen offset:0 sc1
    v_mfma_f32_16x16x32_bf16 v[44:47], v[80:83], v[60:63], v[44:47]
    s_waitcnt vmcnt(16) lgkmcnt(0)
    v_mfma_f32_16x16x32_bf16 v[16:19], v[108:111], v[64:67], v[16:19]
    ds_read_b128 v[48:51], v5 offset:24576
    v_mfma_f32_16x16x32_bf16 v[20:23], v[108:111], v[68:71], v[20:23]
    ds_read_b128 v[52:55], v5 offset:24832
    v_mfma_f32_16x16x32_bf16 v[24:27], v[108:111], v[72:75], v[24:27]
    ds_read_b128 v[56:59], v5 offset:25088
    v_mfma_f32_16x16x32_bf16 v[28:31], v[108:111], v[76:79], v[28:31]
    ds_read_b128 v[60:63], v5 offset:25344
    v_mfma_f32_16x16x32_bf16 v[32:35], v[84:87], v[64:67], v[32:35]
    ds_read_b128 v[80:83], v13 offset:6144
    v_mfma_f32_16x16x32_bf16 v[36:39], v[84:87], v[68:71], v[36:39]
    buffer_load_dwordx4 v2, s[28:31], s66 offen offset:1024 sc1 lds
    v_mfma_f32_16x16x32_bf16 v[40:43], v[84:87], v[72:75], v[40:43]
    buffer_load_dwordx4 v[108:111], v2, s[28:31], s57 offen offset:1024 sc1
    v_mfma_f32_16x16x32_bf16 v[44:47], v[84:87], v[76:79], v[44:47]
    v_mov_b32 v7, 9728
    ds_read_b32 v7, v7
    s_waitcnt vmcnt(17) lgkmcnt(1)
    v_mfma_f32_16x16x32_bf16 v[16:19], v[112:115], v[48:51], v[16:19]
    ds_read_b128 v[64:67], v5 offset:28672
    v_mfma_f32_16x16x32_bf16 v[20:23], v[112:115], v[52:55], v[20:23]
    ds_read_b128 v[68:71], v5 offset:28928
    v_mfma_f32_16x16x32_bf16 v[24:27], v[112:115], v[56:59], v[24:27]
    ds_read_b128 v[72:75], v5 offset:29184
    v_mfma_f32_16x16x32_bf16 v[28:31], v[112:115], v[60:63], v[28:31]
    ds_read_b128 v[76:79], v5 offset:29440
    v_mfma_f32_16x16x32_bf16 v[32:35], v[80:83], v[48:51], v[32:35]
    ds_read_b128 v[84:87], v13 offset:7168
    v_mfma_f32_16x16x32_bf16 v[36:39], v[80:83], v[52:55], v[36:39]
    buffer_load_dwordx4 v2, s[28:31], s66 offen offset:2048 sc1 lds
    v_mfma_f32_16x16x32_bf16 v[40:43], v[80:83], v[56:59], v[40:43]
    buffer_load_dwordx4 v[112:115], v2, s[28:31], s57 offen offset:2048 sc1
    v_mfma_f32_16x16x32_bf16 v[44:47], v[80:83], v[60:63], v[44:47]
    s_waitcnt lgkmcnt(5)
    v_cmp_gt_u32 vcc, 4, v7
    s_cbranch_vccz Lcd_115
    s_mov_b32 s61, 0
Lcw_114:
    v_mov_b32 v7, 9728
    ds_read_b32 v7, v7
    s_waitcnt lgkmcnt(0)
    v_cmp_gt_u32 vcc, 4, v7
    s_cbranch_vccz Lcd_115
    s_sleep 1
    s_add_u32 s61, s61, 1
    s_cmp_lt_u32 s61, 200000
    s_cbranch_scc1 Lcw_114
Lcd_115:
    s_waitcnt vmcnt(18) lgkmcnt(0)
    v_mfma_f32_16x16x32_bf16 v[16:19], v[116:119], v[64:67], v[16:19]
    ds_read_b128 v[48:51], v5 offset:32768
    v_mfma_f32_16x16x32_bf16 v[20:23], v[116:119], v[68:71], v[20:23]
    ds_read_b128 v[52:55], v5 offset:33024
    v_mfma_f32_16x16x32_bf16 v[24:27], v[116:119], v[72:75], v[24:27]
    ds_read_b128 v[56:59], v5 offset:33280
    v_mfma_f32_16x16x32_bf16 v[28:31], v[116:119], v[76:79], v[28:31]
    ds_read_b128 v[60:63], v5 offset:33536
    v_mfma_f32_16x16x32_bf16 v[32:35], v[84:87], v[64:67], v[32:35]
    ds_read_b128 v[80:83], v13 offset:8192
    v_mfma_f32_16x16x32_bf16 v[36:39], v[84:87], v[68:71], v[36:39]
    buffer_load_dwordx4 v2, s[28:31], s66 offen offset:3072 sc1 lds
    v_mfma_f32_16x16x32_bf16 v[40:43], v[84:87], v[72:75], v[40:43]
    buffer_load_dwordx4 v[116:119], v2, s[28:31], s57 offen offset:3072 sc1
    v_mfma_f32_16x16x32_bf16 v[44:47], v[84:87], v[76:79], v[44:47]
    s_waitcnt vmcnt(15) lgkmcnt(0)
    v_mfma_f32_16x16x32_bf16 v[16:19], v[120:123], v[48:51], v[16:19]
    ds_read_b128 v[64:67], v5 offset:36864
    v_mfma_f32_16x16x32_bf16 v[20:23], v[120:123], v[52:55], v[20:23]
    ds_read_b128 v[68:71], v5 offset:37120
    v_mfma_f32_16x16x32_bf16 v[24:27], v[120:123], v[56:59], v[24:27]
    ds_read_b128 v[72:75], v5 offset:37376
    v_mfma_f32_16x16x32_bf16 v[28:31], v[120:123], v[60:63], v[28:31]
    ds_read_b128 v[76:79], v5 offset:37632
    v_mfma_f32_16x16x32_bf16 v[32:35], v[80:83], v[48:51], v[32:35]
    ds_read_b128 v[84:87], v13 offset:0
    v_mfma_f32_16x16x32_bf16 v[36:39], v[80:83], v[52:55], v[36:39]
    s_add_u32 m0, s69, 8192
    s_add_u32 s66, s46, 37888
    buffer_load_dwordx4 v2, s[28:31], s66 offen offset:0 sc1 lds
    v_mfma_f32_16x16x32_bf16 v[40:43], v[80:83], v[56:59], v[40:43]
    v_mfma_f32_16x16x32_bf16 v[44:47], v[80:83], v[60:63], v[44:47]
    s_waitcnt vmcnt(14) lgkmcnt(0)
    v_mfma_f32_16x16x32_bf16 v[16:19], v[124:127], v[64:67], v[16:19]
    ds_read_b128 v[48:51], v6 offset:0
    v_mfma_f32_16x16x32_bf16 v[20:23], v[124:127], v[68:71], v[20:23]
    ds_read_b128 v[52:55], v6 offset:256
    v_mfma_f32_16x16x32_bf16 v[24:27], v[124:127], v[72:75], v[24:27]
    ds_read_b128 v[56:59], v6 offset:512
    v_mfma_f32_16x16x32_bf16 v[28:31], v[124:127], v[76:79], v[28:31]
    ds_read_b128 v[60:63], v6 offset:768
    v_mfma_f32_16x16x32_bf16 v[32:35], v[84:87], v[64:67], v[32:35]
    ds_read_b128 v[80:83], v13 offset:1024
    v_mfma_f32_16x16x32_bf16 v[36:39], v[84:87], v[68:71], v[36:39]
    s_add_u32 m0, s69, 0
    s_add_u32 s66, s46, 38912
    buffer_load_dwordx4 v2, s[28:31], s66 offen offset:0 sc1 lds
    v_mfma_f32_16x16x32_bf16 v[40:43], v[84:87], v[72:75], v[40:43]
    v_mfma_f32_16x16x32_bf16 v[44:47], v[84:87], v[76:79], v[44:47]
    s_waitcnt vmcnt(13) lgkmcnt(0)
    v_mfma_f32_16x16x32_bf16 v[16:19], v[128:131], v[48:51], v[16:19]
    ds_read_b128 v[64:67], v6 offset:4096
    v_mfma_f32_16x16x32_bf16 v[20:23], v[128:131], v[52:55], v[20:23]
    ds_read_b128 v[68:71], v6 offset:4352
    v_mfma_f32_16x16x32_bf16 v[24:27], v[128:131], v[56:59], v[24:27]
    ds_read_b128 v[72:75], v6 offset:4608
    v_mfma_f32_16x16x32_bf16 v[28:31], v[128:131], v[60:63], v[28:31]
    ds_read_b128 v[76:79], v6 offset:4864
    v_mfma_f32_16x16x32_bf16 v[32:35], v[80:83], v[48:51], v[32:35]
    ds_read_b128 v[84:87], v13 offset:2048
    v_mfma_f32_16x16x32_bf16 v[36:39], v[80:83], v[52:55], v[36:39]
    buffer_load_dwordx4 v2, s[28:31], s66 offen offset:1024 sc1 lds
    v_mfma_f32_16x16x32_bf16 v[40:43], v[80:83], v[56:59], v[40:43]
    v_mfma_f32_16x16x32_bf16 v[44:47], v[80:83], v[60:63], v[44:47]
    s_waitcnt vmcnt(12) lgkmcnt(0)
    v_mfma_f32_16x16x32_bf16 v[16:19], v[132:135], v[64:67], v[16:19]
    ds_read_b128 v[48:51], v6 offset:8192
    v_mfma_f32_16x16x32_bf16 v[20:23], v[132:135], v[68:71], v[20:23]
    ds_read_b128 v[52:55], v6 offset:8448
    v_mfma_f32_16x16x32_bf16 v[24:27], v[132:135], v[72:75], v[24:27]
    ds_read_b128 v[56:59], v6 offset:8704
    v_mfma_f32_16x16x32_bf16 v[28:31], v[132:135], v[76:79], v[28:31]
    ds_read_b128 v[60:63], v6 offset:8960
    v_mfma_f32_16x16x32_bf16 v[32:35], v[84:87], v[64:67], v[32:35]
    ds_read_b128 v[80:83], v13 offset:3072
    v_mfma_f32_16x16x32_bf16 v[36:39], v[84:87], v[68:71], v[36:39]
    v_mfma_f32_16x16x32_bf16 v[40:43], v[84:87], v[72:75], v[40:43]
    v_mfma_f32_16x16x32_bf16 v[44:47], v[84:87], v[76:79], v[44:47]
    s_waitcnt vmcnt(10) lgkmcnt(0)
    v_mfma_f32_16x16x32_bf16 v[16:19], v[88:91], v[48:51], v[16:19]
    ds_read_b128 v[64:67], v6 offset:12288
    v_mfma_f32_16x16x32_bf16 v[20:23], v[88:91], v[52:55], v[20:23]
    ds_read_b128 v[68:71], v6 offset:12544
    v_mfma_f32_16x16x32_bf16 v[24:27], v[88:91], v[56:59], v[24:27]
    ds_read_b128 v[72:75], v6 offset:12800
    v_mfma_f32_16x16x32_bf16 v[28:31], v[88:91], v[60:63], v[28:31]
    ds_read_b128 v[76:79], v6 offset:13056
    v_mfma_f32_16x16x32_bf16 v[32:35], v[80:83], v[48:51], v[32:35]
    ds_read_b128 v[84:87], v13 offset:4096
    v_mfma_f32_16x16x32_bf16 v[36:39], v[80:83], v[52:55], v[36:39]
    v_mfma_f32_16x16x32_bf16 v[40:43], v[80:83], v[56:59], v[40:43]
    v_mfma_f32_16x16x32_bf16 v[44:47], v[80:83], v[60:63], v[44:47]
    s_waitcnt vmcnt(8) lgkmcnt(0)
    v_mfma_f32_16x16x32_bf16 v[16:19], v[92:95], v[64:67], v[16:19]
    ds_read_b128 v[48:51], v6 offset:16384
    v_mfma_f32_16x16x32_bf16 v[20:23], v[92:95], v[68:71], v[20:23]
    ds_read_b128 v[52:55], v6 offset:16640
    v_mfma_f32_16x16x32_bf16 v[24:27], v[92:95], v[72:75], v[24:27]
    ds_read_b128 v[56:59], v6 offset:16896
    v_mfma_f32_16x16x32_bf16 v[28:31], v[92:95], v[76:79], v[28:31]
    ds_read_b128 v[60:63], v6 offset:17152
    v_mfma_f32_16x16x32_bf16 v[32:35], v[84:87], v[64:67], v[32:35]
    ds_read_b128 v[80:83], v13 offset:5120
    v_mfma_f32_16x16x32_bf16 v[36:39], v[84:87], v[68:71], v[36:39]
    v_mfma_f32_16x16x32_bf16 v[40:43], v[84:87], v[72:75], v[40:43]
    v_mfma_f32_16x16x32_bf16 v[44:47], v[84:87], v[76:79], v[44:47]
    s_waitcnt vmcnt(6) lgkmcnt(0)
    v_mfma_f32_16x16x32_bf16 v[16:19], v[96:99], v[48:51], v[16:19]
    ds_read_b128 v[64:67], v6 offset:20480
    v_mfma_f32_16x16x32_bf16 v[20:23], v[96:99], v[52:55], v[20:23]
    ds_read_b128 v[68:71], v6 offset:20736
    v_mfma_f32_16x16x32_bf16 v[24:27], v[96:99], v[56:59], v[24:27]
    ds_read_b128 v[72:75], v6 offset:20992
    v_mfma_f32_16x16x32_bf16 v[28:31], v[96:99], v[60:63], v[28:31]
    ds_read_b128 v[76:79], v6 offset:21248
    v_mfma_f32_16x16x32_bf16 v[32:35], v[80:83], v[48:51], v[32:35]
    ds_read_b128 v[84:87], v13 offset:6144
    v_mfma_f32_16x16x32_bf16 v[36:39], v[80:83], v[52:55], v[36:39]
    v_mfma_f32_16x16x32_bf16 v[40:43], v[80:83], v[56:59], v[40:43]
    v_mfma_f32_16x16x32_bf16 v[44:47], v[80:83], v[60:63], v[44:47]
    s_waitcnt vmcnt(4) lgkmcnt(0)
    v_mfma_f32_16x16x32_bf16 v[16:19], v[100:103], v[64:67], v[16:19]
    ds_read_b128 v[48:51], v6 offset:24576
    v_mfma_f32_16x16x32_bf16 v[20:23], v[100:103], v[68:71], v[20:23]
    ds_read_b128 v[52:55], v6 offset:24832
    v_mfma_f32_16x16x32_bf16 v[24:27], v[100:103], v[72:75], v[24:27]
    ds_read_b128 v[56:59], v6 offset:25088
    v_mfma_f32_16x16x32_bf16 v[28:31], v[100:103], v[76:79], v[28:31]
    ds_read_b128 v[60:63], v6 offset:25344
    v_mfma_f32_16x16x32_bf16 v[32:35], v[84:87], v[64:67], v[32:35]
    ds_read_b128 v[80:83], v13 offset:7168
    v_mfma_f32_16x16x32_bf16 v[36:39], v[84:87], v[68:71], v[36:39]
    v_mfma_f32_16x16x32_bf16 v[40:43], v[84:87], v[72:75], v[40:43]
    v_mfma_f32_16x16x32_bf16 v[44:47], v[84:87], v[76:79], v[44:47]
    s_waitcnt vmcnt(2) lgkmcnt(0)
    v_mfma_f32_16x16x32_bf16 v[16:19], v[104:107], v[48:51], v[16:19]
    ds_read_b128 v[64:67], v6 offset:28672
    v_mfma_f32_16x16x32_bf16 v[20:23], v[104:107], v[52:55], v[20:23]
    ds_read_b128 v[68:71], v6 offset:28928
    v_mfma_f32_16x16x32_bf16 v[24:27], v[104:107], v[56:59], v[24:27]
    ds_read_b128 v[72:75], v6 offset:29184
    v_mfma_f32_16x16x32_bf16 v[28:31], v[104:107], v[60:63], v[28:31]
    ds_read_b128 v[76:79], v6 offset:29440
    v_mfma_f32_16x16x32_bf16 v[32:35], v[80:83], v[48:51], v[32:35]
    ds_read_b128 v[84:87], v13 offset:8192
    v_mfma_f32_16x16x32_bf16 v[36:39], v[80:83], v[52:55], v[36:39]
    v_mfma_f32_16x16x32_bf16 v[40:43], v[80:83], v[56:59], v[40:43]
    v_mfma_f32_16x16x32_bf16 v[44:47], v[80:83], v[60:63], v[44:47]
    s_waitcnt vmcnt(1) lgkmcnt(0)
    v_mfma_f32_16x16x32_bf16 v[16:19], v[108:111], v[64:67], v[16:19]
    ds_read_b128 v[48:51], v6 offset:32768
    v_mfma_f32_16x16x32_bf16 v[20:23], v[108:111], v[68:71], v[20:23]
    ds_read_b128 v[52:55], v6 offset:33024
    v_mfma_f32_16x16x32_bf16 v[24:27], v[108:111], v[72:75], v[24:27]
    ds_read_b128 v[56:59], v6 offset:33280
    v_mfma_f32_16x16x32_bf16 v[28:31], v[108:111], v[76:79], v[28:31]
    ds_read_b128 v[60:63], v6 offset:33536
    v_mfma_f32_16x16x32_bf16 v[32:35], v[84:87], v[64:67], v[32:35]
    ds_read_b128 v[80:83], v13 offset:0
    v_mfma_f32_16x16x32_bf16 v[36:39], v[84:87], v[68:71], v[36:39]
    v_mfma_f32_16x16x32_bf16 v[40:43], v[84:87], v[72:75], v[40:43]
    v_mfma_f32_16x16x32_bf16 v[44:47], v[84:87], v[76:79], v[44:47]
    s_waitcnt vmcnt(0) lgkmcnt(0)
    v_mfma_f32_16x16x32_bf16 v[16:19], v[112:115], v[48:51], v[16:19]
    ds_read_b128 v[64:67], v6 offset:36864
    v_mfma_f32_16x16x32_bf16 v[20:23], v[112:115], v[52:55], v[20:23]
    ds_read_b128 v[68:71], v6 offset:37120
    v_mfma_f32_16x16x32_bf16 v[24:27], v[112:115], v[56:59], v[24:27]
    ds_read_b128 v[72:75], v6 offset:37376
    v_mfma_f32_16x16x32_bf16 v[28:31], v[112:115], v[60:63], v[28:31]
    ds_read_b128 v[76:79], v6 offset:37632
    v_mfma_f32_16x16x32_bf16 v[32:35], v[80:83], v[48:51], v[32:35]
    ds_read_b128 v[84:87], v13 offset:1024
    v_mfma_f32_16x16x32_bf16 v[36:39], v[80:83], v[52:55], v[36:39]
    v_mfma_f32_16x16x32_bf16 v[40:43], v[80:83], v[56:59], v[40:43]
    v_mfma_f32_16x16x32_bf16 v[44:47], v[80:83], v[60:63], v[44:47]
    s_waitcnt lgkmcnt(0)
    v_mfma_f32_16x16x32_bf16 v[16:19], v[116:119], v[64:67], v[16:19]
    s_lshl_b32 s6, s3, 7
    v_lshl_add_u32 v7, v9, 4, s6
    ds_read_b128 v[48:51], v7 offset:19456
    ds_read_b128 v[52:55], v7 offset:19520
    v_mfma_f32_16x16x32_bf16 v[20:23], v[116:119], v[68:71], v[20:23]
    v_lshlrev_b32 v7, 2, v8
    ds_read_b32 v60, v7 offset:9472
    ds_read_b32 v61, v7 offset:9536
    ds_read_b32 v62, v7 offset:9600
    ds_read_b32 v63, v7 offset:9664
    ds_read_b32 v56, v7 offset:9216
    ds_read_b32 v57, v7 offset:9280
    ds_read_b32 v58, v7 offset:9344
    ds_read_b32 v59, v7 offset:9408
    v_mfma_f32_16x16x32_bf16 v[24:27], v[116:119], v[72:75], v[24:27]
    v_mfma_f32_16x16x32_bf16 v[28:31], v[116:119], v[76:79], v[28:31]
    v_mfma_f32_16x16x32_bf16 v[32:35], v[84:87], v[64:67], v[32:35]
    v_mfma_f32_16x16x32_bf16 v[36:39], v[84:87], v[68:71], v[36:39]
    v_mfma_f32_16x16x32_bf16 v[40:43], v[84:87], v[72:75], v[40:43]
    v_mfma_f32_16x16x32_bf16 v[44:47], v[84:87], v[76:79], v[44:47]
    s_setprio 3
    s_lshl_b32 s65, s42, 11
    s_add_u32 s65, s65, s49
    s_add_u32 s65, s65, 0x16e0000
    s_mov_b32 s61, 0
Lsw_116:
    s_waitcnt lgkmcnt(0)
    v_min_u32 v7, v60, v61
    v_min3_u32 v7, v7, v62, v63
    v_cmp_eq_u32 vcc, 0, v7
    s_cbranch_vccz Lsd_117
    s_sleep 1
    v_lshlrev_b32 v7, 2, v8
    ds_read_b32 v60, v7 offset:9472
    ds_read_b32 v61, v7 offset:9536
    ds_read_b32 v62, v7 offset:9600
    ds_read_b32 v63, v7 offset:9664
    ds_read_b32 v56, v7 offset:9216
    ds_read_b32 v57, v7 offset:9280
    ds_read_b32 v58, v7 offset:9344
    ds_read_b32 v59, v7 offset:9408
    s_add_u32 s61, s61, 1
    s_cmp_lt_u32 s61, 200000
    s_cbranch_scc1 Lsw_116
    s_waitcnt lgkmcnt(0)
Lsd_117:
    v_lshlrev_b32 v7, 10, v4
    v_lshl_add_u32 v7, v10, 4, v7
    v_fma_f32 v16, -v56, v48, v16
    v_fma_f32 v17, -v56, v49, v17
    v_fma_f32 v18, -v56, v50, v18
    v_fma_f32 v19, -v56, v51, v19
    v_fma_f32 v20, -v57, v48, v20
    v_fma_f32 v21, -v57, v49, v21
    v_fma_f32 v22, -v57, v50, v22
    v_fma_f32 v23, -v57, v51, v23
    v_mul_f32 v16, v16, v60
    v_mul_f32 v17, v17, v60
    v_mul_f32 v18, v18, v60
    v_mul_f32 v19, v19, v60
    v_mul_f32 v20, v20, v61
    v_mul_f32 v21, v21, v61
    v_mul_f32 v22, v22, v61
    v_mul_f32 v23, v23, v61
    v_cvt_pk_bf16_f32 v16, v16, v17
    v_cvt_pk_bf16_f32 v17, v18, v19
    v_cvt_pk_bf16_f32 v18, v20, v21
    v_cvt_pk_bf16_f32 v19, v22, v23
    v_pk_max_i16 v16, v16, 0
    v_pk_max_i16 v17, v17, 0
    v_pk_max_i16 v18, v18, 0
    v_pk_max_i16 v19, v19, 0
    s_nop 0
    v_permlane16_swap_b32 v16, v18
    v_permlane16_swap_b32 v17, v19
    buffer_store_dwordx4 v[16:19], v7, s[28:31], s65 offen offset:0 sc1
    v_fma_f32 v24, -v58, v48, v24
    v_fma_f32 v25, -v58, v49, v25
    v_fma_f32 v26, -v58, v50, v26
    v_fma_f32 v27, -v58, v51, v27
    v_fma_f32 v28, -v59, v48, v28
    v_fma_f32 v29, -v59, v49, v29
    v_fma_f32 v30, -v59, v50, v30
    v_fma_f32 v31, -v59, v51, v31
    v_mul_f32 v24, v24, v62
    v_mul_f32 v25, v25, v62
    v_mul_f32 v26, v26, v62
    v_mul_f32 v27, v27, v62
    v_mul_f32 v28, v28, v63
    v_mul_f32 v29, v29, v63
    v_mul_f32 v30, v30, v63
    v_mul_f32 v31, v31, v63
    v_cvt_pk_bf16_f32 v24, v24, v25
    v_cvt_pk_bf16_f32 v25, v26, v27
    v_cvt_pk_bf16_f32 v26, v28, v29
    v_cvt_pk_bf16_f32 v27, v30, v31
    v_pk_max_i16 v24, v24, 0
    v_pk_max_i16 v25, v25, 0
    v_pk_max_i16 v26, v26, 0
    v_pk_max_i16 v27, v27, 0
    s_nop 0
    v_permlane16_swap_b32 v24, v26
    v_permlane16_swap_b32 v25, v27
    buffer_store_dwordx4 v[24:27], v7, s[28:31], s65 offen offset:512 sc1
    v_fma_f32 v32, -v56, v52, v32
    v_fma_f32 v33, -v56, v53, v33
    v_fma_f32 v34, -v56, v54, v34
    v_fma_f32 v35, -v56, v55, v35
    v_fma_f32 v36, -v57, v52, v36
    v_fma_f32 v37, -v57, v53, v37
    v_fma_f32 v38, -v57, v54, v38
    v_fma_f32 v39, -v57, v55, v39
    v_mul_f32 v32, v32, v60
    v_mul_f32 v33, v33, v60
    v_mul_f32 v34, v34, v60
    v_mul_f32 v35, v35, v60
    v_mul_f32 v36, v36, v61
    v_mul_f32 v37, v37, v61
    v_mul_f32 v38, v38, v61
    v_mul_f32 v39, v39, v61
    v_cvt_pk_bf16_f32 v32, v32, v33
    v_cvt_pk_bf16_f32 v33, v34, v35
    v_cvt_pk_bf16_f32 v34, v36, v37
    v_cvt_pk_bf16_f32 v35, v38, v39
    v_pk_max_i16 v32, v32, 0
    v_pk_max_i16 v33, v33, 0
    v_pk_max_i16 v34, v34, 0
    v_pk_max_i16 v35, v35, 0
    s_nop 0
    v_permlane16_swap_b32 v32, v34
    v_permlane16_swap_b32 v33, v35
    buffer_store_dwordx4 v[32:35], v7, s[28:31], s65 offen offset:2048 sc1
    v_fma_f32 v40, -v58, v52, v40
    v_fma_f32 v41, -v58, v53, v41
    v_fma_f32 v42, -v58, v54, v42
    v_fma_f32 v43, -v58, v55, v43
    v_fma_f32 v44, -v59, v52, v44
    v_fma_f32 v45, -v59, v53, v45
    v_fma_f32 v46, -v59, v54, v46
    v_fma_f32 v47, -v59, v55, v47
    v_mul_f32 v40, v40, v62
    v_mul_f32 v41, v41, v62
    v_mul_f32 v42, v42, v62
    v_mul_f32 v43, v43, v62
    v_mul_f32 v44, v44, v63
    v_mul_f32 v45, v45, v63
    v_mul_f32 v46, v46, v63
    v_mul_f32 v47, v47, v63
    v_cvt_pk_bf16_f32 v40, v40, v41
    v_cvt_pk_bf16_f32 v41, v42, v43
    v_cvt_pk_bf16_f32 v42, v44, v45
    v_cvt_pk_bf16_f32 v43, v46, v47
    v_pk_max_i16 v40, v40, 0
    v_pk_max_i16 v41, v41, 0
    v_pk_max_i16 v42, v42, 0
    v_pk_max_i16 v43, v43, 0
    s_nop 0
    v_permlane16_swap_b32 v40, v42
    v_permlane16_swap_b32 v41, v43
    buffer_store_dwordx4 v[40:43], v7, s[28:31], s65 offen offset:2560 sc1
    v_mov_b32 v7, 9732
    v_mov_b32 v0, 1
    s_mov_b64 exec, 1
    ds_add_u32 v7, v0
    s_mov_b64 exec, -1
    s_waitcnt vmcnt(0)
Lg2_85:
    s_add_u32 s62, s41, 9
    v_mov_b32 v0, s62
    v_writelane_b32 v0, s27, 1
    v_lshlrev_b32 v12, 2, v1
    s_mov_b32 exec_hi, 0
    s_add_u32 s62, s45, 0x80000
    buffer_store_dword v0, v12, s[28:31], s62 offen
    s_cmp_eq_u32 s26, 0
    s_cbranch_scc1 Lng_118
    buffer_store_dword v0, v12, s[28:31], s45 offen sc1
Lng_118:
    s_mov_b32 exec_hi, -1
    s_lshl_b32 s7, s3, 11
    s_lshl_b32 s67, s4, 13
    s_cmp_eq_u32 s26, 0
    s_cselect_b32 s6, 0x80000, 0
    s_add_u32 s67, s67, s6
    s_add_u32 s67, s67, s7
    v_and_b32 v11, 3, v1
    v_min_u32 v11, 2, v11
    v_lshlrev_b32 v11, 7, v11
    v_lshl_add_u32 v11, v4, 10, v11
    s_add_u32 s60, s67, 0x75e200
    buffer_load_dword v11, v11, s[28:31], s60 offen sc1
    s_add_u32 s59, s41, 9
    s_waitcnt vmcnt(0)
    s_mov_b32 s61, 0
Lpoll_119:
    v_subrev_u32 v11, s59, v11
    v_cmp_le_u32 vcc, 16, v11
    s_cbranch_vccz Lpd_120
    s_sleep 2
    v_and_b32 v11, 3, v1
    v_min_u32 v11, 2, v11
    v_lshlrev_b32 v11, 7, v11
    v_lshl_add_u32 v11, v4, 10, v11
    s_add_u32 s60, s67, 0x75e200
    buffer_load_dword v11, v11, s[28:31], s60 offen sc1
    s_waitcnt vmcnt(0)
    s_add_u32 s61, s61, 1
    s_cmp_lt_u32 s61, 200000
    s_cbranch_scc1 Lpoll_119
Lpd_120:
    v_add_u32 v12, 0x16e0000, v3
    v_add_u32 v13, s69, v2
    v_add_u32 v11, 81920, v13
    buffer_load_dwordx4 v[96:99], v12, s[28:31], s8 offen offset:0 sc1
    buffer_load_dwordx4 v[100:103], v12, s[28:31], s9 offen offset:0 sc1
    buffer_load_dwordx4 v[104:107], v12, s[28:31], s10 offen offset:0 sc1
    buffer_load_dwordx4 v[108:111], v12, s[28:31], s11 offen offset:0 sc1
    buffer_load_dwordx4 v[112:115], v12, s[28:31], s12 offen offset:0 sc1
    buffer_load_dwordx4 v[116:119], v12, s[28:31], s13 offen offset:0 sc1
    buffer_load_dwordx4 v[120:123], v12, s[28:31], s8 offen offset:256 sc1
    buffer_load_dwordx4 v[124:127], v12, s[28:31], s9 offen offset:256 sc1
    buffer_load_dwordx4 v[128:131], v12, s[28:31], s10 offen offset:256 sc1
    buffer_load_dwordx4 v[132:135], v12, s[28:31], s11 offen offset:256 sc1
    s_mov_b32 s61, 0
Lcw_121:
    v_mov_b32 v7, 9732
    ds_read_b32 v7, v7
    s_waitcnt lgkmcnt(0)
    v_cmp_gt_u32 vcc, 8, v7
    s_cbranch_vccz Lcd_122
    s_sleep 1
    s_add_u32 s61, s61, 1
    s_cmp_lt_u32 s61, 200000
    s_cbranch_scc1 Lcw_121
Lcd_122:
    v_mov_b32 v7, 9732
    v_mov_b32 v0, 1
    s_mov_b64 exec, 1
    ds_add_u32 v7, v0
    s_mov_b64 exec, -1
    s_setprio 0
    s_waitcnt vmcnt(9)
    v_mfma_f32_16x16x32_bf16 v[16:19], v[136:139], v[96:99], 0
    s_add_u32 m0, s69, 0
    s_add_u32 s64, s12, 256
    buffer_load_dwordx4 v12, s[28:31], s64 offen sc1 lds
    v_mfma_f32_16x16x32_bf16 v[20:23], v[140:143], v[96:99], 0
    s_add_u32 m0, s69, 1024
    s_add_u32 s64, s13, 256
    buffer_load_dwordx4 v12, s[28:31], s64 offen sc1 lds
    v_mfma_f32_16x16x32_bf16 v[24:27], v[144:147], v[96:99], 0
    v_mfma_f32_16x16x32_bf16 v[28:31], v[148:151], v[96:99], 0
    v_mfma_f32_16x16x32_bf16 v[32:35], v[152:155], v[96:99], 0
    s_waitcnt vmcnt(10)
    v_mfma_f32_16x16x32_bf16 v[16:19], v[156:159], v[100:103], v[16:19]
    s_add_u32 m0, s69, 2048
    s_add_u32 s64, s8, 512
    buffer_load_dwordx4 v12, s[28:31], s64 offen sc1 lds
    v_mfma_f32_16x16x32_bf16 v[20:23], v[160:163], v[100:103], v[20:23]
    s_add_u32 m0, s69, 3072
    s_add_u32 s64, s9, 512
    buffer_load_dwordx4 v12, s[28:31], s64 offen sc1 lds
    v_mfma_f32_16x16x32_bf16 v[24:27], v[164:167], v[100:103], v[24:27]
    buffer_load_dwordx4 v[96:99], v12, s[28:31], s9 offen offset:768 sc1
    v_mfma_f32_16x16x32_bf16 v[28:31], v[168:171], v[100:103], v[28:31]
    v_mfma_f32_16x16x32_bf16 v[32:35], v[172:175], v[100:103], v[32:35]
    s_waitcnt vmcnt(12)
    v_mfma_f32_16x16x32_bf16 v[16:19], v[176:179], v[104:107], v[16:19]
    s_add_u32 m0, s69, 4096
    s_add_u32 s64, s10, 512
    buffer_load_dwordx4 v12, s[28:31], s64 offen sc1 lds
    v_mfma_f32_16x16x32_bf16 v[20:23], v[180:183], v[104:107], v[20:23]
    s_add_u32 m0, s69, 5120
    s_add_u32 s64, s11, 512
    buffer_load_dwordx4 v12, s[28:31], s64 offen sc1 lds
    v_mfma_f32_16x16x32_bf16 v[24:27], v[184:187], v[104:107], v[24:27]
    buffer_load_dwordx4 v[100:103], v12, s[28:31], s10 offen offset:768 sc1
    v_mfma_f32_16x16x32_bf16 v[28:31], v[188:191], v[104:107], v[28:31]
    v_mfma_f32_16x16x32_bf16 v[32:35], v[192:195], v[104:107], v[32:35]
    s_waitcnt vmcnt(14)
    v_mfma_f32_16x16x32_bf16 v[16:19], v[196:199], v[108:111], v[16:19]
    s_add_u32 m0, s69, 6144
    s_add_u32 s64, s12, 512
    buffer_load_dwordx4 v12, s[28:31], s64 offen sc1 lds
    v_mfma_f32_16x16x32_bf16 v[20:23], v[200:203], v[108:111], v[20:23]
    s_add_u32 m0, s69, 7168
    s_add_u32 s64, s13, 512
    buffer_load_dwordx4 v12, s[28:31], s64 offen sc1 lds
    v_mfma_f32_16x16x32_bf16 v[24:27], v[204:207], v[108:111], v[24:27]
    buffer_load_dwordx4 v[104:107], v12, s[28:31], s11 offen offset:768 sc1
    v_mfma_f32_16x16x32_bf16 v[28:31], v[208:211], v[108:111], v[28:31]
    v_mfma_f32_16x16x32_bf16 v[32:35], v[212:215], v[108:111], v[32:35]
    s_waitcnt vmcnt(16)
    v_mfma_f32_16x16x32_bf16 v[16:19], v[216:219], v[112:115], v[16:19]
    s_add_u32 m0, s69, 8192
    s_add_u32 s64, s8, 768
    buffer_load_dwordx4 v12, s[28:31], s64 offen sc1 lds
    v_mfma_f32_16x16x32_bf16 v[20:23], v[220:223], v[112:115], v[20:23]
    buffer_load_dwordx4 v[108:111], v12, s[28:31], s12 offen offset:768 sc1
    v_mfma_f32_16x16x32_bf16 v[24:27], v[224:227], v[112:115], v[24:27]
    v_mfma_f32_16x16x32_bf16 v[28:31], v[228:231], v[112:115], v[28:31]
    v_mfma_f32_16x16x32_bf16 v[32:35], v[232:235], v[112:115], v[32:35]
    s_waitcnt vmcnt(17)
    v_mfma_f32_16x16x32_bf16 v[16:19], v[236:239], v[116:119], v[16:19]
    buffer_load_dwordx4 v[112:115], v12, s[28:31], s13 offen offset:768 sc1
    v_mfma_f32_16x16x32_bf16 v[20:23], v[240:243], v[116:119], v[20:23]
    v_mfma_f32_16x16x32_bf16 v[24:27], v[244:247], v[116:119], v[24:27]
    v_mfma_f32_16x16x32_bf16 v[28:31], v[248:251], v[116:119], v[28:31]
    v_mfma_f32_16x16x32_bf16 v[32:35], v[252:255], v[116:119], v[32:35]
    s_waitcnt vmcnt(17)
    v_mfma_f32_16x16x32_bf16 v[36:39], v[136:139], v[120:123], 0
    v_mfma_f32_16x16x32_bf16 v[40:43], v[140:143], v[120:123], 0
    v_mfma_f32_16x16x32_bf16 v[44:47], v[144:147], v[120:123], 0
    v_mfma_f32_16x16x32_bf16 v[48:51], v[148:151], v[120:123], 0
    v_mfma_f32_16x16x32_bf16 v[52:55], v[152:155], v[120:123], 0
    s_waitcnt vmcnt(13)
    v_mfma_f32_16x16x32_bf16 v[36:39], v[156:159], v[124:127], v[36:39]
    ds_read_b128 v[120:123], v13 offset:0
    v_mfma_f32_16x16x32_bf16 v[40:43], v[160:163], v[124:127], v[40:43]
    ds_write_b128 v11, v[16:19] offset:0
    v_mfma_f32_16x16x32_bf16 v[44:47], v[164:167], v[124:127], v[44:47]
    ds_write_b128 v11, v[20:23] offset:1024
    v_mfma_f32_16x16x32_bf16 v[48:51], v[168:171], v[124:127], v[48:51]
    v_mfma_f32_16x16x32_bf16 v[52:55], v[172:175], v[124:127], v[52:55]
    s_waitcnt vmcnt(12)
    v_mfma_f32_16x16x32_bf16 v[36:39], v[176:179], v[128:131], v[36:39]
    ds_read_b128 v[124:127], v13 offset:1024
    v_mfma_f32_16x16x32_bf16 v[40:43], v[180:183], v[128:131], v[40:43]
    ds_write_b128 v11, v[24:27] offset:2048
    v_mfma_f32_16x16x32_bf16 v[44:47], v[184:187], v[128:131], v[44:47]
    ds_write_b128 v11, v[28:31] offset:3072
    v_mfma_f32_16x16x32_bf16 v[48:51], v[188:191], v[128:131], v[48:51]
    v_mfma_f32_16x16x32_bf16 v[52:55], v[192:195], v[128:131], v[52:55]
    s_waitcnt vmcnt(11)
    v_mfma_f32_16x16x32_bf16 v[36:39], v[196:199], v[132:135], v[36:39]
    ds_read_b128 v[128:131], v13 offset:2048
    v_mfma_f32_16x16x32_bf16 v[40:43], v[200:203], v[132:135], v[40:43]
    ds_write_b128 v11, v[32:35] offset:4096
    v_mfma_f32_16x16x32_bf16 v[44:47], v[204:207], v[132:135], v[44:47]
    v_mfma_f32_16x16x32_bf16 v[48:51], v[208:211], v[132:135], v[48:51]
    v_mfma_f32_16x16x32_bf16 v[52:55], v[212:215], v[132:135], v[52:55]
    s_waitcnt vmcnt(10) lgkmcnt(7)
    v_mfma_f32_16x16x32_bf16 v[36:39], v[216:219], v[120:123], v[36:39]
    ds_read_b128 v[132:135], v13 offset:3072
    v_mfma_f32_16x16x32_bf16 v[40:43], v[220:223], v[120:123], v[40:43]
    v_mfma_f32_16x16x32_bf16 v[44:47], v[224:227], v[120:123], v[44:47]
    v_mfma_f32_16x16x32_bf16 v[48:51], v[228:231], v[120:123], v[48:51]
    v_mfma_f32_16x16x32_bf16 v[52:55], v[232:235], v[120:123], v[52:55]
    s_waitcnt vmcnt(8) lgkmcnt(5)
    v_mfma_f32_16x16x32_bf16 v[36:39], v[236:239], v[124:127], v[36:39]
    ds_read_b128 v[120:123], v13 offset:4096
    v_mfma_f32_16x16x32_bf16 v[40:43], v[240:243], v[124:127], v[40:43]
    v_mfma_f32_16x16x32_bf16 v[44:47], v[244:247], v[124:127], v[44:47]
    v_mfma_f32_16x16x32_bf16 v[48:51], v[248:251], v[124:127], v[48:51]
    v_mfma_f32_16x16x32_bf16 v[52:55], v[252:255], v[124:127], v[52:55]
    s_waitcnt vmcnt(7) lgkmcnt(3)
    v_mfma_f32_16x16x32_bf16 v[56:59], v[136:139], v[128:131], 0
    ds_read_b128 v[124:127], v13 offset:5120
    v_mfma_f32_16x16x32_bf16 v[60:63], v[140:143], v[128:131], 0
    v_mfma_f32_16x16x32_bf16 v[64:67], v[144:147], v[128:131], 0
    v_mfma_f32_16x16x32_bf16 v[68:71], v[148:151], v[128:131], 0
    v_mfma_f32_16x16x32_bf16 v[72:75], v[152:155], v[128:131], 0
    s_waitcnt vmcnt(5) lgkmcnt(2)
    v_mfma_f32_16x16x32_bf16 v[56:59], v[156:159], v[132:135], v[56:59]
    ds_read_b128 v[128:131], v13 offset:6144
    v_mfma_f32_16x16x32_bf16 v[60:63], v[160:163], v[132:135], v[60:63]
    ds_write_b128 v11, v[36:39] offset:5120
    v_mfma_f32_16x16x32_bf16 v[64:67], v[164:167], v[132:135], v[64:67]
    ds_write_b128 v11, v[40:43] offset:6144
    v_mfma_f32_16x16x32_bf16 v[68:71], v[168:171], v[132:135], v[68:71]
    v_mfma_f32_16x16x32_bf16 v[72:75], v[172:175], v[132:135], v[72:75]
    s_waitcnt vmcnt(4) lgkmcnt(4)
    v_mfma_f32_16x16x32_bf16 v[56:59], v[176:179], v[120:123], v[56:59]
    ds_read_b128 v[132:135], v13 offset:7168
    v_mfma_f32_16x16x32_bf16 v[60:63], v[180:183], v[120:123], v[60:63]
    ds_write_b128 v11, v[44:47] offset:7168
    v_mfma_f32_16x16x32_bf16 v[64:67], v[184:187], v[120:123], v[64:67]
    ds_write_b128 v11, v[48:51] offset:8192
    v_mfma_f32_16x16x32_bf16 v[68:71], v[188:191], v[120:123], v[68:71]
    v_mfma_f32_16x16x32_bf16 v[72:75], v[192:195], v[120:123], v[72:75]
    s_waitcnt vmcnt(2) lgkmcnt(6)
    v_mfma_f32_16x16x32_bf16 v[56:59], v[196:199], v[124:127], v[56:59]
    ds_read_b128 v[120:123], v13 offset:8192
    v_mfma_f32_16x16x32_bf16 v[60:63], v[200:203], v[124:127], v[60:63]
    ds_write_b128 v11, v[52:55] offset:9216
    v_mfma_f32_16x16x32_bf16 v[64:67], v[204:207], v[124:127], v[64:67]
    v_mfma_f32_16x16x32_bf16 v[68:71], v[208:211], v[124:127], v[68:71]
    v_mfma_f32_16x16x32_bf16 v[72:75], v[212:215], v[124:127], v[72:75]
    s_waitcnt lgkmcnt(7)
    v_mfma_f32_16x16x32_bf16 v[56:59], v[216:219], v[128:131], v[56:59]
    v_mfma_f32_16x16x32_bf16 v[60:63], v[220:223], v[128:131], v[60:63]
    v_mfma_f32_16x16x32_bf16 v[64:67], v[224:227], v[128:131], v[64:67]
    v_mfma_f32_16x16x32_bf16 v[68:71], v[228:231], v[128:131], v[68:71]
    v_mfma_f32_16x16x32_bf16 v[72:75], v[232:235], v[128:131], v[72:75]
    s_waitcnt lgkmcnt(4)
    v_mfma_f32_16x16x32_bf16 v[56:59], v[236:239], v[132:135], v[56:59]
    v_mfma_f32_16x16x32_bf16 v[60:63], v[240:243], v[132:135], v[60:63]
    v_mfma_f32_16x16x32_bf16 v[64:67], v[244:247], v[132:135], v[64:67]
    v_mfma_f32_16x16x32_bf16 v[68:71], v[248:251], v[132:135], v[68:71]
    v_mfma_f32_16x16x32_bf16 v[72:75], v[252:255], v[132:135], v[72:75]
    s_waitcnt lgkmcnt(1)
    v_mfma_f32_16x16x32_bf16 v[76:79], v[136:139], v[120:123], 0
    v_mfma_f32_16x16x32_bf16 v[80:83], v[140:143], v[120:123], 0
    v_mfma_f32_16x16x32_bf16 v[84:87], v[144:147], v[120:123], 0
    v_mfma_f32_16x16x32_bf16 v[88:91], v[148:151], v[120:123], 0
    v_mfma_f32_16x16x32_bf16 v[92:95], v[152:155], v[120:123], 0
    v_mfma_f32_16x16x32_bf16 v[76:79], v[156:159], v[96:99], v[76:79]
    ds_write_b128 v13, v[56:59] offset:0
    v_mfma_f32_16x16x32_bf16 v[80:83], v[160:163], v[96:99], v[80:83]
    ds_write_b128 v13, v[60:63] offset:1024
    v_mfma_f32_16x16x32_bf16 v[84:87], v[164:167], v[96:99], v[84:87]
    v_mfma_f32_16x16x32_bf16 v[88:91], v[168:171], v[96:99], v[88:91]
    v_mfma_f32_16x16x32_bf16 v[92:95], v[172:175], v[96:99], v[92:95]
    v_mfma_f32_16x16x32_bf16 v[76:79], v[176:179], v[100:103], v[76:79]
    ds_write_b128 v13, v[64:67] offset:2048
    v_mfma_f32_16x16x32_bf16 v[80:83], v[180:183], v[100:103], v[80:83]
    ds_write_b128 v13, v[68:71] offset:3072
    v_mfma_f32_16x16x32_bf16 v[84:87], v[184:187], v[100:103], v[84:87]
    v_mfma_f32_16x16x32_bf16 v[88:91], v[188:191], v[100:103], v[88:91]
    v_mfma_f32_16x16x32_bf16 v[92:95], v[192:195], v[100:103], v[92:95]
    v_mfma_f32_16x16x32_bf16 v[76:79], v[196:199], v[104:107], v[76:79]
    ds_write_b128 v13, v[72:75] offset:4096
    v_mfma_f32_16x16x32_bf16 v[80:83], v[200:203], v[104:107], v[80:83]
    v_mfma_f32_16x16x32_bf16 v[84:87], v[204:207], v[104:107], v[84:87]
    v_mfma_f32_16x16x32_bf16 v[88:91], v[208:211], v[104:107], v[88:91]
    v_mfma_f32_16x16x32_bf16 v[92:95], v[212:215], v[104:107], v[92:95]
    s_waitcnt vmcnt(1)
    v_mfma_f32_16x16x32_bf16 v[76:79], v[216:219], v[108:111], v[76:79]
    v_mfma_f32_16x16x32_bf16 v[80:83], v[220:223], v[108:111], v[80:83]
    v_mfma_f32_16x16x32_bf16 v[84:87], v[224:227], v[108:111], v[84:87]
    v_mfma_f32_16x16x32_bf16 v[88:91], v[228:231], v[108:111], v[88:91]
    v_mfma_f32_16x16x32_bf16 v[92:95], v[232:235], v[108:111], v[92:95]
    s_waitcnt vmcnt(0)
    v_mfma_f32_16x16x32_bf16 v[76:79], v[236:239], v[112:115], v[76:79]
    v_mfma_f32_16x16x32_bf16 v[80:83], v[240:243], v[112:115], v[80:83]
    v_mfma_f32_16x16x32_bf16 v[84:87], v[244:247], v[112:115], v[84:87]
    v_mfma_f32_16x16x32_bf16 v[88:91], v[248:251], v[112:115], v[88:91]
    v_mfma_f32_16x16x32_bf16 v[92:95], v[252:255], v[112:115], v[92:95]
    s_setprio 3
    s_nop 2
    ds_write_b128 v13, v[76:79] offset:5120
    ds_write_b128 v13, v[80:83] offset:6144
    ds_write_b128 v13, v[84:87] offset:7168
    ds_write_b128 v13, v[88:91] offset:8192
    ds_write_b128 v13, v[92:95] offset:9216
    s_branch Ljoin_86
LS_83:
    s_add_u32 s62, s41, 8
    v_mov_b32 v0, s62
    v_writelane_b32 v0, s27, 1
    v_lshlrev_b32 v12, 2, v1
    s_mov_b32 exec_hi, 0
    s_add_u32 s62, s45, 0x80000
    buffer_store_dword v0, v12, s[28:31], s62 offen
    s_cmp_eq_u32 s26, 0
    s_cbranch_scc1 Lng_123
    buffer_store_dword v0, v12, s[28:31], s45 offen sc1
Lng_123:
    s_mov_b32 exec_hi, -1
    s_setprio 3
    s_waitcnt vmcnt(1)
    v_mov_b32 v7, 9728
    v_mov_b32 v0, 1
    s_mov_b64 exec, 1
    ds_add_u32 v7, v0
    s_mov_b64 exec, -1
    s_lshl_b32 s67, s4, 13
    s_cmp_eq_u32 s26, 0
    s_cselect_b32 s6, 0x80000, 0
    s_add_u32 s67, s67, s6
    s_add_u32 s60, s67, 0x760380
    s_add_u32 s59, s41, 8
    s_mov_b32 s61, 0
Lsp_124:
    v_and_b32 v7, 7, v1
    v_lshlrev_b32 v7, 10, v7
    buffer_load_dword v7, v7, s[28:31], s60 offen sc1
    s_waitcnt vmcnt(0)
    v_subrev_u32 v7, s59, v7
    v_cmp_le_u32 vcc, 16, v7
    s_cbranch_vccz Lsd_125
    s_sleep 2
    s_add_u32 s61, s61, 1
    s_cmp_lt_u32 s61, 200000
    s_cbranch_scc1 Lsp_124
Lsd_125:
    v_lshlrev_b32 v7, 3, v1
    buffer_load_dwordx2 v[16:17], v7, s[28:31], s65 offen offset:0 sc1
    buffer_load_dwordx2 v[18:19], v7, s[28:31], s65 offen offset:512 sc1
    buffer_load_dwordx2 v[20:21], v7, s[28:31], s65 offen offset:1024 sc1
    buffer_load_dwordx2 v[22:23], v7, s[28:31], s65 offen offset:1536 sc1
    buffer_load_dwordx2 v[24:25], v7, s[28:31], s65 offen offset:2048 sc1
    buffer_load_dwordx2 v[26:27], v7, s[28:31], s65 offen offset:2560 sc1
    buffer_load_dwordx2 v[28:29], v7, s[28:31], s65 offen offset:3072 sc1
    buffer_load_dwordx2 v[30:31], v7, s[28:31], s65 offen offset:3584 sc1
    v_lshlrev_b32 v7, 2, v1
    s_mov_b32 s7, 0x3acccccd
    s_waitcnt vmcnt(0)
    v_add_f32 v16, v16, v18
    v_add_f32 v17, v17, v19
    v_add_f32 v16, v16, v20
    v_add_f32 v17, v17, v21
    v_add_f32 v16, v16, v22
    v_add_f32 v17, v17, v23
    v_add_f32 v16, v16, v24
    v_add_f32 v17, v17, v25
    v_add_f32 v16, v16, v26
    v_add_f32 v17, v17, v27
    v_add_f32 v16, v16, v28
    v_add_f32 v17, v17, v29
    v_add_f32 v16, v16, v30
    v_add_f32 v17, v17, v31
    v_mul_f32 v16, s7, v16
    v_mul_f32 v17, s7, v17
    v_fma_f32 v17, -v16, v16, v17
    v_max_f32 v17, 0, v17
    v_add_f32 v17, 0x3727c5ac, v17
    v_rsq_f32 v17, v17
    ds_write_b32 v7, v16 offset:9216
    ds_write_b32 v7, v17 offset:9472
    s_mov_b32 s61, 0
Lcw_126:
    v_mov_b32 v7, 9728
    ds_read_b32 v7, v7
    s_waitcnt lgkmcnt(0)
    v_cmp_gt_u32 vcc, 4, v7
    s_cbranch_vccz Lcd_127
    s_sleep 1
    s_add_u32 s61, s61, 1
    s_cmp_lt_u32 s61, 200000
    s_cbranch_scc1 Lcw_126
Lcd_127:
    s_setprio 0
    s_cmp_ge_u32 s5, 4
    s_cselect_b64 s[70:71], -1, 0
    v_and_b32 v11, 7, v8
    v_sub_u32 v12, 8, v11
    v_cndmask_b32 v12, v11, v12, s[70:71]
    v_lshrrev_b32 v13, 3, v8
    v_add_u32 v0, 2, v13
    v_cmp_eq_u32 vcc, 0, v11
    s_nop 1
    v_cndmask_b32 v12, v12, 0, vcc
    v_cndmask_b32 v13, v13, v0, vcc
    v_and_b32 v0, 1, v12
    v_lshlrev_b32 v0, 4, v0
    v_mov_b32 v36, 0x3f80
    v_lshlrev_b32 v0, v0, v36
    v_cmp_eq_u32 vcc, v13, v9
    s_nop 1
    v_cndmask_b32 v0, 0, v0, vcc
    v_lshrrev_b32 v12, 1, v12
    v_cmp_eq_u32 vcc, 0, v12
    s_nop 1
    v_cndmask_b32 v32, 0, v0, vcc
    v_cmp_eq_u32 vcc, 1, v12
    s_nop 1
    v_cndmask_b32 v33, 0, v0, vcc
    v_cmp_eq_u32 vcc, 2, v12
    s_nop 1
    v_cndmask_b32 v34, 0, v0, vcc
    v_cmp_eq_u32 vcc, 3, v12
    s_nop 1
    v_cndmask_b32 v35, 0, v0, vcc
    ds_write_b128 v2, v[32:35] offset:29696
    v_lshlrev_b32 v37, 2, v1
    s_mul_i32 s6, s5, 10
    v_cmp_le_u32 s[72:73], 2, v9
    v_and_b32 v11, 1, v9
    v_add3_u32 v11, v11, s6, 0
    v_sub_u32 v12, 119, v11
    v_cndmask_b32 v12, v11, v12, s[70:71]
    v_sub_u32 v13, 120, v11
    v_cndmask_b32 v13, v11, v13, s[70:71]
    v_cmp_eq_u32 vcc, 0, v13
    s_nop 1
    v_cndmask_b32 v13, v13, 40, vcc
    v_cmp_eq_u32 vcc, 80, v13
    s_nop 1
    v_cndmask_b32 v13, v13, 0, vcc
    v_cndmask_b32 v12, v12, v13, s[72:73]
    v_mul_u32_u24 v13, 13108, v12
    v_lshrrev_b32 v13, 16, v13
    v_sub_u32 v11, v12, v13
    v_mul_u32_u24 v0, 5, v13
    v_sub_u32 v12, v12, v0
    v_and_b32 v0, 7, v13
    v_lshrrev_b32 v13, 3, v13
    v_lshl_add_u32 v13, v0, 1, v13
    v_add_u32 v13, 64, v13
    v_cmp_eq_u32 vcc, 4, v12
    s_nop 1
    v_cndmask_b32 v11, v11, v13, vcc
    v_lshlrev_b32 v11, 10, v11
    v_lshl_add_u32 v11, v8, 4, v11
    v_add_u32 v11, 81920, v11
    ds_write_b32 v37, v11 offset:39936
    v_and_b32 v11, 1, v9
    v_add3_u32 v11, v11, s6, 2
    v_sub_u32 v12, 119, v11
    v_cndmask_b32 v12, v11, v12, s[70:71]
    v_sub_u32 v13, 120, v11
    v_cndmask_b32 v13, v11, v13, s[70:71]
    v_cndmask_b32 v12, v12, v13, s[72:73]
    v_mul_u32_u24 v13, 13108, v12
    v_lshrrev_b32 v13, 16, v13
    v_sub_u32 v11, v12, v13
    v_mul_u32_u24 v0, 5, v13
    v_sub_u32 v12, v12, v0
    v_and_b32 v0, 7, v13
    v_lshrrev_b32 v13, 3, v13
    v_lshl_add_u32 v13, v0, 1, v13
    v_add_u32 v13, 64, v13
    v_cmp_eq_u32 vcc, 4, v12
    s_nop 1
    v_cndmask_b32 v11, v11, v13, vcc
    v_lshlrev_b32 v11, 10, v11
    v_lshl_add_u32 v11, v8, 4, v11
    v_add_u32 v11, 81920, v11
    ds_write_b32 v37, v11 offset:40192
    v_and_b32 v11, 1, v9
    v_add3_u32 v11, v11, s6, 4
    v_sub_u32 v12, 119, v11
    v_cndmask_b32 v12, v11, v12, s[70:71]
    v_sub_u32 v13, 120, v11
    v_cndmask_b32 v13, v11, v13, s[70:71]
    v_cndmask_b32 v12, v12, v13, s[72:73]
    v_mul_u32_u24 v13, 13108, v12
    v_lshrrev_b32 v13, 16, v13
    v_sub_u32 v11, v12, v13
    v_mul_u32_u24 v0, 5, v13
    v_sub_u32 v12, v12, v0
    v_and_b32 v0, 7, v13
    v_lshrrev_b32 v13, 3, v13
    v_lshl_add_u32 v13, v0, 1, v13
    v_add_u32 v13, 64, v13
    v_cmp_eq_u32 vcc, 4, v12
    s_nop 1
    v_cndmask_b32 v11, v11, v13, vcc
    v_lshlrev_b32 v11, 10, v11
    v_lshl_add_u32 v11, v8, 4, v11
    v_add_u32 v11, 81920, v11
    ds_write_b32 v37, v11 offset:40448
    v_and_b32 v11, 1, v9
    v_add3_u32 v11, v11, s6, 6
    v_sub_u32 v12, 119, v11
    v_cndmask_b32 v12, v11, v12, s[70:71]
    v_sub_u32 v13, 120, v11
    v_cndmask_b32 v13, v11, v13, s[70:71]
    v_cndmask_b32 v12, v12, v13, s[72:73]
    v_mul_u32_u24 v13, 13108, v12
    v_lshrrev_b32 v13, 16, v13
    v_sub_u32 v11, v12, v13
    v_mul_u32_u24 v0, 5, v13
    v_sub_u32 v12, v12, v0
    v_and_b32 v0, 7, v13
    v_lshrrev_b32 v13, 3, v13
    v_lshl_add_u32 v13, v0, 1, v13
    v_add_u32 v13, 64, v13
    v_cmp_eq_u32 vcc, 4, v12
    s_nop 1
    v_cndmask_b32 v11, v11, v13, vcc
    v_lshlrev_b32 v11, 10, v11
    v_lshl_add_u32 v11, v8, 4, v11
    v_add_u32 v11, 81920, v11
    ds_write_b32 v37, v11 offset:40704
    v_and_b32 v11, 1, v9
    v_add3_u32 v11, v11, s6, 8
    v_sub_u32 v12, 119, v11
    v_cndmask_b32 v12, v11, v12, s[70:71]
    v_sub_u32 v13, 120, v11
    v_cndmask_b32 v13, v11, v13, s[70:71]
    v_cndmask_b32 v12, v12, v13, s[72:73]
    v_mul_u32_u24 v13, 13108, v12
    v_lshrrev_b32 v13, 16, v13
    v_sub_u32 v11, v12, v13
    v_mul_u32_u24 v0, 5, v13
    v_sub_u32 v12, v12, v0
    v_and_b32 v0, 7, v13
    v_lshrrev_b32 v13, 3, v13
    v_lshl_add_u32 v13, v0, 1, v13
    v_add_u32 v13, 64, v13
    v_cmp_eq_u32 vcc, 4, v12
    s_nop 1
    v_cndmask_b32 v11, v11, v13, vcc
    v_lshlrev_b32 v11, 10, v11
    v_lshl_add_u32 v11, v8, 4, v11
    v_add_u32 v11, 81920, v11
    ds_write_b32 v37, v11 offset:50176
    v_lshlrev_b32 v7, 2, v1
    ds_read_b128 v[96:99], v2 offset:29696
    ds_read_b32 v0, v7 offset:39936
    ds_read_b32 v11, v7 offset:40192
    ds_read_b32 v12, v7 offset:40448
    ds_read_b32 v13, v7 offset:40704
    ds_read_b32 v7, v7 offset:50176
    s_waitcnt lgkmcnt(0)
    ds_read_b128 v[100:103], v0 offset:0
    ds_read_b128 v[104:107], v0 offset:256
    ds_read_b128 v[108:111], v0 offset:512
    ds_read_b128 v[112:115], v0 offset:768
    ds_read_b128 v[116:119], v11 offset:0
    ds_read_b128 v[120:123], v11 offset:256
    ds_read_b128 v[124:127], v11 offset:512
    ds_read_b128 v[128:131], v11 offset:768
    s_waitcnt lgkmcnt(4)
    v_mfma_f32_16x16x32_bf16 v[16:19], v[96:99], v[100:103], 0
    v_mfma_f32_16x16x32_bf16 v[36:39], v[96:99], v[104:107], 0
    v_mfma_f32_16x16x32_bf16 v[56:59], v[96:99], v[108:111], 0
    v_mfma_f32_16x16x32_bf16 v[76:79], v[96:99], v[112:115], 0
    ds_read_b128 v[100:103], v12 offset:0
    ds_read_b128 v[104:107], v12 offset:256
    ds_read_b128 v[108:111], v12 offset:512
    ds_read_b128 v[112:115], v12 offset:768
    s_waitcnt lgkmcnt(4)
    v_mfma_f32_16x16x32_bf16 v[20:23], v[96:99], v[116:119], 0
    v_mfma_f32_16x16x32_bf16 v[40:43], v[96:99], v[120:123], 0
    v_mfma_f32_16x16x32_bf16 v[60:63], v[96:99], v[124:127], 0
    v_mfma_f32_16x16x32_bf16 v[80:83], v[96:99], v[128:131], 0
    ds_read_b128 v[116:119], v13 offset:0
    ds_read_b128 v[120:123], v13 offset:256
    ds_read_b128 v[124:127], v13 offset:512
    ds_read_b128 v[128:131], v13 offset:768
    s_waitcnt lgkmcnt(4)
    v_mfma_f32_16x16x32_bf16 v[24:27], v[96:99], v[100:103], 0
    v_mfma_f32_16x16x32_bf16 v[44:47], v[96:99], v[104:107], 0
    v_mfma_f32_16x16x32_bf16 v[64:67], v[96:99], v[108:111], 0
    v_mfma_f32_16x16x32_bf16 v[84:87], v[96:99], v[112:115], 0
    ds_read_b128 v[100:103], v7 offset:0
    ds_read_b128 v[104:107], v7 offset:256
    ds_read_b128 v[108:111], v7 offset:512
    ds_read_b128 v[112:115], v7 offset:768
    s_waitcnt lgkmcnt(4)
    v_mfma_f32_16x16x32_bf16 v[28:31], v[96:99], v[116:119], 0
    v_mfma_f32_16x16x32_bf16 v[48:51], v[96:99], v[120:123], 0
    v_mfma_f32_16x16x32_bf16 v[68:71], v[96:99], v[124:127], 0
    v_mfma_f32_16x16x32_bf16 v[88:91], v[96:99], v[128:131], 0
    s_waitcnt lgkmcnt(0)
    v_mfma_f32_16x16x32_bf16 v[32:35], v[96:99], v[100:103], 0
    v_mfma_f32_16x16x32_bf16 v[52:55], v[96:99], v[104:107], 0
    v_mfma_f32_16x16x32_bf16 v[72:75], v[96:99], v[108:111], 0
    v_mfma_f32_16x16x32_bf16 v[92:95], v[96:99], v[112:115], 0
    s_setprio 0
    v_mov_b32 v7, 9732
    v_mov_b32 v0, 1
    s_mov_b64 exec, 1
    ds_add_u32 v7, v0
    s_mov_b64 exec, -1
    s_sleep 40
    s_lshl_b32 s7, s3, 11
    s_lshl_b32 s67, s4, 13
    s_cmp_eq_u32 s26, 0
    s_cselect_b32 s6, 0x80000, 0
    s_add_u32 s67, s67, s6
    s_add_u32 s67, s67, s7
    v_and_b32 v11, 3, v1
    v_min_u32 v11, 2, v11
    v_lshlrev_b32 v11, 7, v11
    v_lshl_add_u32 v11, v4, 10, v11
    s_add_u32 s60, s67, 0x75e200
    buffer_load_dword v11, v11, s[28:31], s60 offen sc1
    s_add_u32 s59, s41, 9
    s_waitcnt vmcnt(0)
    s_mov_b32 s61, 0
Lpoll_128:
    v_subrev_u32 v11, s59, v11
    v_cmp_le_u32 vcc, 16, v11
    s_cbranch_vccz Lpd_129
    s_sleep 2
    v_and_b32 v11, 3, v1
    v_min_u32 v11, 2, v11
    v_lshlrev_b32 v11, 7, v11
    v_lshl_add_u32 v11, v4, 10, v11
    s_add_u32 s60, s67, 0x75e200
    buffer_load_dword v11, v11, s[28:31], s60 offen sc1
    s_waitcnt vmcnt(0)
    s_add_u32 s61, s61, 1
    s_cmp_lt_u32 s61, 200000
    s_cbranch_scc1 Lpoll_128
Lpd_129:
    v_add_u32 v12, 0x16e0000, v3
    v_add_u32 v13, s69, v2
    v_add_u32 v11, 81920, v13
    buffer_load_dwordx4 v[96:99], v12, s[28:31], s8 offen offset:0 sc1
    buffer_load_dwordx4 v[100:103], v12, s[28:31], s9 offen offset:0 sc1
    buffer_load_dwordx4 v[104:107], v12, s[28:31], s10 offen offset:0 sc1
    buffer_load_dwordx4 v[108:111], v12, s[28:31], s11 offen offset:0 sc1
    buffer_load_dwordx4 v[112:115], v12, s[28:31], s8 offen offset:256 sc1
    buffer_load_dwordx4 v[116:119], v12, s[28:31], s9 offen offset:256 sc1
    buffer_load_dwordx4 v[120:123], v12, s[28:31], s10 offen offset:256 sc1
    buffer_load_dwordx4 v[124:127], v12, s[28:31], s11 offen offset:256 sc1
    buffer_load_dwordx4 v[128:131], v12, s[28:31], s8 offen offset:512 sc1
    buffer_load_dwordx4 v[132:135], v12, s[28:31], s9 offen offset:512 sc1
    s_mov_b32 s61, 0
Lcw_130:
    v_mov_b32 v7, 9732
    ds_read_b32 v7, v7
    s_waitcnt lgkmcnt(0)
    v_cmp_gt_u32 vcc, 8, v7
    s_cbranch_vccz Lcd_131
    s_sleep 1
    s_add_u32 s61, s61, 1
    s_cmp_lt_u32 s61, 200000
    s_cbranch_scc1 Lcw_130
Lcd_131:
    v_mov_b32 v7, 9732
    v_mov_b32 v0, 1
    s_mov_b64 exec, 1
    ds_add_u32 v7, v0
    s_mov_b64 exec, -1
    s_setprio 0
    s_waitcnt vmcnt(9)
    v_mfma_f32_16x16x32_bf16 v[16:19], v[136:139], v[96:99], v[16:19]
    s_add_u32 m0, s69, 0
    s_add_u32 s64, s10, 512
    buffer_load_dwordx4 v12, s[28:31], s64 offen sc1 lds
    v_mfma_f32_16x16x32_bf16 v[20:23], v[140:143], v[96:99], v[20:23]
    s_add_u32 m0, s69, 1024
    s_add_u32 s64, s11, 512
    buffer_load_dwordx4 v12, s[28:31], s64 offen sc1 lds
    v_mfma_f32_16x16x32_bf16 v[24:27], v[144:147], v[96:99], v[24:27]
    v_mfma_f32_16x16x32_bf16 v[28:31], v[148:151], v[96:99], v[28:31]
    v_mfma_f32_16x16x32_bf16 v[32:35], v[152:155], v[96:99], v[32:35]
    s_waitcnt vmcnt(10)
    v_mfma_f32_16x16x32_bf16 v[16:19], v[156:159], v[100:103], v[16:19]
    s_add_u32 m0, s69, 2048
    s_add_u32 s64, s8, 768
    buffer_load_dwordx4 v12, s[28:31], s64 offen sc1 lds
    v_mfma_f32_16x16x32_bf16 v[20:23], v[160:163], v[100:103], v[20:23]
    s_add_u32 m0, s69, 3072
    s_add_u32 s64, s9, 768
    buffer_load_dwordx4 v12, s[28:31], s64 offen sc1 lds
    v_mfma_f32_16x16x32_bf16 v[24:27], v[164:167], v[100:103], v[24:27]
    v_mfma_f32_16x16x32_bf16 v[28:31], v[168:171], v[100:103], v[28:31]
    v_mfma_f32_16x16x32_bf16 v[32:35], v[172:175], v[100:103], v[32:35]
    s_waitcnt vmcnt(11)
    v_mfma_f32_16x16x32_bf16 v[16:19], v[176:179], v[104:107], v[16:19]
    s_add_u32 m0, s69, 4096
    s_add_u32 s64, s10, 768
    buffer_load_dwordx4 v12, s[28:31], s64 offen sc1 lds
    v_mfma_f32_16x16x32_bf16 v[20:23], v[180:183], v[104:107], v[20:23]
    s_add_u32 m0, s69, 5120
    s_add_u32 s64, s11, 768
    buffer_load_dwordx4 v12, s[28:31], s64 offen sc1 lds
    v_mfma_f32_16x16x32_bf16 v[24:27], v[184:187], v[104:107], v[24:27]
    v_mfma_f32_16x16x32_bf16 v[28:31], v[188:191], v[104:107], v[28:31]
    v_mfma_f32_16x16x32_bf16 v[32:35], v[192:195], v[104:107], v[32:35]
    s_waitcnt vmcnt(12)
    v_mfma_f32_16x16x32_bf16 v[16:19], v[196:199], v[108:111], v[16:19]
    v_mfma_f32_16x16x32_bf16 v[20:23], v[200:203], v[108:111], v[20:23]
    v_mfma_f32_16x16x32_bf16 v[24:27], v[204:207], v[108:111], v[24:27]
    v_mfma_f32_16x16x32_bf16 v[28:31], v[208:211], v[108:111], v[28:31]
    v_mfma_f32_16x16x32_bf16 v[32:35], v[212:215], v[108:111], v[32:35]
    s_waitcnt vmcnt(11)
    v_mfma_f32_16x16x32_bf16 v[36:39], v[136:139], v[112:115], v[36:39]
    v_mfma_f32_16x16x32_bf16 v[40:43], v[140:143], v[112:115], v[40:43]
    v_mfma_f32_16x16x32_bf16 v[44:47], v[144:147], v[112:115], v[44:47]
    v_mfma_f32_16x16x32_bf16 v[48:51], v[148:151], v[112:115], v[48:51]
    v_mfma_f32_16x16x32_bf16 v[52:55], v[152:155], v[112:115], v[52:55]
    s_waitcnt vmcnt(10)
    v_mfma_f32_16x16x32_bf16 v[36:39], v[156:159], v[116:119], v[36:39]
    ds_write_b128 v11, v[16:19] offset:0
    v_mfma_f32_16x16x32_bf16 v[40:43], v[160:163], v[116:119], v[40:43]
    ds_write_b128 v11, v[20:23] offset:1024
    v_mfma_f32_16x16x32_bf16 v[44:47], v[164:167], v[116:119], v[44:47]
    v_mfma_f32_16x16x32_bf16 v[48:51], v[168:171], v[116:119], v[48:51]
    v_mfma_f32_16x16x32_bf16 v[52:55], v[172:175], v[116:119], v[52:55]
    s_waitcnt vmcnt(9)
    v_mfma_f32_16x16x32_bf16 v[36:39], v[176:179], v[120:123], v[36:39]
    ds_write_b128 v11, v[24:27] offset:2048
    v_mfma_f32_16x16x32_bf16 v[40:43], v[180:183], v[120:123], v[40:43]
    ds_write_b128 v11, v[28:31] offset:3072
    v_mfma_f32_16x16x32_bf16 v[44:47], v[184:187], v[120:123], v[44:47]
    v_mfma_f32_16x16x32_bf16 v[48:51], v[188:191], v[120:123], v[48:51]
    v_mfma_f32_16x16x32_bf16 v[52:55], v[192:195], v[120:123], v[52:55]
    s_waitcnt vmcnt(5)
    v_mfma_f32_16x16x32_bf16 v[36:39], v[196:199], v[124:127], v[36:39]
    ds_read_b128 v[120:123], v13 offset:0
    v_mfma_f32_16x16x32_bf16 v[40:43], v[200:203], v[124:127], v[40:43]
    ds_write_b128 v11, v[32:35] offset:4096
    v_mfma_f32_16x16x32_bf16 v[44:47], v[204:207], v[124:127], v[44:47]
    v_mfma_f32_16x16x32_bf16 v[48:51], v[208:211], v[124:127], v[48:51]
    v_mfma_f32_16x16x32_bf16 v[52:55], v[212:215], v[124:127], v[52:55]
    s_waitcnt vmcnt(4)
    v_mfma_f32_16x16x32_bf16 v[56:59], v[136:139], v[128:131], v[56:59]
    ds_read_b128 v[124:127], v13 offset:1024
    v_mfma_f32_16x16x32_bf16 v[60:63], v[140:143], v[128:131], v[60:63]
    v_mfma_f32_16x16x32_bf16 v[64:67], v[144:147], v[128:131], v[64:67]
    v_mfma_f32_16x16x32_bf16 v[68:71], v[148:151], v[128:131], v[68:71]
    v_mfma_f32_16x16x32_bf16 v[72:75], v[152:155], v[128:131], v[72:75]
    s_waitcnt vmcnt(3)
    v_mfma_f32_16x16x32_bf16 v[56:59], v[156:159], v[132:135], v[56:59]
    ds_read_b128 v[128:131], v13 offset:2048
    v_mfma_f32_16x16x32_bf16 v[60:63], v[160:163], v[132:135], v[60:63]
    ds_write_b128 v11, v[36:39] offset:5120
    v_mfma_f32_16x16x32_bf16 v[64:67], v[164:167], v[132:135], v[64:67]
    ds_write_b128 v11, v[40:43] offset:6144
    v_mfma_f32_16x16x32_bf16 v[68:71], v[168:171], v[132:135], v[68:71]
    v_mfma_f32_16x16x32_bf16 v[72:75], v[172:175], v[132:135], v[72:75]
    s_waitcnt vmcnt(2) lgkmcnt(5)
    v_mfma_f32_16x16x32_bf16 v[56:59], v[176:179], v[120:123], v[56:59]
    ds_read_b128 v[132:135], v13 offset:3072
    v_mfma_f32_16x16x32_bf16 v[60:63], v[180:183], v[120:123], v[60:63]
    ds_write_b128 v11, v[44:47] offset:7168
    v_mfma_f32_16x16x32_bf16 v[64:67], v[184:187], v[120:123], v[64:67]
    ds_write_b128 v11, v[48:51] offset:8192
    v_mfma_f32_16x16x32_bf16 v[68:71], v[188:191], v[120:123], v[68:71]
    v_mfma_f32_16x16x32_bf16 v[72:75], v[192:195], v[120:123], v[72:75]
    s_waitcnt vmcnt(1) lgkmcnt(6)
    v_mfma_f32_16x16x32_bf16 v[56:59], v[196:199], v[124:127], v[56:59]
    ds_read_b128 v[120:123], v13 offset:4096
    v_mfma_f32_16x16x32_bf16 v[60:63], v[200:203], v[124:127], v[60:63]
    ds_write_b128 v11, v[52:55] offset:9216
    v_mfma_f32_16x16x32_bf16 v[64:67], v[204:207], v[124:127], v[64:67]
    v_mfma_f32_16x16x32_bf16 v[68:71], v[208:211], v[124:127], v[68:71]
    v_mfma_f32_16x16x32_bf16 v[72:75], v[212:215], v[124:127], v[72:75]
    s_waitcnt vmcnt(0) lgkmcnt(7)
    v_mfma_f32_16x16x32_bf16 v[76:79], v[136:139], v[128:131], v[76:79]
    ds_read_b128 v[124:127], v13 offset:5120
    v_mfma_f32_16x16x32_bf16 v[80:83], v[140:143], v[128:131], v[80:83]
    v_mfma_f32_16x16x32_bf16 v[84:87], v[144:147], v[128:131], v[84:87]
    v_mfma_f32_16x16x32_bf16 v[88:91], v[148:151], v[128:131], v[88:91]
    v_mfma_f32_16x16x32_bf16 v[92:95], v[152:155], v[128:131], v[92:95]
    s_waitcnt lgkmcnt(0)
    v_mfma_f32_16x16x32_bf16 v[76:79], v[156:159], v[132:135], v[76:79]
    ds_write_b128 v13, v[56:59] offset:0
    v_mfma_f32_16x16x32_bf16 v[80:83], v[160:163], v[132:135], v[80:83]
    ds_write_b128 v13, v[60:63] offset:1024
    v_mfma_f32_16x16x32_bf16 v[84:87], v[164:167], v[132:135], v[84:87]
    v_mfma_f32_16x16x32_bf16 v[88:91], v[168:171], v[132:135], v[88:91]
    v_mfma_f32_16x16x32_bf16 v[92:95], v[172:175], v[132:135], v[92:95]
    v_mfma_f32_16x16x32_bf16 v[76:79], v[176:179], v[120:123], v[76:79]
    ds_write_b128 v13, v[64:67] offset:2048
    v_mfma_f32_16x16x32_bf16 v[80:83], v[180:183], v[120:123], v[80:83]
    ds_write_b128 v13, v[68:71] offset:3072
    v_mfma_f32_16x16x32_bf16 v[84:87], v[184:187], v[120:123], v[84:87]
    v_mfma_f32_16x16x32_bf16 v[88:91], v[188:191], v[120:123], v[88:91]
    v_mfma_f32_16x16x32_bf16 v[92:95], v[192:195], v[120:123], v[92:95]
    v_mfma_f32_16x16x32_bf16 v[76:79], v[196:199], v[124:127], v[76:79]
    ds_write_b128 v13, v[72:75] offset:4096
    v_mfma_f32_16x16x32_bf16 v[80:83], v[200:203], v[124:127], v[80:83]
    v_mfma_f32_16x16x32_bf16 v[84:87], v[204:207], v[124:127], v[84:87]
    v_mfma_f32_16x16x32_bf16 v[88:91], v[208:211], v[124:127], v[88:91]
    v_mfma_f32_16x16x32_bf16 v[92:95], v[212:215], v[124:127], v[92:95]
    s_setprio 3
    s_nop 1
    ds_write_b128 v13, v[76:79] offset:5120
    s_nop 0
    ds_write_b128 v13, v[80:83] offset:6144
    ds_write_b128 v13, v[84:87] offset:7168
    ds_write_b128 v13, v[88:91] offset:8192
    ds_write_b128 v13, v[92:95] offset:9216
Ljoin_86:
    s_nop 1
    s_add_u32 s6, s3, 0
    s_cmp_ge_u32 s6, 5
    s_cselect_b32 s7, 5, 0
    s_cselect_b32 s62, 0, 81920
    s_cselect_b32 s65, s51, s4
    s_sub_u32 s6, s6, s7
    s_lshl_b32 s7, s6, 10
    s_add_u32 s62, s62, s7
    v_lshrrev_b32 v11, 4, v10
    v_mul_u32_u24 v11, 5120, v11
    v_lshl_add_u32 v11, v4, 9, v11
    v_lshl_add_u32 v11, v8, 4, v11
    v_add_u32 v11, s62, v11
    v_add_u32 v13, 51200, v11
    s_lshl_b32 s6, s6, 1
    s_mul_i32 s7, s5, 10
    s_add_u32 s6, s6, s7
    v_add_u32 v7, s6, v4
    v_lshlrev_b32 v7, 4, v7
    s_mov_b32 s7, 81920
    v_mad_u32_u24 v7, v10, s7, v7
    s_mulk_i32 s65, 1280
    s_waitcnt lgkmcnt(0)
    s_barrier
    ds_read_b128 v[56:59], v11 offset:0
    ds_read_b128 v[60:63], v11 offset:256
    ds_read_b128 v[64:67], v11 offset:10240
    ds_read_b128 v[68:71], v11 offset:10496
    ds_read_b128 v[72:75], v11 offset:20480
    ds_read_b128 v[76:79], v11 offset:20736
    ds_read_b128 v[80:83], v11 offset:30720
    ds_read_b128 v[84:87], v11 offset:30976
    ds_read_b128 v[88:91], v11 offset:40960
    ds_read_b128 v[92:95], v11 offset:41216
    ds_read_b128 v[96:99], v13 offset:0
    ds_read_b128 v[100:103], v13 offset:256
    ds_read_b128 v[104:107], v13 offset:10240
    ds_read_b128 v[108:111], v13 offset:10496
    s_waitcnt lgkmcnt(10)
    v_pk_add_f32 v[56:57], v[56:57], v[64:65]
    v_pk_add_f32 v[58:59], v[58:59], v[66:67]
    v_pk_add_f32 v[60:61], v[60:61], v[68:69]
    v_pk_add_f32 v[62:63], v[62:63], v[70:71]
    ds_read_b128 v[64:67], v13 offset:20480
    ds_read_b128 v[68:71], v13 offset:20736
    s_waitcnt lgkmcnt(10)
    v_pk_add_f32 v[56:57], v[56:57], v[72:73]
    v_pk_add_f32 v[58:59], v[58:59], v[74:75]
    v_pk_add_f32 v[60:61], v[60:61], v[76:77]
    v_pk_add_f32 v[62:63], v[62:63], v[78:79]
    s_waitcnt lgkmcnt(8)
    v_pk_add_f32 v[56:57], v[56:57], v[80:81]
    v_pk_add_f32 v[58:59], v[58:59], v[82:83]
    v_pk_add_f32 v[60:61], v[60:61], v[84:85]
    v_pk_add_f32 v[62:63], v[62:63], v[86:87]
    s_waitcnt lgkmcnt(6)
    v_pk_add_f32 v[56:57], v[56:57], v[88:89]
    v_pk_add_f32 v[58:59], v[58:59], v[90:91]
    v_pk_add_f32 v[60:61], v[60:61], v[92:93]
    v_pk_add_f32 v[62:63], v[62:63], v[94:95]
    s_waitcnt lgkmcnt(4)
    v_pk_add_f32 v[56:57], v[56:57], v[96:97]
    v_pk_add_f32 v[58:59], v[58:59], v[98:99]
    v_pk_add_f32 v[60:61], v[60:61], v[100:101]
    v_pk_add_f32 v[62:63], v[62:63], v[102:103]
    s_waitcnt lgkmcnt(2)
    v_pk_add_f32 v[56:57], v[56:57], v[104:105]
    v_pk_add_f32 v[58:59], v[58:59], v[106:107]
    v_pk_add_f32 v[60:61], v[60:61], v[108:109]
    v_pk_add_f32 v[62:63], v[62:63], v[110:111]
    s_waitcnt lgkmcnt(0)
    v_pk_add_f32 v[56:57], v[56:57], v[64:65]
    v_pk_add_f32 v[58:59], v[58:59], v[66:67]
    v_pk_add_f32 v[60:61], v[60:61], v[68:69]
    v_pk_add_f32 v[62:63], v[62:63], v[70:71]
    v_cvt_pk_bf16_f32 v56, v56, v57
    v_cvt_pk_bf16_f32 v57, v58, v59
    v_cvt_pk_bf16_f32 v58, v60, v61
    v_cvt_pk_bf16_f32 v59, v62, v63
    buffer_store_dwordx4 v[56:59], v7, s[32:35], s65 offen
    s_cmp_ge_u32 s3, 2
    s_cbranch_scc1 Lnr_132
    s_add_u32 s6, s3, 8
    s_cmp_ge_u32 s6, 5
    s_cselect_b32 s7, 5, 0
    s_cselect_b32 s62, 0, 81920
    s_cselect_b32 s65, s51, s4
    s_sub_u32 s6, s6, s7
    s_lshl_b32 s7, s6, 10
    s_add_u32 s62, s62, s7
    v_lshrrev_b32 v11, 4, v10
    v_mul_u32_u24 v11, 5120, v11
    v_lshl_add_u32 v11, v4, 9, v11
    v_lshl_add_u32 v11, v8, 4, v11
    v_add_u32 v11, s62, v11
    v_add_u32 v13, 51200, v11
    s_lshl_b32 s6, s6, 1
    s_mul_i32 s7, s5, 10
    s_add_u32 s6, s6, s7
    v_add_u32 v7, s6, v4
    v_lshlrev_b32 v7, 4, v7
    s_mov_b32 s7, 81920
    v_mad_u32_u24 v7, v10, s7, v7
    s_mulk_i32 s65, 1280
    ds_read_b128 v[56:59], v11 offset:0
    ds_read_b128 v[60:63], v11 offset:256
    ds_read_b128 v[64:67], v11 offset:10240
    ds_read_b128 v[68:71], v11 offset:10496
    ds_read_b128 v[72:75], v11 offset:20480
    ds_read_b128 v[76:79], v11 offset:20736
    ds_read_b128 v[80:83], v11 offset:30720
    ds_read_b128 v[84:87], v11 offset:30976
    ds_read_b128 v[88:91], v11 offset:40960
    ds_read_b128 v[92:95], v11 offset:41216
    ds_read_b128 v[96:99], v13 offset:0
    ds_read_b128 v[100:103], v13 offset:256
    ds_read_b128 v[104:107], v13 offset:10240
    ds_read_b128 v[108:111], v13 offset:10496
    s_waitcnt lgkmcnt(10)
    v_pk_add_f32 v[56:57], v[56:57], v[64:65]
    v_pk_add_f32 v[58:59], v[58:59], v[66:67]
    v_pk_add_f32 v[60:61], v[60:61], v[68:69]
    v_pk_add_f32 v[62:63], v[62:63], v[70:71]
    ds_read_b128 v[64:67], v13 offset:20480
    ds_read_b128 v[68:71], v13 offset:20736
    s_waitcnt lgkmcnt(10)
    v_pk_add_f32 v[56:57], v[56:57], v[72:73]
    v_pk_add_f32 v[58:59], v[58:59], v[74:75]
    v_pk_add_f32 v[60:61], v[60:61], v[76:77]
    v_pk_add_f32 v[62:63], v[62:63], v[78:79]
    s_waitcnt lgkmcnt(8)
    v_pk_add_f32 v[56:57], v[56:57], v[80:81]
    v_pk_add_f32 v[58:59], v[58:59], v[82:83]
    v_pk_add_f32 v[60:61], v[60:61], v[84:85]
    v_pk_add_f32 v[62:63], v[62:63], v[86:87]
    s_waitcnt lgkmcnt(6)
    v_pk_add_f32 v[56:57], v[56:57], v[88:89]
    v_pk_add_f32 v[58:59], v[58:59], v[90:91]
    v_pk_add_f32 v[60:61], v[60:61], v[92:93]
    v_pk_add_f32 v[62:63], v[62:63], v[94:95]
    s_waitcnt lgkmcnt(4)
    v_pk_add_f32 v[56:57], v[56:57], v[96:97]
    v_pk_add_f32 v[58:59], v[58:59], v[98:99]
    v_pk_add_f32 v[60:61], v[60:61], v[100:101]
    v_pk_add_f32 v[62:63], v[62:63], v[102:103]
    s_waitcnt lgkmcnt(2)
    v_pk_add_f32 v[56:57], v[56:57], v[104:105]
    v_pk_add_f32 v[58:59], v[58:59], v[106:107]
    v_pk_add_f32 v[60:61], v[60:61], v[108:109]
    v_pk_add_f32 v[62:63], v[62:63], v[110:111]
    s_waitcnt lgkmcnt(0)
    v_pk_add_f32 v[56:57], v[56:57], v[64:65]
    v_pk_add_f32 v[58:59], v[58:59], v[66:67]
    v_pk_add_f32 v[60:61], v[60:61], v[68:69]
    v_pk_add_f32 v[62:63], v[62:63], v[70:71]
    v_cvt_pk_bf16_f32 v56, v56, v57
    v_cvt_pk_bf16_f32 v57, v58, v59
    v_cvt_pk_bf16_f32 v58, v60, v61
    v_cvt_pk_bf16_f32 v59, v62, v63
    buffer_store_dwordx4 v[56:59], v7, s[32:35], s65 offen
Lnr_132:
    s_lshl_b32 s6, s2, 3
    s_add_u32 s6, s6, s3
    s_cmp_lg_u32 s6, 7
    s_cbranch_scc1 Lnn_133
    v_mov_b32 v0, s41
    s_mov_b32 s7, 0x7a0000
    s_mov_b64 exec, 1
    buffer_store_dword v0, off, s[28:31], s7 sc1
    s_mov_b64 exec, -1
Lnn_133:
interleave_layers__spectral_fnet__dense_activation_relu__prompt_kernel_end:
    s_endpgm
.section .rodata,"a"
.p2align 6
.amdhsa_kernel interleave_layers__spectral_fnet__dense_activation_relu__prompt_kernel
  .amdhsa_next_free_vgpr 256
  .amdhsa_next_free_sgpr 102
  .amdhsa_accum_offset 256
  .amdhsa_group_segment_fixed_size 0
  .amdhsa_kernarg_size 88
  .amdhsa_user_sgpr_count 2
  .amdhsa_user_sgpr_kernarg_segment_ptr 1
  .amdhsa_system_sgpr_workgroup_id_x 1
.end_amdhsa_kernel
```
